```python
import torch

def _softmax(x, axis=-1):
    return torch.softmax(x, dim=axis)
def _gelu(x):
    return torch.nn.functional.gelu(x, approximate="tanh")
def _silu(x):
    return torch.nn.functional.silu(x)
def _sigmoid(x):
    return torch.sigmoid(x)
def _layernorm(x, axis=-1, eps=1e-5):
    m = x.mean(dim=axis, keepdim=True)
    v = x.var(dim=axis, keepdim=True, unbiased=False)
    return (x - m) / torch.sqrt(v + eps)
def _scatter_add(tgt, idx, src, axis=0):
    return tgt.clone().index_add_(axis, idx, src)
def _segment_sum(src, seg, n):
    out = torch.zeros((n,) + src.shape[1:], dtype=src.dtype)
    return out.index_add_(0, seg, src)
def _pad(x, pw):
    flat = tuple(v for pair in reversed(pw) for v in pair)
    return torch.nn.functional.pad(x, flat)

kernel_name = 'recurrent_scan__ssm_conv_s4d__dense_activation_silu__prompt'

def setup_inputs():

    _w = (lambda a: (lambda t: t.to(torch.bfloat16) if t.is_floating_point() else t)(torch.as_tensor(a)))
    def _A_setup():
        Bsz, L, D, N = 1, 2048, 640, 128
        return {
            "u": _w((lambda *s: torch.randn(*s, dtype=torch.bfloat16) * 0.05)(Bsz, L, D)),
            "log_A_real": _w((lambda *s: torch.randn(*s, dtype=torch.bfloat16) * 6.4)(D, N) * 0.5),
            "A_imag": _w((lambda *s: torch.randn(*s, dtype=torch.bfloat16) * 0.2)(D, N) * 3.14),
            "C_real": _w((lambda *s: torch.randn(*s, dtype=torch.bfloat16) * 0.4)(D, N) / N ** 0.5),
            "C_imag": _w((lambda *s: torch.randn(*s, dtype=torch.bfloat16) * 0.4)(D, N) / N ** 0.5),
            "log_dt": _w((lambda *s: torch.randn(*s, dtype=torch.bfloat16) * 0.2)(D) * 0.5 - 4.0),
            "D_skip": _w((lambda *s: torch.randn(*s, dtype=torch.bfloat16) * 0.2)(D)),
        }
    _A_in = _A_setup()

    def _B_setup():
        B, S, D, F = 1, 2048, 640, 1728
        return {
            "x": _w((lambda *s: torch.randn(*s, dtype=torch.bfloat16) * 0.05)(B, S, D)),
            "w1": _w((lambda *s: torch.randn(*s, dtype=torch.bfloat16) * 0.8)(D, F) * (D ** -0.5)),
            "w2": _w((lambda *s: torch.randn(*s, dtype=torch.bfloat16) * 0.1)(F, D) * (F ** -0.5)),
        }
    _B_in = _B_setup()

    return {
        "A_u": _A_in["u"],
        "A_log_A_real": _A_in["log_A_real"],
        "A_A_imag": _A_in["A_imag"],
        "A_C_real": _A_in["C_real"],
        "A_C_imag": _A_in["C_imag"],
        "A_log_dt": _A_in["log_dt"],
        "A_D_skip": _A_in["D_skip"],
        "B_x": _B_in["x"],
        "B_w1": _B_in["w1"],
        "B_w2": _B_in["w2"],
    }

def reference(A_u, A_log_A_real, A_A_imag, A_C_real, A_C_imag, A_log_dt, A_D_skip, B_x, B_w1, B_w2):
    def _A_ref(u, log_A_real, A_imag, C_real, C_imag, log_dt, D_skip):
        L = u.shape[1]
        dt = torch.exp(log_dt)
        A = -torch.exp(log_A_real) + 1j * A_imag
        C = (C_real + 1j * C_imag) * dt[:, None]
        pos = (lambda x, dt: x.to(dt))(torch.arange(L), log_dt.dtype)
        P = torch.exp((A * dt[:, None])[:, :, None] * pos[None, None, :])
        K = 2.0 * torch.einsum("dn,dnl->dl", C, P).real
        L2 = 2 * L
        u_t = (lambda x, *d: x.permute(*d))(u, 0, 2, 1)
        Kf = (lambda x, *a, **k: torch.fft.rfft(x.float(), *a, **k))(K, L2)
        Uf = (lambda x, *a, **k: torch.fft.rfft(x.float(), *a, **k))(u_t, L2)
        y = (lambda x, *a, **k: torch.fft.irfft(x, *a, **k).to(torch.bfloat16))(Uf * Kf[None, :, :], L2)[:, :, :L]
        y = (lambda x, *d: x.permute(*d))(y, 0, 2, 1)
        return y + u * D_skip[None, None, :]

    def _B_ref(x, w1, w2):
        h = torch.einsum("bsd,df->bsf", x, w1)
        h = _silu(h)
        out = torch.einsum("bsf,fd->bsd", h, w2)
        return out

    x = A_u
    xn = _layernorm(x, axis=-1)
    s = _A_ref(xn, A_log_A_real, A_A_imag, A_C_real, A_C_imag, A_log_dt, A_D_skip)
    g = _silu(_B_ref(xn, B_w1, B_w2))
    return x + s * g
```

```asm
; @launch grid=(512,1,1) block=(256,1,1) lds=81920
.amdgcn_target "amdgcn-amd-amdhsa--gfx950"
.text
.globl recurrent_scan__ssm_conv_s4d__dense_activation_silu__prompt_kernel
.p2align 8
.type recurrent_scan__ssm_conv_s4d__dense_activation_silu__prompt_kernel,@function
recurrent_scan__ssm_conv_s4d__dense_activation_silu__prompt_kernel:
    s_cmp_lt_u32 s2, 288
    s_cbranch_scc1 L_others_k
    s_cmp_ge_u32 s2, 512
    s_cbranch_scc1 L_exit_k
L_role_k_3:
    s_sub_u32 s3, s2, 288
L_body_k_3:
    s_setprio 3
    s_load_dwordx2 s[40:41], s[0:1], 0
    s_load_dwordx2 s[42:43], s[0:1], 64
    s_load_dwordx2 s[44:45], s[0:1], 96
    v_and_b32 v1, 63, v0
    v_lshrrev_b32 v2, 6, v0
    s_nop 0
    v_readfirstlane_b32 s4, v2
    s_and_b32 s5, s3, 7
    s_lshr_b32 s6, s3, 3
    s_lshr_b32 s7, s5, 1
    s_and_b32 s5, s5, 1
    s_and_b32 s32, s6, 3
    s_lshl_b32 s24, s7, 2
    s_add_u32 s24, s24, s32
    s_lshr_b32 s33, s6, 2
    s_mul_i32 s25, s5, 7
    s_add_u32 s25, s25, s33
    s_lshl_b32 s5, s5, 1
    s_add_u32 s5, s5, s7
    s_and_b32 s5, s5, 3
    s_mul_i32 s5, s5, 5
    s_and_b32 s26, s5, 0xfe
    s_lshr_b32 s27, s4, 1
    s_and_b32 s28, s4, 1
    v_lshrrev_b32 v4, 3, v1
    s_lshl_b32 s5, s24, 7
    s_lshl_b32 s6, s4, 5
    s_add_u32 s5, s5, s6
    v_add_u32 v4, s5, v4
    v_mul_u32_u24 v6, 1280, v4
    v_lshrrev_b32 v5, 4, v1
    v_xor_b32 v5, v5, v1
    v_and_b32 v5, 7, v5
    v_lshl_add_u32 v2, v5, 4, v6
    v_xor_b32 v5, 4, v5
    v_lshl_add_u32 v7, v5, 4, v6
    v_add_u32 v7, 10240, v7
    v_lshrrev_b32 v4, 4, v1
    v_lshlrev_b32 v5, 2, v4
    v_and_b32 v6, 15, v1
    v_xor_b32 v5, v5, v6
    s_lshl_b32 s5, s4, 3
    v_add_u32 v4, s5, v4
    v_mul_u32_u24 v3, 3456, v4
    v_lshl_add_u32 v3, v5, 4, v3
    s_lshl_b32 s5, s25, 8
    v_add_u32 v3, s5, v3
    v_lshl_add_u32 v6, v5, 4, s5
    v_cmp_le_u32 vcc, 3456, v6
    v_mov_b32 v6, 0x7f000000
    s_nop 0
    v_cndmask_b32 v3, v3, v6, vcc
    v_add_u32 v8, 13824, v3
    s_lshl_b32 s31, s4, 11
    s_mov_b32 s33, s26
    s_waitcnt lgkmcnt(0)
    s_mov_b32 s8, s40
    s_mov_b32 s9, s41
    s_mov_b32 s10, 0x280000
    s_mov_b32 s11, 0x00020000
    s_mov_b32 s12, s42
    s_mov_b32 s13, s43
    s_mov_b32 s14, 0x21c000
    s_mov_b32 s15, 0x00020000
    s_mov_b32 s34, s26
    s_lshl_b32 s37, s4, 12
    s_mul_i32 s30, s33, 110592
    s_add_u32 m0, s31, 49152
    s_add_u32 s33, s33, 1
    buffer_load_dwordx4 v3, s[12:15], s30 offen lds
    s_add_u32 m0, s31, 50176
    s_cmp_eq_u32 s33, 20
    s_cselect_b32 s33, 0, s33
    buffer_load_dwordx4 v8, s[12:15], s30 offen lds
    s_lshl_b32 s29, s34, 6
    s_add_u32 m0, s37, 0
    s_add_u32 s34, s34, 2
    buffer_load_dwordx4 v2, s[8:11], s29 offen lds
    s_add_u32 m0, s37, 1024
    s_add_u32 s32, s29, 20480
    buffer_load_dwordx4 v7, s[8:11], s29 offen lds
    s_add_u32 m0, s37, 2048
    s_cmp_eq_u32 s34, 20
    s_cselect_b32 s34, 0, s34
    buffer_load_dwordx4 v2, s[8:11], s32 offen lds
    s_add_u32 m0, s37, 3072
    s_nop 0
    buffer_load_dwordx4 v7, s[8:11], s32 offen lds
    s_barrier
    s_mul_i32 s30, s33, 110592
    s_add_u32 m0, s31, 57344
    s_add_u32 s33, s33, 1
    buffer_load_dwordx4 v3, s[12:15], s30 offen lds
    s_add_u32 m0, s31, 58368
    s_cmp_eq_u32 s33, 20
    s_cselect_b32 s33, 0, s33
    buffer_load_dwordx4 v8, s[12:15], s30 offen lds
    s_mov_b32 s16, s44
    s_mov_b32 s17, s45
    s_mov_b32 s18, 0x4000
    s_mov_b32 s19, 0x00020000
    s_add_u32 s20, s44, 0x300000
    s_addc_u32 s21, s45, 0
    s_mov_b32 s22, 0x6c0000
    s_mov_b32 s23, 0x00020000
    s_add_u32 s80, s44, 0x1400000
    s_addc_u32 s81, s45, 0
    s_mov_b32 s82, 0x17000
    s_mov_b32 s83, 0x00020000
    v_and_b32 v4, 31, v1
    s_lshl_b32 s5, s28, 6
    v_add_u32 v4, s5, v4
    v_lshlrev_b32 v9, 7, v4
    v_lshrrev_b32 v5, 5, v1
    v_lshrrev_b32 v6, 1, v1
    v_and_b32 v6, 7, v6
    v_xor_b32 v6, v5, v6
    v_lshl_add_u32 v9, v6, 4, v9
    v_xor_b32 v10, 32, v9
    v_xor_b32 v25, 64, v9
    v_xor_b32 v26, 96, v9
    v_lshrrev_b32 v13, 5, v1
    v_and_b32 v4, 15, v1
    v_lshrrev_b32 v5, 2, v4
    v_lshl_add_u32 v6, v13, 3, v5
    v_lshlrev_b32 v11, 8, v6
    v_add_u32 v11, 49152, v11
    v_and_b32 v6, 1, v4
    v_lshl_add_u32 v11, v6, 3, v11
    v_and_b32 v4, 3, v4
    v_lshrrev_b32 v4, 1, v4
    v_lshrrev_b32 v6, 4, v1
    v_and_b32 v6, 1, v6
    v_lshl_add_u32 v4, v6, 1, v4
    s_lshl_b32 s5, s27, 3
    s_lshl_b32 s6, s28, 2
    s_add_u32 s5, s5, s6
    v_add_u32 v4, s5, v4
    v_lshlrev_b32 v5, 2, v5
    v_xor_b32 v6, v4, v5
    v_xor_b32 v4, 4, v6
    v_lshl_add_u32 v12, v4, 4, v11
    v_lshl_add_u32 v11, v6, 4, v11
    v_mov_b32 v24, 0
    v_mov_b32 v112, 0x3f803f80
    s_waitcnt vmcnt(2)
    s_barrier
    s_lshl_b32 s29, s34, 6
    s_add_u32 m0, s37, 16384
    s_add_u32 s34, s34, 2
    buffer_load_dwordx4 v2, s[8:11], s29 offen lds
    s_add_u32 m0, s37, 17408
    s_add_u32 s32, s29, 20480
    buffer_load_dwordx4 v7, s[8:11], s29 offen lds
    s_add_u32 m0, s37, 18432
    s_cmp_eq_u32 s34, 20
    s_cselect_b32 s34, 0, s34
    buffer_load_dwordx4 v2, s[8:11], s32 offen lds
    s_add_u32 m0, s37, 19456
    s_nop 0
    buffer_load_dwordx4 v7, s[8:11], s32 offen lds
    s_mul_i32 s30, s33, 110592
    s_add_u32 m0, s31, 65536
    s_add_u32 s33, s33, 1
    buffer_load_dwordx4 v3, s[12:15], s30 offen lds
    s_add_u32 m0, s31, 66560
    s_cmp_eq_u32 s33, 20
    s_cselect_b32 s33, 0, s33
    buffer_load_dwordx4 v8, s[12:15], s30 offen lds
    s_mul_i32 s30, s33, 110592
    s_add_u32 m0, s31, 73728
    s_add_u32 s33, s33, 1
    buffer_load_dwordx4 v3, s[12:15], s30 offen lds
    s_add_u32 m0, s31, 74752
    s_cmp_eq_u32 s33, 20
    s_cselect_b32 s33, 0, s33
    buffer_load_dwordx4 v8, s[12:15], s30 offen lds
    s_lshl_b32 s29, s34, 6
    s_add_u32 m0, s37, 32768
    s_add_u32 s34, s34, 2
    buffer_load_dwordx4 v2, s[8:11], s29 offen lds
    s_add_u32 m0, s37, 33792
    s_add_u32 s32, s29, 20480
    buffer_load_dwordx4 v7, s[8:11], s29 offen lds
    s_add_u32 m0, s37, 34816
    s_cmp_eq_u32 s34, 20
    s_cselect_b32 s34, 0, s34
    buffer_load_dwordx4 v2, s[8:11], s32 offen lds
    s_add_u32 m0, s37, 35840
    s_nop 0
    buffer_load_dwordx4 v7, s[8:11], s32 offen lds
    s_load_dwordx2 s[84:85], s[0:1], 88
    v_mov_b32 v18, 0
    v_and_b32 v20, 3, v1
    s_lshl_b32 s35, s24, 2
    s_add_u32 s35, s35, 0
    v_add_u32 v20, s35, v20
    v_lshlrev_b32 v20, 7, v20
    v_and_b32 v21, 31, v1
    s_lshl_b32 s5, s24, 7
    s_lshl_b32 s6, s28, 6
    s_add_u32 s5, s5, s6
    v_add_u32 v21, s5, v21
    v_lshlrev_b32 v21, 3, v21
    s_waitcnt lgkmcnt(0)
    s_mov_b32 s86, 256
    s_mov_b32 s87, 0x00020000
    ds_read_b64_tr_b16 v[116:117], v11 offset:0
    ds_read_b64_tr_b16 v[118:119], v11 offset:1024
    ds_read_b128 v[124:127], v9 offset:0
    ds_read_b64_tr_b16 v[120:121], v12 offset:0
    ds_read_b64_tr_b16 v[122:123], v12 offset:1024
    ds_read_b128 v[128:131], v9 offset:4096
    s_waitcnt lgkmcnt(0)
    v_mfma_f32_32x32x16_bf16 v[32:47], v[116:119], v[124:127], 0
    ds_read_b64_tr_b16 v[132:133], v11 offset:4096
    ds_read_b64_tr_b16 v[134:135], v11 offset:5120
    ds_read_b128 v[140:143], v10 offset:0
    v_mfma_f32_32x32x16_bf16 v[48:63], v[116:119], v[128:131], 0
    ds_read_b64_tr_b16 v[136:137], v12 offset:4096
    ds_read_b64_tr_b16 v[138:139], v12 offset:5120
    ds_read_b128 v[144:147], v10 offset:4096
    v_mfma_f32_32x32x16_bf16 v[64:79], v[120:123], v[124:127], 0
    v_dot2c_f32_bf16 v24, v116, v112
    v_dot2c_f32_bf16 v24, v117, v112
    v_mfma_f32_32x32x16_bf16 v[80:95], v[120:123], v[128:131], 0
    v_dot2c_f32_bf16 v24, v118, v112
    v_dot2c_f32_bf16 v24, v119, v112
    s_waitcnt vmcnt(12) lgkmcnt(0)
    s_barrier
    v_mfma_f32_32x32x16_bf16 v[32:47], v[132:135], v[140:143], v[32:47]
    ds_read_b64_tr_b16 v[116:117], v11 offset:8192
    ds_read_b64_tr_b16 v[118:119], v11 offset:9216
    ds_read_b128 v[124:127], v25 offset:0
    s_mul_i32 s30, s33, 110592
    s_add_u32 m0, s31, 49152
    s_add_u32 s33, s33, 1
    buffer_load_dwordx4 v3, s[12:15], s30 offen lds
    v_mfma_f32_32x32x16_bf16 v[48:63], v[132:135], v[144:147], v[48:63]
    ds_read_b64_tr_b16 v[120:121], v12 offset:8192
    ds_read_b64_tr_b16 v[122:123], v12 offset:9216
    ds_read_b128 v[128:131], v25 offset:4096
    s_add_u32 m0, s31, 50176
    s_cmp_eq_u32 s33, 20
    s_cselect_b32 s33, 0, s33
    buffer_load_dwordx4 v8, s[12:15], s30 offen lds
    v_mfma_f32_32x32x16_bf16 v[64:79], v[136:139], v[140:143], v[64:79]
    v_dot2c_f32_bf16 v24, v132, v112
    v_dot2c_f32_bf16 v24, v133, v112
    v_mfma_f32_32x32x16_bf16 v[80:95], v[136:139], v[144:147], v[80:95]
    v_dot2c_f32_bf16 v24, v134, v112
    v_dot2c_f32_bf16 v24, v135, v112
    s_waitcnt lgkmcnt(0)
    v_mfma_f32_32x32x16_bf16 v[32:47], v[116:119], v[124:127], v[32:47]
    ds_read_b64_tr_b16 v[132:133], v11 offset:12288
    ds_read_b64_tr_b16 v[134:135], v11 offset:13312
    ds_read_b128 v[140:143], v26 offset:0
    v_mfma_f32_32x32x16_bf16 v[48:63], v[116:119], v[128:131], v[48:63]
    ds_read_b64_tr_b16 v[136:137], v12 offset:12288
    ds_read_b64_tr_b16 v[138:139], v12 offset:13312
    ds_read_b128 v[144:147], v26 offset:4096
    v_mfma_f32_32x32x16_bf16 v[64:79], v[120:123], v[124:127], v[64:79]
    v_dot2c_f32_bf16 v24, v116, v112
    v_dot2c_f32_bf16 v24, v117, v112
    v_mfma_f32_32x32x16_bf16 v[80:95], v[120:123], v[128:131], v[80:95]
    v_dot2c_f32_bf16 v24, v118, v112
    v_dot2c_f32_bf16 v24, v119, v112
    s_waitcnt vmcnt(8) lgkmcnt(0)
    s_barrier
    v_mfma_f32_32x32x16_bf16 v[32:47], v[132:135], v[140:143], v[32:47]
    ds_read_b64_tr_b16 v[116:117], v11 offset:16384
    ds_read_b64_tr_b16 v[118:119], v11 offset:17408
    ds_read_b128 v[124:127], v9 offset:16384
    s_mul_i32 s30, s33, 110592
    s_add_u32 m0, s31, 57344
    s_add_u32 s33, s33, 1
    buffer_load_dwordx4 v3, s[12:15], s30 offen lds
    v_mfma_f32_32x32x16_bf16 v[48:63], v[132:135], v[144:147], v[48:63]
    ds_read_b64_tr_b16 v[120:121], v12 offset:16384
    ds_read_b64_tr_b16 v[122:123], v12 offset:17408
    ds_read_b128 v[128:131], v9 offset:20480
    s_add_u32 m0, s31, 58368
    s_cmp_eq_u32 s33, 20
    s_cselect_b32 s33, 0, s33
    buffer_load_dwordx4 v8, s[12:15], s30 offen lds
    v_mfma_f32_32x32x16_bf16 v[64:79], v[136:139], v[140:143], v[64:79]
    v_dot2c_f32_bf16 v24, v132, v112
    v_dot2c_f32_bf16 v24, v133, v112
    s_lshl_b32 s29, s34, 6
    s_add_u32 m0, s37, 0
    s_add_u32 s34, s34, 2
    buffer_load_dwordx4 v2, s[8:11], s29 offen lds
    s_add_u32 m0, s37, 1024
    s_add_u32 s32, s29, 20480
    buffer_load_dwordx4 v7, s[8:11], s29 offen lds
    v_mfma_f32_32x32x16_bf16 v[80:95], v[136:139], v[144:147], v[80:95]
    v_dot2c_f32_bf16 v24, v134, v112
    v_dot2c_f32_bf16 v24, v135, v112
    s_add_u32 m0, s37, 2048
    s_cmp_eq_u32 s34, 20
    s_cselect_b32 s34, 0, s34
    buffer_load_dwordx4 v2, s[8:11], s32 offen lds
    s_add_u32 m0, s37, 3072
    s_nop 0
    buffer_load_dwordx4 v7, s[8:11], s32 offen lds
    s_waitcnt lgkmcnt(0)
    v_mfma_f32_32x32x16_bf16 v[32:47], v[116:119], v[124:127], v[32:47]
    ds_read_b64_tr_b16 v[132:133], v11 offset:20480
    ds_read_b64_tr_b16 v[134:135], v11 offset:21504
    ds_read_b128 v[140:143], v10 offset:16384
    v_mfma_f32_32x32x16_bf16 v[48:63], v[116:119], v[128:131], v[48:63]
    ds_read_b64_tr_b16 v[136:137], v12 offset:20480
    ds_read_b64_tr_b16 v[138:139], v12 offset:21504
    ds_read_b128 v[144:147], v10 offset:20480
    v_mfma_f32_32x32x16_bf16 v[64:79], v[120:123], v[124:127], v[64:79]
    v_dot2c_f32_bf16 v24, v116, v112
    v_dot2c_f32_bf16 v24, v117, v112
    v_mfma_f32_32x32x16_bf16 v[80:95], v[120:123], v[128:131], v[80:95]
    v_dot2c_f32_bf16 v24, v118, v112
    v_dot2c_f32_bf16 v24, v119, v112
    s_waitcnt vmcnt(12) lgkmcnt(0)
    s_barrier
    v_mfma_f32_32x32x16_bf16 v[32:47], v[132:135], v[140:143], v[32:47]
    ds_read_b64_tr_b16 v[116:117], v11 offset:24576
    ds_read_b64_tr_b16 v[118:119], v11 offset:25600
    ds_read_b128 v[124:127], v25 offset:16384
    s_mul_i32 s30, s33, 110592
    s_add_u32 m0, s31, 65536
    s_add_u32 s33, s33, 1
    buffer_load_dwordx4 v3, s[12:15], s30 offen lds
    v_mfma_f32_32x32x16_bf16 v[48:63], v[132:135], v[144:147], v[48:63]
    ds_read_b64_tr_b16 v[120:121], v12 offset:24576
    ds_read_b64_tr_b16 v[122:123], v12 offset:25600
    ds_read_b128 v[128:131], v25 offset:20480
    s_add_u32 m0, s31, 66560
    s_cmp_eq_u32 s33, 20
    s_cselect_b32 s33, 0, s33
    buffer_load_dwordx4 v8, s[12:15], s30 offen lds
    v_mfma_f32_32x32x16_bf16 v[64:79], v[136:139], v[140:143], v[64:79]
    v_dot2c_f32_bf16 v24, v132, v112
    v_dot2c_f32_bf16 v24, v133, v112
    v_mfma_f32_32x32x16_bf16 v[80:95], v[136:139], v[144:147], v[80:95]
    v_dot2c_f32_bf16 v24, v134, v112
    v_dot2c_f32_bf16 v24, v135, v112
    s_waitcnt lgkmcnt(0)
    v_mfma_f32_32x32x16_bf16 v[32:47], v[116:119], v[124:127], v[32:47]
    ds_read_b64_tr_b16 v[132:133], v11 offset:28672
    ds_read_b64_tr_b16 v[134:135], v11 offset:29696
    ds_read_b128 v[140:143], v26 offset:16384
    v_mfma_f32_32x32x16_bf16 v[48:63], v[116:119], v[128:131], v[48:63]
    ds_read_b64_tr_b16 v[136:137], v12 offset:28672
    ds_read_b64_tr_b16 v[138:139], v12 offset:29696
    ds_read_b128 v[144:147], v26 offset:20480
    v_mfma_f32_32x32x16_bf16 v[64:79], v[120:123], v[124:127], v[64:79]
    v_dot2c_f32_bf16 v24, v116, v112
    v_dot2c_f32_bf16 v24, v117, v112
    v_mfma_f32_32x32x16_bf16 v[80:95], v[120:123], v[128:131], v[80:95]
    v_dot2c_f32_bf16 v24, v118, v112
    v_dot2c_f32_bf16 v24, v119, v112
    s_waitcnt vmcnt(8) lgkmcnt(0)
    s_barrier
    v_mfma_f32_32x32x16_bf16 v[32:47], v[132:135], v[140:143], v[32:47]
    ds_read_b64_tr_b16 v[116:117], v11 offset:0
    ds_read_b64_tr_b16 v[118:119], v11 offset:1024
    ds_read_b128 v[124:127], v9 offset:32768
    s_mul_i32 s30, s33, 110592
    s_add_u32 m0, s31, 73728
    s_add_u32 s33, s33, 1
    buffer_load_dwordx4 v3, s[12:15], s30 offen lds
    v_mfma_f32_32x32x16_bf16 v[48:63], v[132:135], v[144:147], v[48:63]
    ds_read_b64_tr_b16 v[120:121], v12 offset:0
    ds_read_b64_tr_b16 v[122:123], v12 offset:1024
    ds_read_b128 v[128:131], v9 offset:36864
    s_add_u32 m0, s31, 74752
    s_cmp_eq_u32 s33, 20
    s_cselect_b32 s33, 0, s33
    buffer_load_dwordx4 v8, s[12:15], s30 offen lds
    v_mfma_f32_32x32x16_bf16 v[64:79], v[136:139], v[140:143], v[64:79]
    v_dot2c_f32_bf16 v24, v132, v112
    v_dot2c_f32_bf16 v24, v133, v112
    s_lshl_b32 s29, s34, 6
    s_add_u32 m0, s37, 16384
    s_add_u32 s34, s34, 2
    buffer_load_dwordx4 v2, s[8:11], s29 offen lds
    s_add_u32 m0, s37, 17408
    s_add_u32 s32, s29, 20480
    buffer_load_dwordx4 v7, s[8:11], s29 offen lds
    v_mfma_f32_32x32x16_bf16 v[80:95], v[136:139], v[144:147], v[80:95]
    v_dot2c_f32_bf16 v24, v134, v112
    v_dot2c_f32_bf16 v24, v135, v112
    s_add_u32 m0, s37, 18432
    s_cmp_eq_u32 s34, 20
    s_cselect_b32 s34, 0, s34
    buffer_load_dwordx4 v2, s[8:11], s32 offen lds
    s_add_u32 m0, s37, 19456
    s_nop 0
    buffer_load_dwordx4 v7, s[8:11], s32 offen lds
    s_waitcnt lgkmcnt(0)
    v_mfma_f32_32x32x16_bf16 v[32:47], v[116:119], v[124:127], v[32:47]
    ds_read_b64_tr_b16 v[132:133], v11 offset:4096
    ds_read_b64_tr_b16 v[134:135], v11 offset:5120
    ds_read_b128 v[140:143], v10 offset:32768
    v_mfma_f32_32x32x16_bf16 v[48:63], v[116:119], v[128:131], v[48:63]
    ds_read_b64_tr_b16 v[136:137], v12 offset:4096
    ds_read_b64_tr_b16 v[138:139], v12 offset:5120
    ds_read_b128 v[144:147], v10 offset:36864
    v_mfma_f32_32x32x16_bf16 v[64:79], v[120:123], v[124:127], v[64:79]
    v_dot2c_f32_bf16 v24, v116, v112
    v_dot2c_f32_bf16 v24, v117, v112
    v_mfma_f32_32x32x16_bf16 v[80:95], v[120:123], v[128:131], v[80:95]
    v_dot2c_f32_bf16 v24, v118, v112
    v_dot2c_f32_bf16 v24, v119, v112
    s_waitcnt vmcnt(12) lgkmcnt(0)
    s_barrier
    v_mfma_f32_32x32x16_bf16 v[32:47], v[132:135], v[140:143], v[32:47]
    ds_read_b64_tr_b16 v[116:117], v11 offset:8192
    ds_read_b64_tr_b16 v[118:119], v11 offset:9216
    ds_read_b128 v[124:127], v25 offset:32768
    s_mul_i32 s30, s33, 110592
    s_add_u32 m0, s31, 49152
    s_add_u32 s33, s33, 1
    buffer_load_dwordx4 v3, s[12:15], s30 offen lds
    v_mfma_f32_32x32x16_bf16 v[48:63], v[132:135], v[144:147], v[48:63]
    ds_read_b64_tr_b16 v[120:121], v12 offset:8192
    ds_read_b64_tr_b16 v[122:123], v12 offset:9216
    ds_read_b128 v[128:131], v25 offset:36864
    s_add_u32 m0, s31, 50176
    s_cmp_eq_u32 s33, 20
    s_cselect_b32 s33, 0, s33
    buffer_load_dwordx4 v8, s[12:15], s30 offen lds
    v_mfma_f32_32x32x16_bf16 v[64:79], v[136:139], v[140:143], v[64:79]
    v_dot2c_f32_bf16 v24, v132, v112
    v_dot2c_f32_bf16 v24, v133, v112
    v_mfma_f32_32x32x16_bf16 v[80:95], v[136:139], v[144:147], v[80:95]
    v_dot2c_f32_bf16 v24, v134, v112
    v_dot2c_f32_bf16 v24, v135, v112
    s_waitcnt lgkmcnt(0)
    v_mfma_f32_32x32x16_bf16 v[32:47], v[116:119], v[124:127], v[32:47]
    ds_read_b64_tr_b16 v[132:133], v11 offset:12288
    ds_read_b64_tr_b16 v[134:135], v11 offset:13312
    ds_read_b128 v[140:143], v26 offset:32768
    v_mfma_f32_32x32x16_bf16 v[48:63], v[116:119], v[128:131], v[48:63]
    ds_read_b64_tr_b16 v[136:137], v12 offset:12288
    ds_read_b64_tr_b16 v[138:139], v12 offset:13312
    ds_read_b128 v[144:147], v26 offset:36864
    v_mfma_f32_32x32x16_bf16 v[64:79], v[120:123], v[124:127], v[64:79]
    v_dot2c_f32_bf16 v24, v116, v112
    v_dot2c_f32_bf16 v24, v117, v112
    v_mfma_f32_32x32x16_bf16 v[80:95], v[120:123], v[128:131], v[80:95]
    v_dot2c_f32_bf16 v24, v118, v112
    v_dot2c_f32_bf16 v24, v119, v112
    s_waitcnt vmcnt(8) lgkmcnt(0)
    s_barrier
    v_mfma_f32_32x32x16_bf16 v[32:47], v[132:135], v[140:143], v[32:47]
    ds_read_b64_tr_b16 v[116:117], v11 offset:16384
    ds_read_b64_tr_b16 v[118:119], v11 offset:17408
    ds_read_b128 v[124:127], v9 offset:0
    s_mul_i32 s30, s33, 110592
    s_add_u32 m0, s31, 57344
    s_add_u32 s33, s33, 1
    buffer_load_dwordx4 v3, s[12:15], s30 offen lds
    v_mfma_f32_32x32x16_bf16 v[48:63], v[132:135], v[144:147], v[48:63]
    ds_read_b64_tr_b16 v[120:121], v12 offset:16384
    ds_read_b64_tr_b16 v[122:123], v12 offset:17408
    ds_read_b128 v[128:131], v9 offset:4096
    s_add_u32 m0, s31, 58368
    s_cmp_eq_u32 s33, 20
    s_cselect_b32 s33, 0, s33
    buffer_load_dwordx4 v8, s[12:15], s30 offen lds
    v_mfma_f32_32x32x16_bf16 v[64:79], v[136:139], v[140:143], v[64:79]
    v_dot2c_f32_bf16 v24, v132, v112
    v_dot2c_f32_bf16 v24, v133, v112
    s_lshl_b32 s29, s34, 6
    s_add_u32 m0, s37, 32768
    s_add_u32 s34, s34, 2
    buffer_load_dwordx4 v2, s[8:11], s29 offen lds
    s_add_u32 m0, s37, 33792
    s_add_u32 s32, s29, 20480
    buffer_load_dwordx4 v7, s[8:11], s29 offen lds
    v_mfma_f32_32x32x16_bf16 v[80:95], v[136:139], v[144:147], v[80:95]
    v_dot2c_f32_bf16 v24, v134, v112
    v_dot2c_f32_bf16 v24, v135, v112
    s_add_u32 m0, s37, 34816
    s_cmp_eq_u32 s34, 20
    s_cselect_b32 s34, 0, s34
    buffer_load_dwordx4 v2, s[8:11], s32 offen lds
    s_add_u32 m0, s37, 35840
    s_nop 0
    buffer_load_dwordx4 v7, s[8:11], s32 offen lds
    s_waitcnt lgkmcnt(0)
    v_mfma_f32_32x32x16_bf16 v[32:47], v[116:119], v[124:127], v[32:47]
    ds_read_b64_tr_b16 v[132:133], v11 offset:20480
    ds_read_b64_tr_b16 v[134:135], v11 offset:21504
    ds_read_b128 v[140:143], v10 offset:0
    v_mfma_f32_32x32x16_bf16 v[48:63], v[116:119], v[128:131], v[48:63]
    ds_read_b64_tr_b16 v[136:137], v12 offset:20480
    ds_read_b64_tr_b16 v[138:139], v12 offset:21504
    ds_read_b128 v[144:147], v10 offset:4096
    v_mfma_f32_32x32x16_bf16 v[64:79], v[120:123], v[124:127], v[64:79]
    v_dot2c_f32_bf16 v24, v116, v112
    v_dot2c_f32_bf16 v24, v117, v112
    v_mfma_f32_32x32x16_bf16 v[80:95], v[120:123], v[128:131], v[80:95]
    v_dot2c_f32_bf16 v24, v118, v112
    v_dot2c_f32_bf16 v24, v119, v112
    s_waitcnt vmcnt(12) lgkmcnt(0)
    s_barrier
    v_mfma_f32_32x32x16_bf16 v[32:47], v[132:135], v[140:143], v[32:47]
    ds_read_b64_tr_b16 v[116:117], v11 offset:24576
    ds_read_b64_tr_b16 v[118:119], v11 offset:25600
    ds_read_b128 v[124:127], v25 offset:0
    s_mul_i32 s30, s33, 110592
    s_add_u32 m0, s31, 65536
    s_add_u32 s33, s33, 1
    buffer_load_dwordx4 v3, s[12:15], s30 offen lds
    v_mfma_f32_32x32x16_bf16 v[48:63], v[132:135], v[144:147], v[48:63]
    ds_read_b64_tr_b16 v[120:121], v12 offset:24576
    ds_read_b64_tr_b16 v[122:123], v12 offset:25600
    ds_read_b128 v[128:131], v25 offset:4096
    s_add_u32 m0, s31, 66560
    s_cmp_eq_u32 s33, 20
    s_cselect_b32 s33, 0, s33
    buffer_load_dwordx4 v8, s[12:15], s30 offen lds
    v_mfma_f32_32x32x16_bf16 v[64:79], v[136:139], v[140:143], v[64:79]
    v_dot2c_f32_bf16 v24, v132, v112
    v_dot2c_f32_bf16 v24, v133, v112
    v_mfma_f32_32x32x16_bf16 v[80:95], v[136:139], v[144:147], v[80:95]
    v_dot2c_f32_bf16 v24, v134, v112
    v_dot2c_f32_bf16 v24, v135, v112
    s_waitcnt lgkmcnt(0)
    v_mfma_f32_32x32x16_bf16 v[32:47], v[116:119], v[124:127], v[32:47]
    ds_read_b64_tr_b16 v[132:133], v11 offset:28672
    ds_read_b64_tr_b16 v[134:135], v11 offset:29696
    ds_read_b128 v[140:143], v26 offset:0
    v_mfma_f32_32x32x16_bf16 v[48:63], v[116:119], v[128:131], v[48:63]
    ds_read_b64_tr_b16 v[136:137], v12 offset:28672
    ds_read_b64_tr_b16 v[138:139], v12 offset:29696
    ds_read_b128 v[144:147], v26 offset:4096
    v_mfma_f32_32x32x16_bf16 v[64:79], v[120:123], v[124:127], v[64:79]
    v_dot2c_f32_bf16 v24, v116, v112
    v_dot2c_f32_bf16 v24, v117, v112
    v_mfma_f32_32x32x16_bf16 v[80:95], v[120:123], v[128:131], v[80:95]
    v_dot2c_f32_bf16 v24, v118, v112
    v_dot2c_f32_bf16 v24, v119, v112
    s_waitcnt vmcnt(8) lgkmcnt(0)
    s_barrier
    v_mfma_f32_32x32x16_bf16 v[32:47], v[132:135], v[140:143], v[32:47]
    ds_read_b64_tr_b16 v[116:117], v11 offset:0
    ds_read_b64_tr_b16 v[118:119], v11 offset:1024
    ds_read_b128 v[124:127], v9 offset:16384
    s_mul_i32 s30, s33, 110592
    s_add_u32 m0, s31, 73728
    s_add_u32 s33, s33, 1
    buffer_load_dwordx4 v3, s[12:15], s30 offen lds
    v_mfma_f32_32x32x16_bf16 v[48:63], v[132:135], v[144:147], v[48:63]
    ds_read_b64_tr_b16 v[120:121], v12 offset:0
    ds_read_b64_tr_b16 v[122:123], v12 offset:1024
    ds_read_b128 v[128:131], v9 offset:20480
    s_add_u32 m0, s31, 74752
    s_cmp_eq_u32 s33, 20
    s_cselect_b32 s33, 0, s33
    buffer_load_dwordx4 v8, s[12:15], s30 offen lds
    v_mfma_f32_32x32x16_bf16 v[64:79], v[136:139], v[140:143], v[64:79]
    v_dot2c_f32_bf16 v24, v132, v112
    v_dot2c_f32_bf16 v24, v133, v112
    s_lshl_b32 s29, s34, 6
    s_add_u32 m0, s37, 0
    s_add_u32 s34, s34, 2
    buffer_load_dwordx4 v2, s[8:11], s29 offen lds
    s_add_u32 m0, s37, 1024
    s_add_u32 s32, s29, 20480
    buffer_load_dwordx4 v7, s[8:11], s29 offen lds
    v_mfma_f32_32x32x16_bf16 v[80:95], v[136:139], v[144:147], v[80:95]
    v_dot2c_f32_bf16 v24, v134, v112
    v_dot2c_f32_bf16 v24, v135, v112
    s_add_u32 m0, s37, 2048
    s_cmp_eq_u32 s34, 20
    s_cselect_b32 s34, 0, s34
    buffer_load_dwordx4 v2, s[8:11], s32 offen lds
    s_add_u32 m0, s37, 3072
    s_nop 0
    buffer_load_dwordx4 v7, s[8:11], s32 offen lds
    s_waitcnt lgkmcnt(0)
    v_mfma_f32_32x32x16_bf16 v[32:47], v[116:119], v[124:127], v[32:47]
    ds_read_b64_tr_b16 v[132:133], v11 offset:4096
    ds_read_b64_tr_b16 v[134:135], v11 offset:5120
    ds_read_b128 v[140:143], v10 offset:16384
    v_mfma_f32_32x32x16_bf16 v[48:63], v[116:119], v[128:131], v[48:63]
    ds_read_b64_tr_b16 v[136:137], v12 offset:4096
    ds_read_b64_tr_b16 v[138:139], v12 offset:5120
    ds_read_b128 v[144:147], v10 offset:20480
    v_mfma_f32_32x32x16_bf16 v[64:79], v[120:123], v[124:127], v[64:79]
    v_dot2c_f32_bf16 v24, v116, v112
    v_dot2c_f32_bf16 v24, v117, v112
    v_mfma_f32_32x32x16_bf16 v[80:95], v[120:123], v[128:131], v[80:95]
    v_dot2c_f32_bf16 v24, v118, v112
    v_dot2c_f32_bf16 v24, v119, v112
    s_waitcnt vmcnt(12) lgkmcnt(0)
    s_barrier
    v_mfma_f32_32x32x16_bf16 v[32:47], v[132:135], v[140:143], v[32:47]
    ds_read_b64_tr_b16 v[116:117], v11 offset:8192
    ds_read_b64_tr_b16 v[118:119], v11 offset:9216
    ds_read_b128 v[124:127], v25 offset:16384
    s_mul_i32 s30, s33, 110592
    s_add_u32 m0, s31, 49152
    s_add_u32 s33, s33, 1
    buffer_load_dwordx4 v3, s[12:15], s30 offen lds
    v_mfma_f32_32x32x16_bf16 v[48:63], v[132:135], v[144:147], v[48:63]
    ds_read_b64_tr_b16 v[120:121], v12 offset:8192
    ds_read_b64_tr_b16 v[122:123], v12 offset:9216
    ds_read_b128 v[128:131], v25 offset:20480
    s_add_u32 m0, s31, 50176
    s_cmp_eq_u32 s33, 20
    s_cselect_b32 s33, 0, s33
    buffer_load_dwordx4 v8, s[12:15], s30 offen lds
    v_mfma_f32_32x32x16_bf16 v[64:79], v[136:139], v[140:143], v[64:79]
    v_dot2c_f32_bf16 v24, v132, v112
    v_dot2c_f32_bf16 v24, v133, v112
    v_mfma_f32_32x32x16_bf16 v[80:95], v[136:139], v[144:147], v[80:95]
    v_dot2c_f32_bf16 v24, v134, v112
    v_dot2c_f32_bf16 v24, v135, v112
    s_waitcnt lgkmcnt(0)
    v_mfma_f32_32x32x16_bf16 v[32:47], v[116:119], v[124:127], v[32:47]
    ds_read_b64_tr_b16 v[132:133], v11 offset:12288
    ds_read_b64_tr_b16 v[134:135], v11 offset:13312
    ds_read_b128 v[140:143], v26 offset:16384
    v_mfma_f32_32x32x16_bf16 v[48:63], v[116:119], v[128:131], v[48:63]
    ds_read_b64_tr_b16 v[136:137], v12 offset:12288
    ds_read_b64_tr_b16 v[138:139], v12 offset:13312
    ds_read_b128 v[144:147], v26 offset:20480
    v_mfma_f32_32x32x16_bf16 v[64:79], v[120:123], v[124:127], v[64:79]
    v_dot2c_f32_bf16 v24, v116, v112
    v_dot2c_f32_bf16 v24, v117, v112
    v_mfma_f32_32x32x16_bf16 v[80:95], v[120:123], v[128:131], v[80:95]
    v_dot2c_f32_bf16 v24, v118, v112
    v_dot2c_f32_bf16 v24, v119, v112
    s_waitcnt vmcnt(8) lgkmcnt(0)
    s_barrier
    v_mfma_f32_32x32x16_bf16 v[32:47], v[132:135], v[140:143], v[32:47]
    ds_read_b64_tr_b16 v[116:117], v11 offset:16384
    ds_read_b64_tr_b16 v[118:119], v11 offset:17408
    ds_read_b128 v[124:127], v9 offset:32768
    s_mul_i32 s30, s33, 110592
    s_add_u32 m0, s31, 57344
    s_add_u32 s33, s33, 1
    buffer_load_dwordx4 v3, s[12:15], s30 offen lds
    v_mfma_f32_32x32x16_bf16 v[48:63], v[132:135], v[144:147], v[48:63]
    ds_read_b64_tr_b16 v[120:121], v12 offset:16384
    ds_read_b64_tr_b16 v[122:123], v12 offset:17408
    ds_read_b128 v[128:131], v9 offset:36864
    s_add_u32 m0, s31, 58368
    s_cmp_eq_u32 s33, 20
    s_cselect_b32 s33, 0, s33
    buffer_load_dwordx4 v8, s[12:15], s30 offen lds
    v_mfma_f32_32x32x16_bf16 v[64:79], v[136:139], v[140:143], v[64:79]
    v_dot2c_f32_bf16 v24, v132, v112
    v_dot2c_f32_bf16 v24, v133, v112
    s_lshl_b32 s29, s34, 6
    s_add_u32 m0, s37, 16384
    s_add_u32 s34, s34, 2
    buffer_load_dwordx4 v2, s[8:11], s29 offen lds
    s_add_u32 m0, s37, 17408
    s_add_u32 s32, s29, 20480
    buffer_load_dwordx4 v7, s[8:11], s29 offen lds
    v_mfma_f32_32x32x16_bf16 v[80:95], v[136:139], v[144:147], v[80:95]
    v_dot2c_f32_bf16 v24, v134, v112
    v_dot2c_f32_bf16 v24, v135, v112
    s_add_u32 m0, s37, 18432
    s_cmp_eq_u32 s34, 20
    s_cselect_b32 s34, 0, s34
    buffer_load_dwordx4 v2, s[8:11], s32 offen lds
    s_add_u32 m0, s37, 19456
    s_nop 0
    buffer_load_dwordx4 v7, s[8:11], s32 offen lds
    buffer_load_dword v19, v18, s[84:87], 0 offen sc1
    s_waitcnt lgkmcnt(0)
    v_mfma_f32_32x32x16_bf16 v[32:47], v[116:119], v[124:127], v[32:47]
    ds_read_b64_tr_b16 v[132:133], v11 offset:20480
    ds_read_b64_tr_b16 v[134:135], v11 offset:21504
    ds_read_b128 v[140:143], v10 offset:32768
    v_mfma_f32_32x32x16_bf16 v[48:63], v[116:119], v[128:131], v[48:63]
    ds_read_b64_tr_b16 v[136:137], v12 offset:20480
    ds_read_b64_tr_b16 v[138:139], v12 offset:21504
    ds_read_b128 v[144:147], v10 offset:36864
    v_mfma_f32_32x32x16_bf16 v[64:79], v[120:123], v[124:127], v[64:79]
    v_dot2c_f32_bf16 v24, v116, v112
    v_dot2c_f32_bf16 v24, v117, v112
    v_mfma_f32_32x32x16_bf16 v[80:95], v[120:123], v[128:131], v[80:95]
    v_dot2c_f32_bf16 v24, v118, v112
    v_dot2c_f32_bf16 v24, v119, v112
    s_waitcnt vmcnt(13) lgkmcnt(0)
    s_barrier
    v_mfma_f32_32x32x16_bf16 v[32:47], v[132:135], v[140:143], v[32:47]
    ds_read_b64_tr_b16 v[116:117], v11 offset:24576
    ds_read_b64_tr_b16 v[118:119], v11 offset:25600
    ds_read_b128 v[124:127], v25 offset:32768
    s_mul_i32 s30, s33, 110592
    s_add_u32 m0, s31, 65536
    s_add_u32 s33, s33, 1
    buffer_load_dwordx4 v3, s[12:15], s30 offen lds
    v_mfma_f32_32x32x16_bf16 v[48:63], v[132:135], v[144:147], v[48:63]
    ds_read_b64_tr_b16 v[120:121], v12 offset:24576
    ds_read_b64_tr_b16 v[122:123], v12 offset:25600
    ds_read_b128 v[128:131], v25 offset:36864
    s_add_u32 m0, s31, 66560
    s_cmp_eq_u32 s33, 20
    s_cselect_b32 s33, 0, s33
    buffer_load_dwordx4 v8, s[12:15], s30 offen lds
    v_mfma_f32_32x32x16_bf16 v[64:79], v[136:139], v[140:143], v[64:79]
    v_dot2c_f32_bf16 v24, v132, v112
    v_dot2c_f32_bf16 v24, v133, v112
    v_mfma_f32_32x32x16_bf16 v[80:95], v[136:139], v[144:147], v[80:95]
    v_dot2c_f32_bf16 v24, v134, v112
    v_dot2c_f32_bf16 v24, v135, v112
    s_waitcnt lgkmcnt(0)
    v_mfma_f32_32x32x16_bf16 v[32:47], v[116:119], v[124:127], v[32:47]
    ds_read_b64_tr_b16 v[132:133], v11 offset:28672
    ds_read_b64_tr_b16 v[134:135], v11 offset:29696
    ds_read_b128 v[140:143], v26 offset:32768
    v_mfma_f32_32x32x16_bf16 v[48:63], v[116:119], v[128:131], v[48:63]
    ds_read_b64_tr_b16 v[136:137], v12 offset:28672
    ds_read_b64_tr_b16 v[138:139], v12 offset:29696
    ds_read_b128 v[144:147], v26 offset:36864
    v_mfma_f32_32x32x16_bf16 v[64:79], v[120:123], v[124:127], v[64:79]
    v_dot2c_f32_bf16 v24, v116, v112
    v_dot2c_f32_bf16 v24, v117, v112
    v_mfma_f32_32x32x16_bf16 v[80:95], v[120:123], v[128:131], v[80:95]
    v_dot2c_f32_bf16 v24, v118, v112
    v_dot2c_f32_bf16 v24, v119, v112
    s_waitcnt vmcnt(9) lgkmcnt(0)
    s_barrier
    v_mfma_f32_32x32x16_bf16 v[32:47], v[132:135], v[140:143], v[32:47]
    ds_read_b64_tr_b16 v[116:117], v11 offset:0
    ds_read_b64_tr_b16 v[118:119], v11 offset:1024
    ds_read_b128 v[124:127], v9 offset:0
    s_mul_i32 s30, s33, 110592
    s_add_u32 m0, s31, 73728
    s_add_u32 s33, s33, 1
    buffer_load_dwordx4 v3, s[12:15], s30 offen lds
    v_mfma_f32_32x32x16_bf16 v[48:63], v[132:135], v[144:147], v[48:63]
    ds_read_b64_tr_b16 v[120:121], v12 offset:0
    ds_read_b64_tr_b16 v[122:123], v12 offset:1024
    ds_read_b128 v[128:131], v9 offset:4096
    s_add_u32 m0, s31, 74752
    s_cmp_eq_u32 s33, 20
    s_cselect_b32 s33, 0, s33
    buffer_load_dwordx4 v8, s[12:15], s30 offen lds
    v_mfma_f32_32x32x16_bf16 v[64:79], v[136:139], v[140:143], v[64:79]
    v_dot2c_f32_bf16 v24, v132, v112
    v_dot2c_f32_bf16 v24, v133, v112
    s_lshl_b32 s29, s34, 6
    s_add_u32 m0, s37, 32768
    s_add_u32 s34, s34, 2
    buffer_load_dwordx4 v2, s[8:11], s29 offen lds
    s_add_u32 m0, s37, 33792
    s_add_u32 s32, s29, 20480
    buffer_load_dwordx4 v7, s[8:11], s29 offen lds
    v_mfma_f32_32x32x16_bf16 v[80:95], v[136:139], v[144:147], v[80:95]
    v_dot2c_f32_bf16 v24, v134, v112
    v_dot2c_f32_bf16 v24, v135, v112
    s_add_u32 m0, s37, 34816
    s_cmp_eq_u32 s34, 20
    s_cselect_b32 s34, 0, s34
    buffer_load_dwordx4 v2, s[8:11], s32 offen lds
    s_add_u32 m0, s37, 35840
    s_nop 0
    buffer_load_dwordx4 v7, s[8:11], s32 offen lds
    s_waitcnt lgkmcnt(0)
    v_mfma_f32_32x32x16_bf16 v[32:47], v[116:119], v[124:127], v[32:47]
    ds_read_b64_tr_b16 v[132:133], v11 offset:4096
    ds_read_b64_tr_b16 v[134:135], v11 offset:5120
    ds_read_b128 v[140:143], v10 offset:0
    v_mfma_f32_32x32x16_bf16 v[48:63], v[116:119], v[128:131], v[48:63]
    ds_read_b64_tr_b16 v[136:137], v12 offset:4096
    ds_read_b64_tr_b16 v[138:139], v12 offset:5120
    ds_read_b128 v[144:147], v10 offset:4096
    v_mfma_f32_32x32x16_bf16 v[64:79], v[120:123], v[124:127], v[64:79]
    v_dot2c_f32_bf16 v24, v116, v112
    v_dot2c_f32_bf16 v24, v117, v112
    v_mfma_f32_32x32x16_bf16 v[80:95], v[120:123], v[128:131], v[80:95]
    v_dot2c_f32_bf16 v24, v118, v112
    v_dot2c_f32_bf16 v24, v119, v112
    s_waitcnt vmcnt(13) lgkmcnt(0)
    s_barrier
    v_mfma_f32_32x32x16_bf16 v[32:47], v[132:135], v[140:143], v[32:47]
    ds_read_b64_tr_b16 v[116:117], v11 offset:8192
    ds_read_b64_tr_b16 v[118:119], v11 offset:9216
    ds_read_b128 v[124:127], v25 offset:0
    s_mul_i32 s30, s33, 110592
    s_add_u32 m0, s31, 49152
    s_add_u32 s33, s33, 1
    buffer_load_dwordx4 v3, s[12:15], s30 offen lds
    v_mfma_f32_32x32x16_bf16 v[48:63], v[132:135], v[144:147], v[48:63]
    ds_read_b64_tr_b16 v[120:121], v12 offset:8192
    ds_read_b64_tr_b16 v[122:123], v12 offset:9216
    ds_read_b128 v[128:131], v25 offset:4096
    s_add_u32 m0, s31, 50176
    s_cmp_eq_u32 s33, 20
    s_cselect_b32 s33, 0, s33
    buffer_load_dwordx4 v8, s[12:15], s30 offen lds
    v_mfma_f32_32x32x16_bf16 v[64:79], v[136:139], v[140:143], v[64:79]
    v_dot2c_f32_bf16 v24, v132, v112
    v_dot2c_f32_bf16 v24, v133, v112
    v_mfma_f32_32x32x16_bf16 v[80:95], v[136:139], v[144:147], v[80:95]
    v_dot2c_f32_bf16 v24, v134, v112
    v_dot2c_f32_bf16 v24, v135, v112
    s_waitcnt lgkmcnt(0)
    v_mfma_f32_32x32x16_bf16 v[32:47], v[116:119], v[124:127], v[32:47]
    ds_read_b64_tr_b16 v[132:133], v11 offset:12288
    ds_read_b64_tr_b16 v[134:135], v11 offset:13312
    ds_read_b128 v[140:143], v26 offset:0
    v_mfma_f32_32x32x16_bf16 v[48:63], v[116:119], v[128:131], v[48:63]
    ds_read_b64_tr_b16 v[136:137], v12 offset:12288
    ds_read_b64_tr_b16 v[138:139], v12 offset:13312
    ds_read_b128 v[144:147], v26 offset:4096
    v_mfma_f32_32x32x16_bf16 v[64:79], v[120:123], v[124:127], v[64:79]
    v_dot2c_f32_bf16 v24, v116, v112
    v_dot2c_f32_bf16 v24, v117, v112
    v_mfma_f32_32x32x16_bf16 v[80:95], v[120:123], v[128:131], v[80:95]
    v_dot2c_f32_bf16 v24, v118, v112
    v_dot2c_f32_bf16 v24, v119, v112
    s_waitcnt vmcnt(8) lgkmcnt(0)
    s_barrier
    s_mov_b32 s62, 0
L_g1tag_1:
    v_readfirstlane_b32 s61, v19
    s_nop 0
    s_cmp_lg_u32 s61, 0
    s_cbranch_scc1 L_g1tagged_2
    buffer_load_dword v19, v18, s[84:87], 0 offen sc1
    s_waitcnt vmcnt(0)
    s_sleep 24
    s_add_u32 s62, s62, 1
    s_cmp_lt_u32 s62, 32768
    s_cbranch_scc1 L_g1tag_1
L_g1tagged_2:
    v_mfma_f32_32x32x16_bf16 v[32:47], v[132:135], v[140:143], v[32:47]
    ds_read_b64_tr_b16 v[116:117], v11 offset:16384
    ds_read_b64_tr_b16 v[118:119], v11 offset:17408
    ds_read_b128 v[124:127], v9 offset:16384
    s_mul_i32 s30, s33, 110592
    s_add_u32 m0, s31, 57344
    s_add_u32 s33, s33, 1
    buffer_load_dwordx4 v3, s[12:15], s30 offen lds
    v_mfma_f32_32x32x16_bf16 v[48:63], v[132:135], v[144:147], v[48:63]
    ds_read_b64_tr_b16 v[120:121], v12 offset:16384
    ds_read_b64_tr_b16 v[122:123], v12 offset:17408
    ds_read_b128 v[128:131], v9 offset:20480
    s_add_u32 m0, s31, 58368
    s_cmp_eq_u32 s33, 20
    s_cselect_b32 s33, 0, s33
    buffer_load_dwordx4 v8, s[12:15], s30 offen lds
    v_mfma_f32_32x32x16_bf16 v[64:79], v[136:139], v[140:143], v[64:79]
    v_dot2c_f32_bf16 v24, v132, v112
    v_dot2c_f32_bf16 v24, v133, v112
    s_lshl_b32 s29, s34, 6
    s_add_u32 m0, s37, 0
    s_add_u32 s34, s34, 2
    buffer_load_dwordx4 v2, s[8:11], s29 offen lds
    s_add_u32 m0, s37, 1024
    s_add_u32 s32, s29, 20480
    buffer_load_dwordx4 v7, s[8:11], s29 offen lds
    v_mfma_f32_32x32x16_bf16 v[80:95], v[136:139], v[144:147], v[80:95]
    v_dot2c_f32_bf16 v24, v134, v112
    v_dot2c_f32_bf16 v24, v135, v112
    s_add_u32 m0, s37, 2048
    s_cmp_eq_u32 s34, 20
    s_cselect_b32 s34, 0, s34
    buffer_load_dwordx4 v2, s[8:11], s32 offen lds
    s_add_u32 m0, s37, 3072
    s_nop 0
    buffer_load_dwordx4 v7, s[8:11], s32 offen lds
    buffer_load_dword v19, v20, s[80:83], 0 offen sc1
    s_waitcnt lgkmcnt(0)
    v_mfma_f32_32x32x16_bf16 v[32:47], v[116:119], v[124:127], v[32:47]
    ds_read_b64_tr_b16 v[132:133], v11 offset:20480
    ds_read_b64_tr_b16 v[134:135], v11 offset:21504
    ds_read_b128 v[140:143], v10 offset:16384
    v_mfma_f32_32x32x16_bf16 v[48:63], v[116:119], v[128:131], v[48:63]
    ds_read_b64_tr_b16 v[136:137], v12 offset:20480
    ds_read_b64_tr_b16 v[138:139], v12 offset:21504
    ds_read_b128 v[144:147], v10 offset:20480
    v_mfma_f32_32x32x16_bf16 v[64:79], v[120:123], v[124:127], v[64:79]
    v_dot2c_f32_bf16 v24, v116, v112
    v_dot2c_f32_bf16 v24, v117, v112
    v_mfma_f32_32x32x16_bf16 v[80:95], v[120:123], v[128:131], v[80:95]
    v_dot2c_f32_bf16 v24, v118, v112
    v_dot2c_f32_bf16 v24, v119, v112
    s_waitcnt vmcnt(13) lgkmcnt(0)
    s_barrier
    v_mfma_f32_32x32x16_bf16 v[32:47], v[132:135], v[140:143], v[32:47]
    ds_read_b64_tr_b16 v[116:117], v11 offset:24576
    ds_read_b64_tr_b16 v[118:119], v11 offset:25600
    ds_read_b128 v[124:127], v25 offset:16384
    s_mul_i32 s30, s33, 110592
    s_add_u32 m0, s31, 65536
    s_add_u32 s33, s33, 1
    buffer_load_dwordx4 v3, s[12:15], s30 offen lds
    v_mfma_f32_32x32x16_bf16 v[48:63], v[132:135], v[144:147], v[48:63]
    ds_read_b64_tr_b16 v[120:121], v12 offset:24576
    ds_read_b64_tr_b16 v[122:123], v12 offset:25600
    ds_read_b128 v[128:131], v25 offset:20480
    s_add_u32 m0, s31, 66560
    s_cmp_eq_u32 s33, 20
    s_cselect_b32 s33, 0, s33
    buffer_load_dwordx4 v8, s[12:15], s30 offen lds
    v_mfma_f32_32x32x16_bf16 v[64:79], v[136:139], v[140:143], v[64:79]
    v_dot2c_f32_bf16 v24, v132, v112
    v_dot2c_f32_bf16 v24, v133, v112
    v_mfma_f32_32x32x16_bf16 v[80:95], v[136:139], v[144:147], v[80:95]
    v_dot2c_f32_bf16 v24, v134, v112
    v_dot2c_f32_bf16 v24, v135, v112
    s_waitcnt lgkmcnt(0)
    v_mfma_f32_32x32x16_bf16 v[32:47], v[116:119], v[124:127], v[32:47]
    ds_read_b64_tr_b16 v[132:133], v11 offset:28672
    ds_read_b64_tr_b16 v[134:135], v11 offset:29696
    ds_read_b128 v[140:143], v26 offset:16384
    v_mfma_f32_32x32x16_bf16 v[48:63], v[116:119], v[128:131], v[48:63]
    ds_read_b64_tr_b16 v[136:137], v12 offset:28672
    ds_read_b64_tr_b16 v[138:139], v12 offset:29696
    ds_read_b128 v[144:147], v26 offset:20480
    v_mfma_f32_32x32x16_bf16 v[64:79], v[120:123], v[124:127], v[64:79]
    v_dot2c_f32_bf16 v24, v116, v112
    v_dot2c_f32_bf16 v24, v117, v112
    v_mfma_f32_32x32x16_bf16 v[80:95], v[120:123], v[128:131], v[80:95]
    v_dot2c_f32_bf16 v24, v118, v112
    v_dot2c_f32_bf16 v24, v119, v112
    s_waitcnt vmcnt(9) lgkmcnt(0)
    s_barrier
    v_mfma_f32_32x32x16_bf16 v[32:47], v[132:135], v[140:143], v[32:47]
    ds_read_b64_tr_b16 v[116:117], v11 offset:0
    ds_read_b64_tr_b16 v[118:119], v11 offset:1024
    ds_read_b128 v[124:127], v9 offset:32768
    s_mul_i32 s30, s33, 110592
    s_add_u32 m0, s31, 73728
    s_add_u32 s33, s33, 1
    buffer_load_dwordx4 v3, s[12:15], s30 offen lds
    v_mfma_f32_32x32x16_bf16 v[48:63], v[132:135], v[144:147], v[48:63]
    ds_read_b64_tr_b16 v[120:121], v12 offset:0
    ds_read_b64_tr_b16 v[122:123], v12 offset:1024
    ds_read_b128 v[128:131], v9 offset:36864
    s_add_u32 m0, s31, 74752
    s_cmp_eq_u32 s33, 20
    s_cselect_b32 s33, 0, s33
    buffer_load_dwordx4 v8, s[12:15], s30 offen lds
    v_mfma_f32_32x32x16_bf16 v[64:79], v[136:139], v[140:143], v[64:79]
    v_dot2c_f32_bf16 v24, v132, v112
    v_dot2c_f32_bf16 v24, v133, v112
    v_mfma_f32_32x32x16_bf16 v[80:95], v[136:139], v[144:147], v[80:95]
    v_dot2c_f32_bf16 v24, v134, v112
    v_dot2c_f32_bf16 v24, v135, v112
    s_waitcnt lgkmcnt(0)
    v_mfma_f32_32x32x16_bf16 v[32:47], v[116:119], v[124:127], v[32:47]
    ds_read_b64_tr_b16 v[132:133], v11 offset:4096
    ds_read_b64_tr_b16 v[134:135], v11 offset:5120
    ds_read_b128 v[140:143], v10 offset:32768
    v_mfma_f32_32x32x16_bf16 v[48:63], v[116:119], v[128:131], v[48:63]
    ds_read_b64_tr_b16 v[136:137], v12 offset:4096
    ds_read_b64_tr_b16 v[138:139], v12 offset:5120
    ds_read_b128 v[144:147], v10 offset:36864
    v_mfma_f32_32x32x16_bf16 v[64:79], v[120:123], v[124:127], v[64:79]
    v_dot2c_f32_bf16 v24, v116, v112
    v_dot2c_f32_bf16 v24, v117, v112
    v_mfma_f32_32x32x16_bf16 v[80:95], v[120:123], v[128:131], v[80:95]
    v_dot2c_f32_bf16 v24, v118, v112
    v_dot2c_f32_bf16 v24, v119, v112
    s_waitcnt vmcnt(9) lgkmcnt(0)
    s_barrier
    v_mfma_f32_32x32x16_bf16 v[32:47], v[132:135], v[140:143], v[32:47]
    ds_read_b64_tr_b16 v[116:117], v11 offset:8192
    ds_read_b64_tr_b16 v[118:119], v11 offset:9216
    ds_read_b128 v[124:127], v25 offset:32768
    v_mfma_f32_32x32x16_bf16 v[48:63], v[132:135], v[144:147], v[48:63]
    ds_read_b64_tr_b16 v[120:121], v12 offset:8192
    ds_read_b64_tr_b16 v[122:123], v12 offset:9216
    ds_read_b128 v[128:131], v25 offset:36864
    v_mfma_f32_32x32x16_bf16 v[64:79], v[136:139], v[140:143], v[64:79]
    v_dot2c_f32_bf16 v24, v132, v112
    v_dot2c_f32_bf16 v24, v133, v112
    v_mfma_f32_32x32x16_bf16 v[80:95], v[136:139], v[144:147], v[80:95]
    v_dot2c_f32_bf16 v24, v134, v112
    v_dot2c_f32_bf16 v24, v135, v112
    s_waitcnt lgkmcnt(0)
    v_mfma_f32_32x32x16_bf16 v[32:47], v[116:119], v[124:127], v[32:47]
    ds_read_b64_tr_b16 v[132:133], v11 offset:12288
    ds_read_b64_tr_b16 v[134:135], v11 offset:13312
    ds_read_b128 v[140:143], v26 offset:32768
    v_mfma_f32_32x32x16_bf16 v[48:63], v[116:119], v[128:131], v[48:63]
    ds_read_b64_tr_b16 v[136:137], v12 offset:12288
    ds_read_b64_tr_b16 v[138:139], v12 offset:13312
    ds_read_b128 v[144:147], v26 offset:36864
    v_mfma_f32_32x32x16_bf16 v[64:79], v[120:123], v[124:127], v[64:79]
    v_dot2c_f32_bf16 v24, v116, v112
    v_dot2c_f32_bf16 v24, v117, v112
    v_mfma_f32_32x32x16_bf16 v[80:95], v[120:123], v[128:131], v[80:95]
    v_dot2c_f32_bf16 v24, v118, v112
    v_dot2c_f32_bf16 v24, v119, v112
    s_waitcnt vmcnt(2) lgkmcnt(0)
    s_barrier
    s_waitcnt vmcnt(4)
    s_mov_b32 s62, 0
L_g1fl_3:
    v_cmp_ne_u32 vcc, s61, v19
    s_nop 0
    s_cmp_eq_u64 vcc, 0
    s_cbranch_scc1 L_g1fld_4
    buffer_load_dword v19, v20, s[80:83], 0 offen sc1
    s_waitcnt vmcnt(0)
    s_sleep 24
    s_add_u32 s62, s62, 1
    s_cmp_lt_u32 s62, 32768
    s_cbranch_scc1 L_g1fl_3
L_g1fld_4:
    v_mfma_f32_32x32x16_bf16 v[32:47], v[132:135], v[140:143], v[32:47]
    ds_read_b64_tr_b16 v[116:117], v11 offset:16384
    ds_read_b64_tr_b16 v[118:119], v11 offset:17408
    ds_read_b128 v[124:127], v9 offset:0
    v_mfma_f32_32x32x16_bf16 v[48:63], v[132:135], v[144:147], v[48:63]
    ds_read_b64_tr_b16 v[120:121], v12 offset:16384
    ds_read_b64_tr_b16 v[122:123], v12 offset:17408
    ds_read_b128 v[128:131], v9 offset:4096
    v_mfma_f32_32x32x16_bf16 v[64:79], v[136:139], v[140:143], v[64:79]
    v_dot2c_f32_bf16 v24, v132, v112
    v_dot2c_f32_bf16 v24, v133, v112
    v_mfma_f32_32x32x16_bf16 v[80:95], v[136:139], v[144:147], v[80:95]
    v_dot2c_f32_bf16 v24, v134, v112
    v_dot2c_f32_bf16 v24, v135, v112
    buffer_load_dwordx2 v[152:153], v21, s[16:19], 0 offen sc1
    buffer_load_dwordx2 v[154:155], v21, s[16:19], 0 offen offset:256 sc1
    s_waitcnt lgkmcnt(0)
    v_mfma_f32_32x32x16_bf16 v[32:47], v[116:119], v[124:127], v[32:47]
    ds_read_b64_tr_b16 v[132:133], v11 offset:20480
    ds_read_b64_tr_b16 v[134:135], v11 offset:21504
    ds_read_b128 v[140:143], v10 offset:0
    v_mfma_f32_32x32x16_bf16 v[48:63], v[116:119], v[128:131], v[48:63]
    ds_read_b64_tr_b16 v[136:137], v12 offset:20480
    ds_read_b64_tr_b16 v[138:139], v12 offset:21504
    ds_read_b128 v[144:147], v10 offset:4096
    v_mfma_f32_32x32x16_bf16 v[64:79], v[120:123], v[124:127], v[64:79]
    v_dot2c_f32_bf16 v24, v116, v112
    v_dot2c_f32_bf16 v24, v117, v112
    v_mfma_f32_32x32x16_bf16 v[80:95], v[120:123], v[128:131], v[80:95]
    v_dot2c_f32_bf16 v24, v118, v112
    v_dot2c_f32_bf16 v24, v119, v112
    s_waitcnt vmcnt(2) lgkmcnt(0)
    s_barrier
    v_mfma_f32_32x32x16_bf16 v[32:47], v[132:135], v[140:143], v[32:47]
    ds_read_b64_tr_b16 v[116:117], v11 offset:24576
    ds_read_b64_tr_b16 v[118:119], v11 offset:25600
    ds_read_b128 v[124:127], v25 offset:0
    v_mfma_f32_32x32x16_bf16 v[48:63], v[132:135], v[144:147], v[48:63]
    ds_read_b64_tr_b16 v[120:121], v12 offset:24576
    ds_read_b64_tr_b16 v[122:123], v12 offset:25600
    ds_read_b128 v[128:131], v25 offset:4096
    v_mfma_f32_32x32x16_bf16 v[64:79], v[136:139], v[140:143], v[64:79]
    v_dot2c_f32_bf16 v24, v132, v112
    v_dot2c_f32_bf16 v24, v133, v112
    v_mfma_f32_32x32x16_bf16 v[80:95], v[136:139], v[144:147], v[80:95]
    v_dot2c_f32_bf16 v24, v134, v112
    v_dot2c_f32_bf16 v24, v135, v112
    s_waitcnt lgkmcnt(0)
    v_mfma_f32_32x32x16_bf16 v[32:47], v[116:119], v[124:127], v[32:47]
    ds_read_b64_tr_b16 v[132:133], v11 offset:28672
    ds_read_b64_tr_b16 v[134:135], v11 offset:29696
    ds_read_b128 v[140:143], v26 offset:0
    v_mfma_f32_32x32x16_bf16 v[48:63], v[116:119], v[128:131], v[48:63]
    ds_read_b64_tr_b16 v[136:137], v12 offset:28672
    ds_read_b64_tr_b16 v[138:139], v12 offset:29696
    ds_read_b128 v[144:147], v26 offset:4096
    v_mfma_f32_32x32x16_bf16 v[64:79], v[120:123], v[124:127], v[64:79]
    v_dot2c_f32_bf16 v24, v116, v112
    v_dot2c_f32_bf16 v24, v117, v112
    v_mfma_f32_32x32x16_bf16 v[80:95], v[120:123], v[128:131], v[80:95]
    v_dot2c_f32_bf16 v24, v118, v112
    v_dot2c_f32_bf16 v24, v119, v112
    s_waitcnt lgkmcnt(0)
    v_mfma_f32_32x32x16_bf16 v[32:47], v[132:135], v[140:143], v[32:47]
    v_dot2c_f32_bf16 v24, v132, v112
    v_dot2c_f32_bf16 v24, v133, v112
    v_mfma_f32_32x32x16_bf16 v[48:63], v[132:135], v[144:147], v[48:63]
    v_dot2c_f32_bf16 v24, v134, v112
    v_dot2c_f32_bf16 v24, v135, v112
    v_mfma_f32_32x32x16_bf16 v[64:79], v[136:139], v[140:143], v[64:79]
    v_mfma_f32_32x32x16_bf16 v[80:95], v[136:139], v[144:147], v[80:95]
    v_and_b32 v5, 31, v1
    s_lshl_b32 s5, s24, 7
    s_lshl_b32 s6, s28, 6
    s_add_u32 s5, s5, s6
    v_add_u32 v5, s5, v5
    s_barrier
    v_mov_b32 v4, v24
    s_nop 1
    v_permlane32_swap_b32 v4, v24
    v_add_f32 v24, v24, v4
    s_lshl_b32 s5, s4, 7
    v_and_b32 v4, 31, v1
    v_lshlrev_b32 v4, 2, v4
    v_add_u32 v4, s5, v4
    ds_write_b32 v4, v24
    v_lshrrev_b32 v6, 4, v5
    v_and_b32 v6, 3, v6
    v_lshlrev_b32 v156, 10, v6
    v_and_b32 v6, 15, v5
    v_lshl_add_u32 v156, v6, 4, v156
    v_lshl_add_u32 v156, v13, 9, v156
    s_lshl_b32 s5, s24, 1
    s_add_u32 s5, s5, s28
    s_mul_i32 s5, s5, 54
    s_lshl_b32 s6, s25, 2
    s_add_u32 s5, s5, s6
    s_lshl_b32 s6, s27, 1
    s_add_u32 s5, s5, s6
    s_lshl_b32 s5, s5, 12
    s_lshl_b32 s32, s28, 12
    s_add_u32 s33, s5, s32
    s_xor_b32 s32, s32, 4096
    s_add_u32 s34, s5, s32
    s_waitcnt lgkmcnt(0)
    s_barrier
    s_xor_b32 s5, s4, 1
    s_lshl_b32 s5, s5, 7
    v_lshlrev_b32 v4, 4, v13
    v_add_u32 v4, s5, v4
    ds_read_b128 v[120:123], v4 offset:0
    ds_read_b128 v[124:127], v4 offset:32
    ds_read_b128 v[128:131], v4 offset:64
    ds_read_b128 v[132:135], v4 offset:96
    s_lshl_b32 s5, s4, 7
    v_lshlrev_b32 v6, 4, v13
    v_add_u32 v6, s5, v6
    ds_read_b128 v[96:99], v6 offset:0
    ds_read_b128 v[100:103], v6 offset:32
    ds_read_b128 v[104:107], v6 offset:64
    ds_read_b128 v[108:111], v6 offset:96
    s_lshl_b32 s6, s25, 1
    s_add_u32 s6, s6, s27
    s_waitcnt vmcnt(0) lgkmcnt(0)
    s_cmp_ge_u32 s6, 27
    s_cbranch_scc1 L_g1_end_k_3
    v_xor_b32 v208, 0x80000000, v152
    v_mov_b32 v209, v208
    v_mov_b32 v210, v153
    v_mov_b32 v211, v153
    v_mul_f32 v212, 0xbfb8aa3b, v153
    v_mov_b32 v213, v212
    v_xor_b32 v214, 0x80000000, v154
    v_mov_b32 v215, v214
    v_mov_b32 v216, v155
    v_mov_b32 v217, v155
    v_mul_f32 v218, 0xbfb8aa3b, v155
    v_mov_b32 v219, v218
    v_mov_b32 v220, 1.0
    v_mov_b32 v221, 1.0
    v_pk_fma_f32 v[160:161], v[208:209], v[96:97], v[32:33]
    v_pk_fma_f32 v[162:163], v[208:209], v[98:99], v[34:35]
    v_pk_fma_f32 v[164:165], v[208:209], v[100:101], v[36:37]
    v_pk_fma_f32 v[166:167], v[208:209], v[102:103], v[38:39]
    v_pk_fma_f32 v[168:169], v[208:209], v[104:105], v[40:41]
    v_pk_fma_f32 v[170:171], v[208:209], v[106:107], v[42:43]
    v_pk_fma_f32 v[172:173], v[208:209], v[108:109], v[44:45]
    v_pk_fma_f32 v[174:175], v[208:209], v[110:111], v[46:47]
    v_pk_mul_f32 v[176:177], v[160:161], v[212:213]
    v_pk_mul_f32 v[178:179], v[162:163], v[212:213]
    v_pk_mul_f32 v[180:181], v[164:165], v[212:213]
    v_pk_mul_f32 v[182:183], v[166:167], v[212:213]
    v_pk_mul_f32 v[184:185], v[168:169], v[212:213]
    v_pk_mul_f32 v[186:187], v[170:171], v[212:213]
    v_pk_mul_f32 v[188:189], v[172:173], v[212:213]
    v_pk_mul_f32 v[190:191], v[174:175], v[212:213]
    v_exp_f32 v176, v176
    v_exp_f32 v177, v177
    v_pk_mul_f32 v[160:161], v[160:161], v[210:211]
    v_exp_f32 v178, v178
    v_exp_f32 v179, v179
    v_pk_mul_f32 v[162:163], v[162:163], v[210:211]
    v_exp_f32 v180, v180
    v_exp_f32 v181, v181
    v_pk_mul_f32 v[164:165], v[164:165], v[210:211]
    v_exp_f32 v182, v182
    v_exp_f32 v183, v183
    v_pk_mul_f32 v[166:167], v[166:167], v[210:211]
    v_exp_f32 v184, v184
    v_exp_f32 v185, v185
    v_pk_mul_f32 v[168:169], v[168:169], v[210:211]
    v_exp_f32 v186, v186
    v_exp_f32 v187, v187
    v_pk_mul_f32 v[170:171], v[170:171], v[210:211]
    v_exp_f32 v188, v188
    v_exp_f32 v189, v189
    v_pk_mul_f32 v[172:173], v[172:173], v[210:211]
    v_exp_f32 v190, v190
    v_exp_f32 v191, v191
    v_pk_mul_f32 v[174:175], v[174:175], v[210:211]
    v_pk_add_f32 v[176:177], v[176:177], v[220:221]
    v_pk_add_f32 v[178:179], v[178:179], v[220:221]
    v_pk_add_f32 v[180:181], v[180:181], v[220:221]
    v_pk_add_f32 v[182:183], v[182:183], v[220:221]
    v_pk_add_f32 v[184:185], v[184:185], v[220:221]
    v_pk_add_f32 v[186:187], v[186:187], v[220:221]
    v_pk_add_f32 v[188:189], v[188:189], v[220:221]
    v_pk_add_f32 v[190:191], v[190:191], v[220:221]
    v_rcp_f32 v176, v176
    v_rcp_f32 v177, v177
    v_rcp_f32 v178, v178
    v_rcp_f32 v179, v179
    v_rcp_f32 v180, v180
    v_rcp_f32 v181, v181
    v_rcp_f32 v182, v182
    v_rcp_f32 v183, v183
    v_rcp_f32 v184, v184
    v_rcp_f32 v185, v185
    v_rcp_f32 v186, v186
    v_rcp_f32 v187, v187
    v_rcp_f32 v188, v188
    v_rcp_f32 v189, v189
    v_rcp_f32 v190, v190
    v_rcp_f32 v191, v191
    v_pk_mul_f32 v[160:161], v[160:161], v[176:177]
    v_pk_mul_f32 v[162:163], v[162:163], v[178:179]
    v_pk_mul_f32 v[164:165], v[164:165], v[180:181]
    v_pk_mul_f32 v[166:167], v[166:167], v[182:183]
    v_pk_mul_f32 v[168:169], v[168:169], v[184:185]
    v_pk_mul_f32 v[170:171], v[170:171], v[186:187]
    v_pk_mul_f32 v[172:173], v[172:173], v[188:189]
    v_pk_mul_f32 v[174:175], v[174:175], v[190:191]
    v_cvt_pk_bf16_f32 v192, v160, v161
    v_cvt_pk_bf16_f32 v193, v162, v163
    v_cvt_pk_bf16_f32 v194, v164, v165
    v_cvt_pk_bf16_f32 v195, v166, v167
    v_cvt_pk_bf16_f32 v196, v168, v169
    v_cvt_pk_bf16_f32 v197, v170, v171
    v_cvt_pk_bf16_f32 v198, v172, v173
    v_cvt_pk_bf16_f32 v199, v174, v175
    s_add_u32 s7, s33, 0
    buffer_store_dwordx4 v[192:195], v156, s[20:23], s7 offen offset:0 sc1
    buffer_store_dwordx4 v[196:199], v156, s[20:23], s7 offen offset:256 sc1
    v_pk_fma_f32 v[160:161], v[214:215], v[96:97], v[48:49]
    v_pk_fma_f32 v[162:163], v[214:215], v[98:99], v[50:51]
    v_pk_fma_f32 v[164:165], v[214:215], v[100:101], v[52:53]
    v_pk_fma_f32 v[166:167], v[214:215], v[102:103], v[54:55]
    v_pk_fma_f32 v[168:169], v[214:215], v[104:105], v[56:57]
    v_pk_fma_f32 v[170:171], v[214:215], v[106:107], v[58:59]
    v_pk_fma_f32 v[172:173], v[214:215], v[108:109], v[60:61]
    v_pk_fma_f32 v[174:175], v[214:215], v[110:111], v[62:63]
    v_pk_mul_f32 v[176:177], v[160:161], v[218:219]
    v_pk_mul_f32 v[178:179], v[162:163], v[218:219]
    v_pk_mul_f32 v[180:181], v[164:165], v[218:219]
    v_pk_mul_f32 v[182:183], v[166:167], v[218:219]
    v_pk_mul_f32 v[184:185], v[168:169], v[218:219]
    v_pk_mul_f32 v[186:187], v[170:171], v[218:219]
    v_pk_mul_f32 v[188:189], v[172:173], v[218:219]
    v_pk_mul_f32 v[190:191], v[174:175], v[218:219]
    v_exp_f32 v176, v176
    v_exp_f32 v177, v177
    v_pk_mul_f32 v[160:161], v[160:161], v[216:217]
    v_exp_f32 v178, v178
    v_exp_f32 v179, v179
    v_pk_mul_f32 v[162:163], v[162:163], v[216:217]
    v_exp_f32 v180, v180
    v_exp_f32 v181, v181
    v_pk_mul_f32 v[164:165], v[164:165], v[216:217]
    v_exp_f32 v182, v182
    v_exp_f32 v183, v183
    v_pk_mul_f32 v[166:167], v[166:167], v[216:217]
    v_exp_f32 v184, v184
    v_exp_f32 v185, v185
    v_pk_mul_f32 v[168:169], v[168:169], v[216:217]
    v_exp_f32 v186, v186
    v_exp_f32 v187, v187
    v_pk_mul_f32 v[170:171], v[170:171], v[216:217]
    v_exp_f32 v188, v188
    v_exp_f32 v189, v189
    v_pk_mul_f32 v[172:173], v[172:173], v[216:217]
    v_exp_f32 v190, v190
    v_exp_f32 v191, v191
    v_pk_mul_f32 v[174:175], v[174:175], v[216:217]
    v_pk_add_f32 v[176:177], v[176:177], v[220:221]
    v_pk_add_f32 v[178:179], v[178:179], v[220:221]
    v_pk_add_f32 v[180:181], v[180:181], v[220:221]
    v_pk_add_f32 v[182:183], v[182:183], v[220:221]
    v_pk_add_f32 v[184:185], v[184:185], v[220:221]
    v_pk_add_f32 v[186:187], v[186:187], v[220:221]
    v_pk_add_f32 v[188:189], v[188:189], v[220:221]
    v_pk_add_f32 v[190:191], v[190:191], v[220:221]
    v_rcp_f32 v176, v176
    v_rcp_f32 v177, v177
    v_rcp_f32 v178, v178
    v_rcp_f32 v179, v179
    v_rcp_f32 v180, v180
    v_rcp_f32 v181, v181
    v_rcp_f32 v182, v182
    v_rcp_f32 v183, v183
    v_rcp_f32 v184, v184
    v_rcp_f32 v185, v185
    v_rcp_f32 v186, v186
    v_rcp_f32 v187, v187
    v_rcp_f32 v188, v188
    v_rcp_f32 v189, v189
    v_rcp_f32 v190, v190
    v_rcp_f32 v191, v191
    v_pk_mul_f32 v[160:161], v[160:161], v[176:177]
    v_pk_mul_f32 v[162:163], v[162:163], v[178:179]
    v_pk_mul_f32 v[164:165], v[164:165], v[180:181]
    v_pk_mul_f32 v[166:167], v[166:167], v[182:183]
    v_pk_mul_f32 v[168:169], v[168:169], v[184:185]
    v_pk_mul_f32 v[170:171], v[170:171], v[186:187]
    v_pk_mul_f32 v[172:173], v[172:173], v[188:189]
    v_pk_mul_f32 v[174:175], v[174:175], v[190:191]
    v_cvt_pk_bf16_f32 v200, v160, v161
    v_cvt_pk_bf16_f32 v201, v162, v163
    v_cvt_pk_bf16_f32 v202, v164, v165
    v_cvt_pk_bf16_f32 v203, v166, v167
    v_cvt_pk_bf16_f32 v204, v168, v169
    v_cvt_pk_bf16_f32 v205, v170, v171
    v_cvt_pk_bf16_f32 v206, v172, v173
    v_cvt_pk_bf16_f32 v207, v174, v175
    s_add_u32 s7, s33, 2048
    buffer_store_dwordx4 v[200:203], v156, s[20:23], s7 offen offset:0 sc1
    buffer_store_dwordx4 v[204:207], v156, s[20:23], s7 offen offset:256 sc1
    v_pk_fma_f32 v[160:161], v[208:209], v[120:121], v[64:65]
    v_pk_fma_f32 v[162:163], v[208:209], v[122:123], v[66:67]
    v_pk_fma_f32 v[164:165], v[208:209], v[124:125], v[68:69]
    v_pk_fma_f32 v[166:167], v[208:209], v[126:127], v[70:71]
    v_pk_fma_f32 v[168:169], v[208:209], v[128:129], v[72:73]
    v_pk_fma_f32 v[170:171], v[208:209], v[130:131], v[74:75]
    v_pk_fma_f32 v[172:173], v[208:209], v[132:133], v[76:77]
    v_pk_fma_f32 v[174:175], v[208:209], v[134:135], v[78:79]
    v_pk_mul_f32 v[176:177], v[160:161], v[212:213]
    v_pk_mul_f32 v[178:179], v[162:163], v[212:213]
    v_pk_mul_f32 v[180:181], v[164:165], v[212:213]
    v_pk_mul_f32 v[182:183], v[166:167], v[212:213]
    v_pk_mul_f32 v[184:185], v[168:169], v[212:213]
    v_pk_mul_f32 v[186:187], v[170:171], v[212:213]
    v_pk_mul_f32 v[188:189], v[172:173], v[212:213]
    v_pk_mul_f32 v[190:191], v[174:175], v[212:213]
    v_exp_f32 v176, v176
    v_exp_f32 v177, v177
    v_pk_mul_f32 v[160:161], v[160:161], v[210:211]
    v_exp_f32 v178, v178
    v_exp_f32 v179, v179
    v_pk_mul_f32 v[162:163], v[162:163], v[210:211]
    v_exp_f32 v180, v180
    v_exp_f32 v181, v181
    v_pk_mul_f32 v[164:165], v[164:165], v[210:211]
    v_exp_f32 v182, v182
    v_exp_f32 v183, v183
    v_pk_mul_f32 v[166:167], v[166:167], v[210:211]
    v_exp_f32 v184, v184
    v_exp_f32 v185, v185
    v_pk_mul_f32 v[168:169], v[168:169], v[210:211]
    v_exp_f32 v186, v186
    v_exp_f32 v187, v187
    v_pk_mul_f32 v[170:171], v[170:171], v[210:211]
    v_exp_f32 v188, v188
    v_exp_f32 v189, v189
    v_pk_mul_f32 v[172:173], v[172:173], v[210:211]
    v_exp_f32 v190, v190
    v_exp_f32 v191, v191
    v_pk_mul_f32 v[174:175], v[174:175], v[210:211]
    v_pk_add_f32 v[176:177], v[176:177], v[220:221]
    v_pk_add_f32 v[178:179], v[178:179], v[220:221]
    v_pk_add_f32 v[180:181], v[180:181], v[220:221]
    v_pk_add_f32 v[182:183], v[182:183], v[220:221]
    v_pk_add_f32 v[184:185], v[184:185], v[220:221]
    v_pk_add_f32 v[186:187], v[186:187], v[220:221]
    v_pk_add_f32 v[188:189], v[188:189], v[220:221]
    v_pk_add_f32 v[190:191], v[190:191], v[220:221]
    v_rcp_f32 v176, v176
    v_rcp_f32 v177, v177
    v_rcp_f32 v178, v178
    v_rcp_f32 v179, v179
    v_rcp_f32 v180, v180
    v_rcp_f32 v181, v181
    v_rcp_f32 v182, v182
    v_rcp_f32 v183, v183
    v_rcp_f32 v184, v184
    v_rcp_f32 v185, v185
    v_rcp_f32 v186, v186
    v_rcp_f32 v187, v187
    v_rcp_f32 v188, v188
    v_rcp_f32 v189, v189
    v_rcp_f32 v190, v190
    v_rcp_f32 v191, v191
    v_pk_mul_f32 v[160:161], v[160:161], v[176:177]
    v_pk_mul_f32 v[162:163], v[162:163], v[178:179]
    v_pk_mul_f32 v[164:165], v[164:165], v[180:181]
    v_pk_mul_f32 v[166:167], v[166:167], v[182:183]
    v_pk_mul_f32 v[168:169], v[168:169], v[184:185]
    v_pk_mul_f32 v[170:171], v[170:171], v[186:187]
    v_pk_mul_f32 v[172:173], v[172:173], v[188:189]
    v_pk_mul_f32 v[174:175], v[174:175], v[190:191]
    v_cvt_pk_bf16_f32 v192, v160, v161
    v_cvt_pk_bf16_f32 v193, v162, v163
    v_cvt_pk_bf16_f32 v194, v164, v165
    v_cvt_pk_bf16_f32 v195, v166, v167
    v_cvt_pk_bf16_f32 v196, v168, v169
    v_cvt_pk_bf16_f32 v197, v170, v171
    v_cvt_pk_bf16_f32 v198, v172, v173
    v_cvt_pk_bf16_f32 v199, v174, v175
    s_add_u32 s7, s34, 0
    buffer_store_dwordx4 v[192:195], v156, s[20:23], s7 offen offset:0 sc1
    buffer_store_dwordx4 v[196:199], v156, s[20:23], s7 offen offset:256 sc1
    v_pk_fma_f32 v[160:161], v[214:215], v[120:121], v[80:81]
    v_pk_fma_f32 v[162:163], v[214:215], v[122:123], v[82:83]
    v_pk_fma_f32 v[164:165], v[214:215], v[124:125], v[84:85]
    v_pk_fma_f32 v[166:167], v[214:215], v[126:127], v[86:87]
    v_pk_fma_f32 v[168:169], v[214:215], v[128:129], v[88:89]
    v_pk_fma_f32 v[170:171], v[214:215], v[130:131], v[90:91]
    v_pk_fma_f32 v[172:173], v[214:215], v[132:133], v[92:93]
    v_pk_fma_f32 v[174:175], v[214:215], v[134:135], v[94:95]
    v_pk_mul_f32 v[176:177], v[160:161], v[218:219]
    v_pk_mul_f32 v[178:179], v[162:163], v[218:219]
    v_pk_mul_f32 v[180:181], v[164:165], v[218:219]
    v_pk_mul_f32 v[182:183], v[166:167], v[218:219]
    v_pk_mul_f32 v[184:185], v[168:169], v[218:219]
    v_pk_mul_f32 v[186:187], v[170:171], v[218:219]
    v_pk_mul_f32 v[188:189], v[172:173], v[218:219]
    v_pk_mul_f32 v[190:191], v[174:175], v[218:219]
    v_exp_f32 v176, v176
    v_exp_f32 v177, v177
    v_pk_mul_f32 v[160:161], v[160:161], v[216:217]
    v_exp_f32 v178, v178
    v_exp_f32 v179, v179
    v_pk_mul_f32 v[162:163], v[162:163], v[216:217]
    v_exp_f32 v180, v180
    v_exp_f32 v181, v181
    v_pk_mul_f32 v[164:165], v[164:165], v[216:217]
    v_exp_f32 v182, v182
    v_exp_f32 v183, v183
    v_pk_mul_f32 v[166:167], v[166:167], v[216:217]
    v_exp_f32 v184, v184
    v_exp_f32 v185, v185
    v_pk_mul_f32 v[168:169], v[168:169], v[216:217]
    v_exp_f32 v186, v186
    v_exp_f32 v187, v187
    v_pk_mul_f32 v[170:171], v[170:171], v[216:217]
    v_exp_f32 v188, v188
    v_exp_f32 v189, v189
    v_pk_mul_f32 v[172:173], v[172:173], v[216:217]
    v_exp_f32 v190, v190
    v_exp_f32 v191, v191
    v_pk_mul_f32 v[174:175], v[174:175], v[216:217]
    v_pk_add_f32 v[176:177], v[176:177], v[220:221]
    v_pk_add_f32 v[178:179], v[178:179], v[220:221]
    v_pk_add_f32 v[180:181], v[180:181], v[220:221]
    v_pk_add_f32 v[182:183], v[182:183], v[220:221]
    v_pk_add_f32 v[184:185], v[184:185], v[220:221]
    v_pk_add_f32 v[186:187], v[186:187], v[220:221]
    v_pk_add_f32 v[188:189], v[188:189], v[220:221]
    v_pk_add_f32 v[190:191], v[190:191], v[220:221]
    v_rcp_f32 v176, v176
    v_rcp_f32 v177, v177
    v_rcp_f32 v178, v178
    v_rcp_f32 v179, v179
    v_rcp_f32 v180, v180
    v_rcp_f32 v181, v181
    v_rcp_f32 v182, v182
    v_rcp_f32 v183, v183
    v_rcp_f32 v184, v184
    v_rcp_f32 v185, v185
    v_rcp_f32 v186, v186
    v_rcp_f32 v187, v187
    v_rcp_f32 v188, v188
    v_rcp_f32 v189, v189
    v_rcp_f32 v190, v190
    v_rcp_f32 v191, v191
    v_pk_mul_f32 v[160:161], v[160:161], v[176:177]
    v_pk_mul_f32 v[162:163], v[162:163], v[178:179]
    v_pk_mul_f32 v[164:165], v[164:165], v[180:181]
    v_pk_mul_f32 v[166:167], v[166:167], v[182:183]
    v_pk_mul_f32 v[168:169], v[168:169], v[184:185]
    v_pk_mul_f32 v[170:171], v[170:171], v[186:187]
    v_pk_mul_f32 v[172:173], v[172:173], v[188:189]
    v_pk_mul_f32 v[174:175], v[174:175], v[190:191]
    v_cvt_pk_bf16_f32 v200, v160, v161
    v_cvt_pk_bf16_f32 v201, v162, v163
    v_cvt_pk_bf16_f32 v202, v164, v165
    v_cvt_pk_bf16_f32 v203, v166, v167
    v_cvt_pk_bf16_f32 v204, v168, v169
    v_cvt_pk_bf16_f32 v205, v170, v171
    v_cvt_pk_bf16_f32 v206, v172, v173
    v_cvt_pk_bf16_f32 v207, v174, v175
    s_add_u32 s7, s34, 2048
    buffer_store_dwordx4 v[200:203], v156, s[20:23], s7 offen offset:0 sc1
    buffer_store_dwordx4 v[204:207], v156, s[20:23], s7 offen offset:256 sc1
L_g1_end_k_3:
    s_mov_b32 s63, 1
L_gemm2_entry:
    s_sub_u32 s3, s2, 256
    s_setprio 0
    s_load_dwordx2 s[40:41], s[0:1], 96
    s_load_dwordx2 s[42:43], s[0:1], 0
    s_load_dwordx2 s[44:45], s[0:1], 80
    v_and_b32 v1, 63, v0
    v_lshrrev_b32 v2, 6, v0
    s_nop 0
    v_readfirstlane_b32 s4, v2
    s_and_b32 s5, s3, 7
    s_lshr_b32 s6, s3, 3
    s_lshr_b32 s7, s5, 1
    s_lshl_b32 s28, s7, 3
    s_and_b32 s7, s6, 7
    s_add_u32 s28, s28, s7
    s_and_b32 s5, s5, 1
    s_lshl_b32 s29, s5, 2
    s_lshr_b32 s7, s6, 3
    s_add_u32 s29, s29, s7
    s_mul_i32 s30, s28, 221184
    s_mul_i32 s31, s29, 276480
    v_lshlrev_b32 v2, 4, v1
    v_add_u32 v3, 4096, v2
    s_add_u32 s5, s4, 0
    s_and_b32 s5, s5, 3
    s_lshl_b32 s5, s5, 10
    v_add_u32 v240, s5, v2
    s_add_u32 s5, s4, 1
    s_and_b32 s5, s5, 3
    s_lshl_b32 s5, s5, 10
    v_add_u32 v241, s5, v2
    s_add_u32 s5, s4, 2
    s_and_b32 s5, s5, 3
    s_lshl_b32 s5, s5, 10
    v_add_u32 v242, s5, v2
    s_add_u32 s5, s4, 3
    s_and_b32 s5, s5, 3
    s_lshl_b32 s5, s5, 10
    v_add_u32 v243, s5, v2
    s_mul_i32 s32, s4, 57344
    s_mul_i32 s33, s4, 71680
    s_waitcnt lgkmcnt(0)
    s_add_u32 s8, s40, 0x300000
    s_addc_u32 s9, s41, 0
    s_add_u32 s8, s8, s30
    s_addc_u32 s9, s9, 0
    s_mov_b32 s10, 0x36000
    s_mov_b32 s11, 0x00020000
    s_add_u32 s12, s40, 0xa00000
    s_addc_u32 s13, s41, 0
    s_add_u32 s12, s12, s31
    s_addc_u32 s13, s13, 0
    s_mov_b32 s14, 0x43800
    s_mov_b32 s15, 0x00020000
    s_cmp_eq_u32 s63, 0
    s_cbranch_scc1 L_g2_nosig_5
    s_waitcnt vmcnt(0)
    s_barrier
    s_cmp_lg_u32 s4, 0
    s_cbranch_scc1 L_g2_nosig_5
    s_mul_i32 s5, s24, 14
    s_add_u32 s5, s5, s25
    s_add_u32 s5, s5, 288
    s_lshl_b32 s60, s5, 7
    v_mov_b32 v8, 0
    v_mov_b32 v9, s61
    s_mov_b64 exec, 1
    buffer_store_dword v9, v8, s[80:83], s60 offen sc1
    s_mov_b64 exec, -1
L_g2_nosig_5:
    s_cmp_lg_u32 s4, 0
    s_cbranch_scc1 L_g2_nopoll_6
    s_lshr_b32 s5, s28, 1
    s_mul_i32 s5, s5, 14
    s_add_u32 s5, s5, 288
    v_min_u32 v10, 13, v1
    v_add_u32 v10, s5, v10
    s_mul_i32 s5, s29, 27
    s_add_u32 s5, s5, 64
    v_subrev_u32 v11, 32, v1
    v_min_u32 v11, 26, v11
    v_add_u32 v11, s5, v11
    v_cmp_le_u32 vcc, 32, v1
    s_nop 1
    v_cndmask_b32 v10, v10, v11, vcc
    v_lshlrev_b32 v10, 7, v10
    s_mov_b32 s62, 0
L_hw_7:
    buffer_load_dword v8, v10, s[80:83], 0 offen sc1
    s_waitcnt vmcnt(0)
    v_cmp_ne_u32 vcc, s61, v8
    s_nop 0
    s_cmp_eq_u64 vcc, 0
    s_cbranch_scc1 L_hwd_8
    s_and_b32 s5, vcc_lo, 0x3fff
    s_cmp_lg_u32 s5, 0x3fff
    s_cbranch_scc1 L_hws_9
    s_sleep 20
L_hws_9:
    s_sleep 4
    s_add_u32 s62, s62, 1
    s_cmp_lt_u32 s62, 32768
    s_cbranch_scc1 L_hw_7
L_hwd_8:
L_g2_nopoll_6:
    s_barrier
    buffer_load_dwordx4 v[96:99], v240, s[8:11], s32 offen sc1
    buffer_load_dwordx4 v[100:103], v241, s[8:11], s32 offen sc1
    buffer_load_dwordx4 v[104:107], v242, s[8:11], s32 offen sc1
    buffer_load_dwordx4 v[108:111], v243, s[8:11], s32 offen sc1
    s_add_u32 s32, s32, 4096
    buffer_load_dwordx4 v[112:115], v2, s[12:15], s33 offen offset:0 sc1
    buffer_load_dwordx4 v[116:119], v2, s[12:15], s33 offen offset:1024 sc1
    buffer_load_dwordx4 v[120:123], v2, s[12:15], s33 offen offset:2048 sc1
    buffer_load_dwordx4 v[124:127], v2, s[12:15], s33 offen offset:3072 sc1
    buffer_load_dwordx4 v[128:131], v3, s[12:15], s33 offen sc1
    s_add_u32 s33, s33, 5120
    s_add_u32 s16, s40, 0x1000000
    s_addc_u32 s17, s41, 0
    s_mov_b32 s18, 0x280000
    s_mov_b32 s19, 0x00020000
    s_mov_b32 s20, s42
    s_mov_b32 s21, s43
    s_mov_b32 s22, 0x280000
    s_mov_b32 s23, 0x00020000
    s_mov_b32 s24, s44
    s_mov_b32 s25, s45
    s_mov_b32 s26, 0x280000
    s_mov_b32 s27, 0x00020000
    v_add_u32 v4, 0, v0
    v_mul_u32_u24 v5, 6554, v4
    v_lshrrev_b32 v5, 16, v5
    v_mul_u32_u24 v6, 10, v5
    v_sub_u32 v6, v4, v6
    v_mul_u32_u24 v220, 176, v5
    v_lshl_add_u32 v220, v6, 4, v220
    s_lshl_b32 s5, s28, 6
    v_add_u32 v5, s5, v5
    v_mul_u32_u24 v216, 1280, v5
    v_lshl_add_u32 v216, v6, 4, v216
    s_mul_i32 s5, s29, 160
    v_add_u32 v216, s5, v216
    v_add_u32 v4, 256, v0
    v_mul_u32_u24 v5, 6554, v4
    v_lshrrev_b32 v5, 16, v5
    v_mul_u32_u24 v6, 10, v5
    v_sub_u32 v6, v4, v6
    v_mul_u32_u24 v221, 176, v5
    v_lshl_add_u32 v221, v6, 4, v221
    s_lshl_b32 s5, s28, 6
    v_add_u32 v5, s5, v5
    v_mul_u32_u24 v217, 1280, v5
    v_lshl_add_u32 v217, v6, 4, v217
    s_mul_i32 s5, s29, 160
    v_add_u32 v217, s5, v217
    v_add_u32 v4, 512, v0
    v_mul_u32_u24 v5, 6554, v4
    v_lshrrev_b32 v5, 16, v5
    v_mul_u32_u24 v6, 10, v5
    v_sub_u32 v6, v4, v6
    v_mul_u32_u24 v222, 176, v5
    v_lshl_add_u32 v222, v6, 4, v222
    s_lshl_b32 s5, s28, 6
    v_add_u32 v5, s5, v5
    v_mul_u32_u24 v218, 1280, v5
    v_lshl_add_u32 v218, v6, 4, v218
    s_mul_i32 s5, s29, 160
    v_add_u32 v218, s5, v218
    v_cmp_gt_u32 vcc, 640, v4
    v_mov_b32 v6, 0x7f000000
    s_nop 0
    v_cndmask_b32 v218, v6, v218, vcc
    v_mov_b32 v6, 0
    v_cndmask_b32 v222, v6, v222, vcc
    v_and_b32 v4, 15, v1
    s_mul_i32 s5, s29, 80
    v_add_u32 v4, s5, v4
    v_lshlrev_b32 v4, 12, v4
    v_lshrrev_b32 v5, 4, v1
    v_lshl_add_u32 v224, v5, 3, v4
    s_lshl_b32 s34, s28, 7
    s_lshl_b32 s6, s4, 5
    s_add_u32 s34, s34, s6
    v_lshlrev_b32 v5, 2, v5
    s_lshl_b32 s5, s4, 4
    v_add_u32 v5, s5, v5
    v_mul_u32_u24 v225, 176, v5
    v_and_b32 v4, 15, v1
    v_lshl_add_u32 v225, v4, 1, v225
    v_add_u32 v225, 61440, v225
    s_add_u32 s5, s4, 1
    s_and_b32 s5, s5, 3
    s_mul_i32 s5, s5, 15360
    s_add_u32 s5, s5, 0
    v_add_u32 v244, s5, v2
    s_add_u32 s5, s4, 2
    s_and_b32 s5, s5, 3
    s_mul_i32 s5, s5, 15360
    s_add_u32 s5, s5, 5120
    v_add_u32 v245, s5, v2
    s_add_u32 s5, s4, 3
    s_and_b32 s5, s5, 3
    s_mul_i32 s5, s5, 15360
    s_add_u32 s5, s5, 10240
    v_add_u32 v246, s5, v2
    s_mul_i32 s5, s4, 15360
    v_add_u32 v7, s5, v2
    s_mul_i32 s35, s29, 28
    s_add_u32 s35, s35, 512
    v_min_u32 v237, 27, v1
    v_add_u32 v237, s35, v237
    v_lshlrev_b32 v237, 7, v237
    buffer_load_dwordx4 v[132:135], v240, s[8:11], s32 offen sc1
    buffer_load_dwordx4 v[136:139], v241, s[8:11], s32 offen sc1
    buffer_load_dwordx4 v[140:143], v242, s[8:11], s32 offen sc1
    buffer_load_dwordx4 v[144:147], v243, s[8:11], s32 offen sc1
    s_add_u32 s32, s32, 4096
    buffer_load_dwordx4 v[148:151], v2, s[12:15], s33 offen offset:0 sc1
    buffer_load_dwordx4 v[152:155], v2, s[12:15], s33 offen offset:1024 sc1
    buffer_load_dwordx4 v[156:159], v2, s[12:15], s33 offen offset:2048 sc1
    buffer_load_dwordx4 v[160:163], v2, s[12:15], s33 offen offset:3072 sc1
    buffer_load_dwordx4 v[164:167], v3, s[12:15], s33 offen sc1
    s_add_u32 s33, s33, 5120
    s_waitcnt vmcnt(9)
    v_mfma_f32_16x16x32_bf16 v[16:19], v[96:99], v[112:115], 0
    v_mfma_f32_16x16x32_bf16 v[20:23], v[96:99], v[116:119], 0
    v_mfma_f32_16x16x32_bf16 v[24:27], v[96:99], v[120:123], 0
    v_mfma_f32_16x16x32_bf16 v[28:31], v[96:99], v[124:127], 0
    v_mfma_f32_16x16x32_bf16 v[32:35], v[96:99], v[128:131], 0
    v_mfma_f32_16x16x32_bf16 v[36:39], v[100:103], v[112:115], 0
    v_mfma_f32_16x16x32_bf16 v[40:43], v[100:103], v[116:119], 0
    v_mfma_f32_16x16x32_bf16 v[44:47], v[100:103], v[120:123], 0
    v_mfma_f32_16x16x32_bf16 v[48:51], v[100:103], v[124:127], 0
    v_mfma_f32_16x16x32_bf16 v[52:55], v[100:103], v[128:131], 0
    v_mfma_f32_16x16x32_bf16 v[56:59], v[104:107], v[112:115], 0
    v_mfma_f32_16x16x32_bf16 v[60:63], v[104:107], v[116:119], 0
    v_mfma_f32_16x16x32_bf16 v[64:67], v[104:107], v[120:123], 0
    v_mfma_f32_16x16x32_bf16 v[68:71], v[104:107], v[124:127], 0
    v_mfma_f32_16x16x32_bf16 v[72:75], v[104:107], v[128:131], 0
    v_mfma_f32_16x16x32_bf16 v[76:79], v[108:111], v[112:115], 0
    v_mfma_f32_16x16x32_bf16 v[80:83], v[108:111], v[116:119], 0
    v_mfma_f32_16x16x32_bf16 v[84:87], v[108:111], v[120:123], 0
    v_mfma_f32_16x16x32_bf16 v[88:91], v[108:111], v[124:127], 0
    v_mfma_f32_16x16x32_bf16 v[92:95], v[108:111], v[128:131], 0
    buffer_load_dwordx4 v[96:99], v240, s[8:11], s32 offen sc1
    buffer_load_dwordx4 v[100:103], v241, s[8:11], s32 offen sc1
    buffer_load_dwordx4 v[104:107], v242, s[8:11], s32 offen sc1
    buffer_load_dwordx4 v[108:111], v243, s[8:11], s32 offen sc1
    s_add_u32 s32, s32, 4096
    buffer_load_dwordx4 v[112:115], v2, s[12:15], s33 offen offset:0 sc1
    buffer_load_dwordx4 v[116:119], v2, s[12:15], s33 offen offset:1024 sc1
    buffer_load_dwordx4 v[120:123], v2, s[12:15], s33 offen offset:2048 sc1
    buffer_load_dwordx4 v[124:127], v2, s[12:15], s33 offen offset:3072 sc1
    buffer_load_dwordx4 v[128:131], v3, s[12:15], s33 offen sc1
    s_add_u32 s33, s33, 5120
    s_waitcnt vmcnt(9)
    v_mfma_f32_16x16x32_bf16 v[16:19], v[132:135], v[148:151], v[16:19]
    v_mfma_f32_16x16x32_bf16 v[20:23], v[132:135], v[152:155], v[20:23]
    v_mfma_f32_16x16x32_bf16 v[24:27], v[132:135], v[156:159], v[24:27]
    v_mfma_f32_16x16x32_bf16 v[28:31], v[132:135], v[160:163], v[28:31]
    v_mfma_f32_16x16x32_bf16 v[32:35], v[132:135], v[164:167], v[32:35]
    v_mfma_f32_16x16x32_bf16 v[36:39], v[136:139], v[148:151], v[36:39]
    v_mfma_f32_16x16x32_bf16 v[40:43], v[136:139], v[152:155], v[40:43]
    v_mfma_f32_16x16x32_bf16 v[44:47], v[136:139], v[156:159], v[44:47]
    v_mfma_f32_16x16x32_bf16 v[48:51], v[136:139], v[160:163], v[48:51]
    v_mfma_f32_16x16x32_bf16 v[52:55], v[136:139], v[164:167], v[52:55]
    v_mfma_f32_16x16x32_bf16 v[56:59], v[140:143], v[148:151], v[56:59]
    v_mfma_f32_16x16x32_bf16 v[60:63], v[140:143], v[152:155], v[60:63]
    v_mfma_f32_16x16x32_bf16 v[64:67], v[140:143], v[156:159], v[64:67]
    v_mfma_f32_16x16x32_bf16 v[68:71], v[140:143], v[160:163], v[68:71]
    v_mfma_f32_16x16x32_bf16 v[72:75], v[140:143], v[164:167], v[72:75]
    v_mfma_f32_16x16x32_bf16 v[76:79], v[144:147], v[148:151], v[76:79]
    v_mfma_f32_16x16x32_bf16 v[80:83], v[144:147], v[152:155], v[80:83]
    v_mfma_f32_16x16x32_bf16 v[84:87], v[144:147], v[156:159], v[84:87]
    v_mfma_f32_16x16x32_bf16 v[88:91], v[144:147], v[160:163], v[88:91]
    v_mfma_f32_16x16x32_bf16 v[92:95], v[144:147], v[164:167], v[92:95]
    buffer_load_dwordx4 v[132:135], v240, s[8:11], s32 offen sc1
    buffer_load_dwordx4 v[136:139], v241, s[8:11], s32 offen sc1
    buffer_load_dwordx4 v[140:143], v242, s[8:11], s32 offen sc1
    buffer_load_dwordx4 v[144:147], v243, s[8:11], s32 offen sc1
    s_add_u32 s32, s32, 4096
    buffer_load_dwordx4 v[148:151], v2, s[12:15], s33 offen offset:0 sc1
    buffer_load_dwordx4 v[152:155], v2, s[12:15], s33 offen offset:1024 sc1
    buffer_load_dwordx4 v[156:159], v2, s[12:15], s33 offen offset:2048 sc1
    buffer_load_dwordx4 v[160:163], v2, s[12:15], s33 offen offset:3072 sc1
    buffer_load_dwordx4 v[164:167], v3, s[12:15], s33 offen sc1
    s_add_u32 s33, s33, 5120
    s_waitcnt vmcnt(9)
    v_mfma_f32_16x16x32_bf16 v[16:19], v[96:99], v[112:115], v[16:19]
    v_mfma_f32_16x16x32_bf16 v[20:23], v[96:99], v[116:119], v[20:23]
    v_mfma_f32_16x16x32_bf16 v[24:27], v[96:99], v[120:123], v[24:27]
    v_mfma_f32_16x16x32_bf16 v[28:31], v[96:99], v[124:127], v[28:31]
    v_mfma_f32_16x16x32_bf16 v[32:35], v[96:99], v[128:131], v[32:35]
    v_mfma_f32_16x16x32_bf16 v[36:39], v[100:103], v[112:115], v[36:39]
    v_mfma_f32_16x16x32_bf16 v[40:43], v[100:103], v[116:119], v[40:43]
    v_mfma_f32_16x16x32_bf16 v[44:47], v[100:103], v[120:123], v[44:47]
    v_mfma_f32_16x16x32_bf16 v[48:51], v[100:103], v[124:127], v[48:51]
    v_mfma_f32_16x16x32_bf16 v[52:55], v[100:103], v[128:131], v[52:55]
    v_mfma_f32_16x16x32_bf16 v[56:59], v[104:107], v[112:115], v[56:59]
    v_mfma_f32_16x16x32_bf16 v[60:63], v[104:107], v[116:119], v[60:63]
    v_mfma_f32_16x16x32_bf16 v[64:67], v[104:107], v[120:123], v[64:67]
    v_mfma_f32_16x16x32_bf16 v[68:71], v[104:107], v[124:127], v[68:71]
    v_mfma_f32_16x16x32_bf16 v[72:75], v[104:107], v[128:131], v[72:75]
    v_mfma_f32_16x16x32_bf16 v[76:79], v[108:111], v[112:115], v[76:79]
    v_mfma_f32_16x16x32_bf16 v[80:83], v[108:111], v[116:119], v[80:83]
    v_mfma_f32_16x16x32_bf16 v[84:87], v[108:111], v[120:123], v[84:87]
    v_mfma_f32_16x16x32_bf16 v[88:91], v[108:111], v[124:127], v[88:91]
    v_mfma_f32_16x16x32_bf16 v[92:95], v[108:111], v[128:131], v[92:95]
    buffer_load_dwordx4 v[96:99], v240, s[8:11], s32 offen sc1
    buffer_load_dwordx4 v[100:103], v241, s[8:11], s32 offen sc1
    buffer_load_dwordx4 v[104:107], v242, s[8:11], s32 offen sc1
    buffer_load_dwordx4 v[108:111], v243, s[8:11], s32 offen sc1
    s_add_u32 s32, s32, 4096
    buffer_load_dwordx4 v[112:115], v2, s[12:15], s33 offen offset:0 sc1
    buffer_load_dwordx4 v[116:119], v2, s[12:15], s33 offen offset:1024 sc1
    buffer_load_dwordx4 v[120:123], v2, s[12:15], s33 offen offset:2048 sc1
    buffer_load_dwordx4 v[124:127], v2, s[12:15], s33 offen offset:3072 sc1
    buffer_load_dwordx4 v[128:131], v3, s[12:15], s33 offen sc1
    s_add_u32 s33, s33, 5120
    s_waitcnt vmcnt(9)
    v_mfma_f32_16x16x32_bf16 v[16:19], v[132:135], v[148:151], v[16:19]
    v_mfma_f32_16x16x32_bf16 v[20:23], v[132:135], v[152:155], v[20:23]
    v_mfma_f32_16x16x32_bf16 v[24:27], v[132:135], v[156:159], v[24:27]
    v_mfma_f32_16x16x32_bf16 v[28:31], v[132:135], v[160:163], v[28:31]
    v_mfma_f32_16x16x32_bf16 v[32:35], v[132:135], v[164:167], v[32:35]
    v_mfma_f32_16x16x32_bf16 v[36:39], v[136:139], v[148:151], v[36:39]
    v_mfma_f32_16x16x32_bf16 v[40:43], v[136:139], v[152:155], v[40:43]
    v_mfma_f32_16x16x32_bf16 v[44:47], v[136:139], v[156:159], v[44:47]
    v_mfma_f32_16x16x32_bf16 v[48:51], v[136:139], v[160:163], v[48:51]
    v_mfma_f32_16x16x32_bf16 v[52:55], v[136:139], v[164:167], v[52:55]
    v_mfma_f32_16x16x32_bf16 v[56:59], v[140:143], v[148:151], v[56:59]
    v_mfma_f32_16x16x32_bf16 v[60:63], v[140:143], v[152:155], v[60:63]
    v_mfma_f32_16x16x32_bf16 v[64:67], v[140:143], v[156:159], v[64:67]
    v_mfma_f32_16x16x32_bf16 v[68:71], v[140:143], v[160:163], v[68:71]
    v_mfma_f32_16x16x32_bf16 v[72:75], v[140:143], v[164:167], v[72:75]
    v_mfma_f32_16x16x32_bf16 v[76:79], v[144:147], v[148:151], v[76:79]
    v_mfma_f32_16x16x32_bf16 v[80:83], v[144:147], v[152:155], v[80:83]
    v_mfma_f32_16x16x32_bf16 v[84:87], v[144:147], v[156:159], v[84:87]
    v_mfma_f32_16x16x32_bf16 v[88:91], v[144:147], v[160:163], v[88:91]
    v_mfma_f32_16x16x32_bf16 v[92:95], v[144:147], v[164:167], v[92:95]
    buffer_load_dwordx4 v[132:135], v240, s[8:11], s32 offen sc1
    buffer_load_dwordx4 v[136:139], v241, s[8:11], s32 offen sc1
    buffer_load_dwordx4 v[140:143], v242, s[8:11], s32 offen sc1
    buffer_load_dwordx4 v[144:147], v243, s[8:11], s32 offen sc1
    s_add_u32 s32, s32, 4096
    buffer_load_dwordx4 v[148:151], v2, s[12:15], s33 offen offset:0 sc1
    buffer_load_dwordx4 v[152:155], v2, s[12:15], s33 offen offset:1024 sc1
    buffer_load_dwordx4 v[156:159], v2, s[12:15], s33 offen offset:2048 sc1
    buffer_load_dwordx4 v[160:163], v2, s[12:15], s33 offen offset:3072 sc1
    buffer_load_dwordx4 v[164:167], v3, s[12:15], s33 offen sc1
    s_add_u32 s33, s33, 5120
    s_waitcnt vmcnt(9)
    v_mfma_f32_16x16x32_bf16 v[16:19], v[96:99], v[112:115], v[16:19]
    v_mfma_f32_16x16x32_bf16 v[20:23], v[96:99], v[116:119], v[20:23]
    v_mfma_f32_16x16x32_bf16 v[24:27], v[96:99], v[120:123], v[24:27]
    v_mfma_f32_16x16x32_bf16 v[28:31], v[96:99], v[124:127], v[28:31]
    v_mfma_f32_16x16x32_bf16 v[32:35], v[96:99], v[128:131], v[32:35]
    v_mfma_f32_16x16x32_bf16 v[36:39], v[100:103], v[112:115], v[36:39]
    v_mfma_f32_16x16x32_bf16 v[40:43], v[100:103], v[116:119], v[40:43]
    v_mfma_f32_16x16x32_bf16 v[44:47], v[100:103], v[120:123], v[44:47]
    v_mfma_f32_16x16x32_bf16 v[48:51], v[100:103], v[124:127], v[48:51]
    v_mfma_f32_16x16x32_bf16 v[52:55], v[100:103], v[128:131], v[52:55]
    v_mfma_f32_16x16x32_bf16 v[56:59], v[104:107], v[112:115], v[56:59]
    v_mfma_f32_16x16x32_bf16 v[60:63], v[104:107], v[116:119], v[60:63]
    v_mfma_f32_16x16x32_bf16 v[64:67], v[104:107], v[120:123], v[64:67]
    v_mfma_f32_16x16x32_bf16 v[68:71], v[104:107], v[124:127], v[68:71]
    v_mfma_f32_16x16x32_bf16 v[72:75], v[104:107], v[128:131], v[72:75]
    v_mfma_f32_16x16x32_bf16 v[76:79], v[108:111], v[112:115], v[76:79]
    v_mfma_f32_16x16x32_bf16 v[80:83], v[108:111], v[116:119], v[80:83]
    v_mfma_f32_16x16x32_bf16 v[84:87], v[108:111], v[120:123], v[84:87]
    v_mfma_f32_16x16x32_bf16 v[88:91], v[108:111], v[124:127], v[88:91]
    v_mfma_f32_16x16x32_bf16 v[92:95], v[108:111], v[128:131], v[92:95]
    buffer_load_dwordx4 v[96:99], v240, s[8:11], s32 offen sc1
    buffer_load_dwordx4 v[100:103], v241, s[8:11], s32 offen sc1
    buffer_load_dwordx4 v[104:107], v242, s[8:11], s32 offen sc1
    buffer_load_dwordx4 v[108:111], v243, s[8:11], s32 offen sc1
    s_add_u32 s32, s32, 4096
    buffer_load_dwordx4 v[112:115], v2, s[12:15], s33 offen offset:0 sc1
    buffer_load_dwordx4 v[116:119], v2, s[12:15], s33 offen offset:1024 sc1
    buffer_load_dwordx4 v[120:123], v2, s[12:15], s33 offen offset:2048 sc1
    buffer_load_dwordx4 v[124:127], v2, s[12:15], s33 offen offset:3072 sc1
    buffer_load_dwordx4 v[128:131], v3, s[12:15], s33 offen sc1
    s_add_u32 s33, s33, 5120
    s_waitcnt vmcnt(9)
    v_mfma_f32_16x16x32_bf16 v[16:19], v[132:135], v[148:151], v[16:19]
    v_mfma_f32_16x16x32_bf16 v[20:23], v[132:135], v[152:155], v[20:23]
    v_mfma_f32_16x16x32_bf16 v[24:27], v[132:135], v[156:159], v[24:27]
    v_mfma_f32_16x16x32_bf16 v[28:31], v[132:135], v[160:163], v[28:31]
    v_mfma_f32_16x16x32_bf16 v[32:35], v[132:135], v[164:167], v[32:35]
    v_mfma_f32_16x16x32_bf16 v[36:39], v[136:139], v[148:151], v[36:39]
    v_mfma_f32_16x16x32_bf16 v[40:43], v[136:139], v[152:155], v[40:43]
    v_mfma_f32_16x16x32_bf16 v[44:47], v[136:139], v[156:159], v[44:47]
    v_mfma_f32_16x16x32_bf16 v[48:51], v[136:139], v[160:163], v[48:51]
    v_mfma_f32_16x16x32_bf16 v[52:55], v[136:139], v[164:167], v[52:55]
    v_mfma_f32_16x16x32_bf16 v[56:59], v[140:143], v[148:151], v[56:59]
    v_mfma_f32_16x16x32_bf16 v[60:63], v[140:143], v[152:155], v[60:63]
    v_mfma_f32_16x16x32_bf16 v[64:67], v[140:143], v[156:159], v[64:67]
    v_mfma_f32_16x16x32_bf16 v[68:71], v[140:143], v[160:163], v[68:71]
    v_mfma_f32_16x16x32_bf16 v[72:75], v[140:143], v[164:167], v[72:75]
    v_mfma_f32_16x16x32_bf16 v[76:79], v[144:147], v[148:151], v[76:79]
    v_mfma_f32_16x16x32_bf16 v[80:83], v[144:147], v[152:155], v[80:83]
    v_mfma_f32_16x16x32_bf16 v[84:87], v[144:147], v[156:159], v[84:87]
    v_mfma_f32_16x16x32_bf16 v[88:91], v[144:147], v[160:163], v[88:91]
    v_mfma_f32_16x16x32_bf16 v[92:95], v[144:147], v[164:167], v[92:95]
    buffer_load_dwordx4 v[132:135], v240, s[8:11], s32 offen sc1
    buffer_load_dwordx4 v[136:139], v241, s[8:11], s32 offen sc1
    buffer_load_dwordx4 v[140:143], v242, s[8:11], s32 offen sc1
    buffer_load_dwordx4 v[144:147], v243, s[8:11], s32 offen sc1
    s_add_u32 s32, s32, 4096
    buffer_load_dwordx4 v[148:151], v2, s[12:15], s33 offen offset:0 sc1
    buffer_load_dwordx4 v[152:155], v2, s[12:15], s33 offen offset:1024 sc1
    buffer_load_dwordx4 v[156:159], v2, s[12:15], s33 offen offset:2048 sc1
    buffer_load_dwordx4 v[160:163], v2, s[12:15], s33 offen offset:3072 sc1
    buffer_load_dwordx4 v[164:167], v3, s[12:15], s33 offen sc1
    s_add_u32 s33, s33, 5120
    s_waitcnt vmcnt(9)
    v_mfma_f32_16x16x32_bf16 v[16:19], v[96:99], v[112:115], v[16:19]
    v_mfma_f32_16x16x32_bf16 v[20:23], v[96:99], v[116:119], v[20:23]
    v_mfma_f32_16x16x32_bf16 v[24:27], v[96:99], v[120:123], v[24:27]
    v_mfma_f32_16x16x32_bf16 v[28:31], v[96:99], v[124:127], v[28:31]
    v_mfma_f32_16x16x32_bf16 v[32:35], v[96:99], v[128:131], v[32:35]
    v_mfma_f32_16x16x32_bf16 v[36:39], v[100:103], v[112:115], v[36:39]
    v_mfma_f32_16x16x32_bf16 v[40:43], v[100:103], v[116:119], v[40:43]
    v_mfma_f32_16x16x32_bf16 v[44:47], v[100:103], v[120:123], v[44:47]
    v_mfma_f32_16x16x32_bf16 v[48:51], v[100:103], v[124:127], v[48:51]
    v_mfma_f32_16x16x32_bf16 v[52:55], v[100:103], v[128:131], v[52:55]
    v_mfma_f32_16x16x32_bf16 v[56:59], v[104:107], v[112:115], v[56:59]
    v_mfma_f32_16x16x32_bf16 v[60:63], v[104:107], v[116:119], v[60:63]
    v_mfma_f32_16x16x32_bf16 v[64:67], v[104:107], v[120:123], v[64:67]
    v_mfma_f32_16x16x32_bf16 v[68:71], v[104:107], v[124:127], v[68:71]
    v_mfma_f32_16x16x32_bf16 v[72:75], v[104:107], v[128:131], v[72:75]
    v_mfma_f32_16x16x32_bf16 v[76:79], v[108:111], v[112:115], v[76:79]
    v_mfma_f32_16x16x32_bf16 v[80:83], v[108:111], v[116:119], v[80:83]
    v_mfma_f32_16x16x32_bf16 v[84:87], v[108:111], v[120:123], v[84:87]
    v_mfma_f32_16x16x32_bf16 v[88:91], v[108:111], v[124:127], v[88:91]
    v_mfma_f32_16x16x32_bf16 v[92:95], v[108:111], v[128:131], v[92:95]
    buffer_load_dwordx4 v[96:99], v240, s[8:11], s32 offen sc1
    buffer_load_dwordx4 v[100:103], v241, s[8:11], s32 offen sc1
    buffer_load_dwordx4 v[104:107], v242, s[8:11], s32 offen sc1
    buffer_load_dwordx4 v[108:111], v243, s[8:11], s32 offen sc1
    s_add_u32 s32, s32, 4096
    buffer_load_dwordx4 v[112:115], v2, s[12:15], s33 offen offset:0 sc1
    buffer_load_dwordx4 v[116:119], v2, s[12:15], s33 offen offset:1024 sc1
    buffer_load_dwordx4 v[120:123], v2, s[12:15], s33 offen offset:2048 sc1
    buffer_load_dwordx4 v[124:127], v2, s[12:15], s33 offen offset:3072 sc1
    buffer_load_dwordx4 v[128:131], v3, s[12:15], s33 offen sc1
    s_add_u32 s33, s33, 5120
    s_waitcnt vmcnt(9)
    v_mfma_f32_16x16x32_bf16 v[16:19], v[132:135], v[148:151], v[16:19]
    v_mfma_f32_16x16x32_bf16 v[20:23], v[132:135], v[152:155], v[20:23]
    v_mfma_f32_16x16x32_bf16 v[24:27], v[132:135], v[156:159], v[24:27]
    v_mfma_f32_16x16x32_bf16 v[28:31], v[132:135], v[160:163], v[28:31]
    v_mfma_f32_16x16x32_bf16 v[32:35], v[132:135], v[164:167], v[32:35]
    v_mfma_f32_16x16x32_bf16 v[36:39], v[136:139], v[148:151], v[36:39]
    v_mfma_f32_16x16x32_bf16 v[40:43], v[136:139], v[152:155], v[40:43]
    v_mfma_f32_16x16x32_bf16 v[44:47], v[136:139], v[156:159], v[44:47]
    v_mfma_f32_16x16x32_bf16 v[48:51], v[136:139], v[160:163], v[48:51]
    v_mfma_f32_16x16x32_bf16 v[52:55], v[136:139], v[164:167], v[52:55]
    v_mfma_f32_16x16x32_bf16 v[56:59], v[140:143], v[148:151], v[56:59]
    v_mfma_f32_16x16x32_bf16 v[60:63], v[140:143], v[152:155], v[60:63]
    v_mfma_f32_16x16x32_bf16 v[64:67], v[140:143], v[156:159], v[64:67]
    v_mfma_f32_16x16x32_bf16 v[68:71], v[140:143], v[160:163], v[68:71]
    v_mfma_f32_16x16x32_bf16 v[72:75], v[140:143], v[164:167], v[72:75]
    v_mfma_f32_16x16x32_bf16 v[76:79], v[144:147], v[148:151], v[76:79]
    v_mfma_f32_16x16x32_bf16 v[80:83], v[144:147], v[152:155], v[80:83]
    v_mfma_f32_16x16x32_bf16 v[84:87], v[144:147], v[156:159], v[84:87]
    v_mfma_f32_16x16x32_bf16 v[88:91], v[144:147], v[160:163], v[88:91]
    v_mfma_f32_16x16x32_bf16 v[92:95], v[144:147], v[164:167], v[92:95]
    buffer_load_dwordx4 v[132:135], v240, s[8:11], s32 offen sc1
    buffer_load_dwordx4 v[136:139], v241, s[8:11], s32 offen sc1
    buffer_load_dwordx4 v[140:143], v242, s[8:11], s32 offen sc1
    buffer_load_dwordx4 v[144:147], v243, s[8:11], s32 offen sc1
    s_add_u32 s32, s32, 4096
    buffer_load_dwordx4 v[148:151], v2, s[12:15], s33 offen offset:0 sc1
    buffer_load_dwordx4 v[152:155], v2, s[12:15], s33 offen offset:1024 sc1
    buffer_load_dwordx4 v[156:159], v2, s[12:15], s33 offen offset:2048 sc1
    buffer_load_dwordx4 v[160:163], v2, s[12:15], s33 offen offset:3072 sc1
    buffer_load_dwordx4 v[164:167], v3, s[12:15], s33 offen sc1
    s_add_u32 s33, s33, 5120
    s_waitcnt vmcnt(9)
    v_mfma_f32_16x16x32_bf16 v[16:19], v[96:99], v[112:115], v[16:19]
    v_mfma_f32_16x16x32_bf16 v[20:23], v[96:99], v[116:119], v[20:23]
    v_mfma_f32_16x16x32_bf16 v[24:27], v[96:99], v[120:123], v[24:27]
    v_mfma_f32_16x16x32_bf16 v[28:31], v[96:99], v[124:127], v[28:31]
    v_mfma_f32_16x16x32_bf16 v[32:35], v[96:99], v[128:131], v[32:35]
    v_mfma_f32_16x16x32_bf16 v[36:39], v[100:103], v[112:115], v[36:39]
    v_mfma_f32_16x16x32_bf16 v[40:43], v[100:103], v[116:119], v[40:43]
    v_mfma_f32_16x16x32_bf16 v[44:47], v[100:103], v[120:123], v[44:47]
    v_mfma_f32_16x16x32_bf16 v[48:51], v[100:103], v[124:127], v[48:51]
    v_mfma_f32_16x16x32_bf16 v[52:55], v[100:103], v[128:131], v[52:55]
    v_mfma_f32_16x16x32_bf16 v[56:59], v[104:107], v[112:115], v[56:59]
    v_mfma_f32_16x16x32_bf16 v[60:63], v[104:107], v[116:119], v[60:63]
    v_mfma_f32_16x16x32_bf16 v[64:67], v[104:107], v[120:123], v[64:67]
    v_mfma_f32_16x16x32_bf16 v[68:71], v[104:107], v[124:127], v[68:71]
    v_mfma_f32_16x16x32_bf16 v[72:75], v[104:107], v[128:131], v[72:75]
    v_mfma_f32_16x16x32_bf16 v[76:79], v[108:111], v[112:115], v[76:79]
    v_mfma_f32_16x16x32_bf16 v[80:83], v[108:111], v[116:119], v[80:83]
    v_mfma_f32_16x16x32_bf16 v[84:87], v[108:111], v[120:123], v[84:87]
    v_mfma_f32_16x16x32_bf16 v[88:91], v[108:111], v[124:127], v[88:91]
    v_mfma_f32_16x16x32_bf16 v[92:95], v[108:111], v[128:131], v[92:95]
    buffer_load_dwordx4 v[96:99], v240, s[8:11], s32 offen sc1
    buffer_load_dwordx4 v[100:103], v241, s[8:11], s32 offen sc1
    buffer_load_dwordx4 v[104:107], v242, s[8:11], s32 offen sc1
    buffer_load_dwordx4 v[108:111], v243, s[8:11], s32 offen sc1
    s_add_u32 s32, s32, 4096
    buffer_load_dwordx4 v[112:115], v2, s[12:15], s33 offen offset:0 sc1
    buffer_load_dwordx4 v[116:119], v2, s[12:15], s33 offen offset:1024 sc1
    buffer_load_dwordx4 v[120:123], v2, s[12:15], s33 offen offset:2048 sc1
    buffer_load_dwordx4 v[124:127], v2, s[12:15], s33 offen offset:3072 sc1
    buffer_load_dwordx4 v[128:131], v3, s[12:15], s33 offen sc1
    s_add_u32 s33, s33, 5120
    s_waitcnt vmcnt(9)
    v_mfma_f32_16x16x32_bf16 v[16:19], v[132:135], v[148:151], v[16:19]
    v_mfma_f32_16x16x32_bf16 v[20:23], v[132:135], v[152:155], v[20:23]
    v_mfma_f32_16x16x32_bf16 v[24:27], v[132:135], v[156:159], v[24:27]
    v_mfma_f32_16x16x32_bf16 v[28:31], v[132:135], v[160:163], v[28:31]
    v_mfma_f32_16x16x32_bf16 v[32:35], v[132:135], v[164:167], v[32:35]
    v_mfma_f32_16x16x32_bf16 v[36:39], v[136:139], v[148:151], v[36:39]
    v_mfma_f32_16x16x32_bf16 v[40:43], v[136:139], v[152:155], v[40:43]
    v_mfma_f32_16x16x32_bf16 v[44:47], v[136:139], v[156:159], v[44:47]
    v_mfma_f32_16x16x32_bf16 v[48:51], v[136:139], v[160:163], v[48:51]
    v_mfma_f32_16x16x32_bf16 v[52:55], v[136:139], v[164:167], v[52:55]
    v_mfma_f32_16x16x32_bf16 v[56:59], v[140:143], v[148:151], v[56:59]
    v_mfma_f32_16x16x32_bf16 v[60:63], v[140:143], v[152:155], v[60:63]
    v_mfma_f32_16x16x32_bf16 v[64:67], v[140:143], v[156:159], v[64:67]
    v_mfma_f32_16x16x32_bf16 v[68:71], v[140:143], v[160:163], v[68:71]
    v_mfma_f32_16x16x32_bf16 v[72:75], v[140:143], v[164:167], v[72:75]
    v_mfma_f32_16x16x32_bf16 v[76:79], v[144:147], v[148:151], v[76:79]
    v_mfma_f32_16x16x32_bf16 v[80:83], v[144:147], v[152:155], v[80:83]
    v_mfma_f32_16x16x32_bf16 v[84:87], v[144:147], v[156:159], v[84:87]
    v_mfma_f32_16x16x32_bf16 v[88:91], v[144:147], v[160:163], v[88:91]
    v_mfma_f32_16x16x32_bf16 v[92:95], v[144:147], v[164:167], v[92:95]
    buffer_load_dwordx4 v[132:135], v240, s[8:11], s32 offen sc1
    buffer_load_dwordx4 v[136:139], v241, s[8:11], s32 offen sc1
    buffer_load_dwordx4 v[140:143], v242, s[8:11], s32 offen sc1
    buffer_load_dwordx4 v[144:147], v243, s[8:11], s32 offen sc1
    s_add_u32 s32, s32, 4096
    buffer_load_dwordx4 v[148:151], v2, s[12:15], s33 offen offset:0 sc1
    buffer_load_dwordx4 v[152:155], v2, s[12:15], s33 offen offset:1024 sc1
    buffer_load_dwordx4 v[156:159], v2, s[12:15], s33 offen offset:2048 sc1
    buffer_load_dwordx4 v[160:163], v2, s[12:15], s33 offen offset:3072 sc1
    buffer_load_dwordx4 v[164:167], v3, s[12:15], s33 offen sc1
    s_add_u32 s33, s33, 5120
    s_waitcnt vmcnt(9)
    v_mfma_f32_16x16x32_bf16 v[16:19], v[96:99], v[112:115], v[16:19]
    v_mfma_f32_16x16x32_bf16 v[20:23], v[96:99], v[116:119], v[20:23]
    v_mfma_f32_16x16x32_bf16 v[24:27], v[96:99], v[120:123], v[24:27]
    v_mfma_f32_16x16x32_bf16 v[28:31], v[96:99], v[124:127], v[28:31]
    v_mfma_f32_16x16x32_bf16 v[32:35], v[96:99], v[128:131], v[32:35]
    v_mfma_f32_16x16x32_bf16 v[36:39], v[100:103], v[112:115], v[36:39]
    v_mfma_f32_16x16x32_bf16 v[40:43], v[100:103], v[116:119], v[40:43]
    v_mfma_f32_16x16x32_bf16 v[44:47], v[100:103], v[120:123], v[44:47]
    v_mfma_f32_16x16x32_bf16 v[48:51], v[100:103], v[124:127], v[48:51]
    v_mfma_f32_16x16x32_bf16 v[52:55], v[100:103], v[128:131], v[52:55]
    v_mfma_f32_16x16x32_bf16 v[56:59], v[104:107], v[112:115], v[56:59]
    v_mfma_f32_16x16x32_bf16 v[60:63], v[104:107], v[116:119], v[60:63]
    v_mfma_f32_16x16x32_bf16 v[64:67], v[104:107], v[120:123], v[64:67]
    v_mfma_f32_16x16x32_bf16 v[68:71], v[104:107], v[124:127], v[68:71]
    v_mfma_f32_16x16x32_bf16 v[72:75], v[104:107], v[128:131], v[72:75]
    v_mfma_f32_16x16x32_bf16 v[76:79], v[108:111], v[112:115], v[76:79]
    v_mfma_f32_16x16x32_bf16 v[80:83], v[108:111], v[116:119], v[80:83]
    v_mfma_f32_16x16x32_bf16 v[84:87], v[108:111], v[120:123], v[84:87]
    v_mfma_f32_16x16x32_bf16 v[88:91], v[108:111], v[124:127], v[88:91]
    v_mfma_f32_16x16x32_bf16 v[92:95], v[108:111], v[128:131], v[92:95]
    buffer_load_dwordx4 v[96:99], v240, s[8:11], s32 offen sc1
    buffer_load_dwordx4 v[100:103], v241, s[8:11], s32 offen sc1
    buffer_load_dwordx4 v[104:107], v242, s[8:11], s32 offen sc1
    buffer_load_dwordx4 v[108:111], v243, s[8:11], s32 offen sc1
    s_add_u32 s32, s32, 4096
    buffer_load_dwordx4 v[112:115], v2, s[12:15], s33 offen offset:0 sc1
    buffer_load_dwordx4 v[116:119], v2, s[12:15], s33 offen offset:1024 sc1
    buffer_load_dwordx4 v[120:123], v2, s[12:15], s33 offen offset:2048 sc1
    buffer_load_dwordx4 v[124:127], v2, s[12:15], s33 offen offset:3072 sc1
    buffer_load_dwordx4 v[128:131], v3, s[12:15], s33 offen sc1
    s_add_u32 s33, s33, 5120
    s_waitcnt vmcnt(9)
    v_mfma_f32_16x16x32_bf16 v[16:19], v[132:135], v[148:151], v[16:19]
    v_mfma_f32_16x16x32_bf16 v[20:23], v[132:135], v[152:155], v[20:23]
    v_mfma_f32_16x16x32_bf16 v[24:27], v[132:135], v[156:159], v[24:27]
    v_mfma_f32_16x16x32_bf16 v[28:31], v[132:135], v[160:163], v[28:31]
    v_mfma_f32_16x16x32_bf16 v[32:35], v[132:135], v[164:167], v[32:35]
    v_mfma_f32_16x16x32_bf16 v[36:39], v[136:139], v[148:151], v[36:39]
    v_mfma_f32_16x16x32_bf16 v[40:43], v[136:139], v[152:155], v[40:43]
    v_mfma_f32_16x16x32_bf16 v[44:47], v[136:139], v[156:159], v[44:47]
    v_mfma_f32_16x16x32_bf16 v[48:51], v[136:139], v[160:163], v[48:51]
    v_mfma_f32_16x16x32_bf16 v[52:55], v[136:139], v[164:167], v[52:55]
    v_mfma_f32_16x16x32_bf16 v[56:59], v[140:143], v[148:151], v[56:59]
    v_mfma_f32_16x16x32_bf16 v[60:63], v[140:143], v[152:155], v[60:63]
    v_mfma_f32_16x16x32_bf16 v[64:67], v[140:143], v[156:159], v[64:67]
    v_mfma_f32_16x16x32_bf16 v[68:71], v[140:143], v[160:163], v[68:71]
    v_mfma_f32_16x16x32_bf16 v[72:75], v[140:143], v[164:167], v[72:75]
    v_mfma_f32_16x16x32_bf16 v[76:79], v[144:147], v[148:151], v[76:79]
    v_mfma_f32_16x16x32_bf16 v[80:83], v[144:147], v[152:155], v[80:83]
    v_mfma_f32_16x16x32_bf16 v[84:87], v[144:147], v[156:159], v[84:87]
    v_mfma_f32_16x16x32_bf16 v[88:91], v[144:147], v[160:163], v[88:91]
    v_mfma_f32_16x16x32_bf16 v[92:95], v[144:147], v[164:167], v[92:95]
    buffer_load_dwordx4 v[132:135], v240, s[8:11], s32 offen sc1
    buffer_load_dwordx4 v[136:139], v241, s[8:11], s32 offen sc1
    buffer_load_dwordx4 v[140:143], v242, s[8:11], s32 offen sc1
    buffer_load_dwordx4 v[144:147], v243, s[8:11], s32 offen sc1
    s_add_u32 s32, s32, 4096
    buffer_load_dwordx4 v[148:151], v2, s[12:15], s33 offen offset:0 sc1
    buffer_load_dwordx4 v[152:155], v2, s[12:15], s33 offen offset:1024 sc1
    buffer_load_dwordx4 v[156:159], v2, s[12:15], s33 offen offset:2048 sc1
    buffer_load_dwordx4 v[160:163], v2, s[12:15], s33 offen offset:3072 sc1
    buffer_load_dwordx4 v[164:167], v3, s[12:15], s33 offen sc1
    s_add_u32 s33, s33, 5120
    s_waitcnt vmcnt(9)
    v_mfma_f32_16x16x32_bf16 v[16:19], v[96:99], v[112:115], v[16:19]
    v_mfma_f32_16x16x32_bf16 v[20:23], v[96:99], v[116:119], v[20:23]
    v_mfma_f32_16x16x32_bf16 v[24:27], v[96:99], v[120:123], v[24:27]
    v_mfma_f32_16x16x32_bf16 v[28:31], v[96:99], v[124:127], v[28:31]
    v_mfma_f32_16x16x32_bf16 v[32:35], v[96:99], v[128:131], v[32:35]
    v_mfma_f32_16x16x32_bf16 v[36:39], v[100:103], v[112:115], v[36:39]
    v_mfma_f32_16x16x32_bf16 v[40:43], v[100:103], v[116:119], v[40:43]
    v_mfma_f32_16x16x32_bf16 v[44:47], v[100:103], v[120:123], v[44:47]
    v_mfma_f32_16x16x32_bf16 v[48:51], v[100:103], v[124:127], v[48:51]
    v_mfma_f32_16x16x32_bf16 v[52:55], v[100:103], v[128:131], v[52:55]
    v_mfma_f32_16x16x32_bf16 v[56:59], v[104:107], v[112:115], v[56:59]
    v_mfma_f32_16x16x32_bf16 v[60:63], v[104:107], v[116:119], v[60:63]
    v_mfma_f32_16x16x32_bf16 v[64:67], v[104:107], v[120:123], v[64:67]
    v_mfma_f32_16x16x32_bf16 v[68:71], v[104:107], v[124:127], v[68:71]
    v_mfma_f32_16x16x32_bf16 v[72:75], v[104:107], v[128:131], v[72:75]
    v_mfma_f32_16x16x32_bf16 v[76:79], v[108:111], v[112:115], v[76:79]
    v_mfma_f32_16x16x32_bf16 v[80:83], v[108:111], v[116:119], v[80:83]
    v_mfma_f32_16x16x32_bf16 v[84:87], v[108:111], v[120:123], v[84:87]
    v_mfma_f32_16x16x32_bf16 v[88:91], v[108:111], v[124:127], v[88:91]
    v_mfma_f32_16x16x32_bf16 v[92:95], v[108:111], v[128:131], v[92:95]
    buffer_load_dwordx4 v[204:207], v216, s[20:23], 0 offen
    buffer_load_dwordx4 v[208:211], v217, s[20:23], 0 offen
    buffer_load_dwordx4 v[212:215], v218, s[20:23], 0 offen
    buffer_load_dword v236, v237, s[80:83], 0 offen sc1
    s_waitcnt vmcnt(4)
    v_mfma_f32_16x16x32_bf16 v[16:19], v[132:135], v[148:151], v[16:19]
    v_mfma_f32_16x16x32_bf16 v[20:23], v[132:135], v[152:155], v[20:23]
    v_mfma_f32_16x16x32_bf16 v[24:27], v[132:135], v[156:159], v[24:27]
    v_mfma_f32_16x16x32_bf16 v[28:31], v[132:135], v[160:163], v[28:31]
    v_mfma_f32_16x16x32_bf16 v[32:35], v[132:135], v[164:167], v[32:35]
    v_mfma_f32_16x16x32_bf16 v[36:39], v[136:139], v[148:151], v[36:39]
    v_mfma_f32_16x16x32_bf16 v[40:43], v[136:139], v[152:155], v[40:43]
    v_mfma_f32_16x16x32_bf16 v[44:47], v[136:139], v[156:159], v[44:47]
    v_mfma_f32_16x16x32_bf16 v[48:51], v[136:139], v[160:163], v[48:51]
    v_mfma_f32_16x16x32_bf16 v[52:55], v[136:139], v[164:167], v[52:55]
    v_mfma_f32_16x16x32_bf16 v[56:59], v[140:143], v[148:151], v[56:59]
    v_mfma_f32_16x16x32_bf16 v[60:63], v[140:143], v[152:155], v[60:63]
    v_mfma_f32_16x16x32_bf16 v[64:67], v[140:143], v[156:159], v[64:67]
    v_mfma_f32_16x16x32_bf16 v[68:71], v[140:143], v[160:163], v[68:71]
    v_mfma_f32_16x16x32_bf16 v[72:75], v[140:143], v[164:167], v[72:75]
    v_mfma_f32_16x16x32_bf16 v[76:79], v[144:147], v[148:151], v[76:79]
    v_mfma_f32_16x16x32_bf16 v[80:83], v[144:147], v[152:155], v[80:83]
    v_mfma_f32_16x16x32_bf16 v[84:87], v[144:147], v[156:159], v[84:87]
    v_mfma_f32_16x16x32_bf16 v[88:91], v[144:147], v[160:163], v[88:91]
    v_mfma_f32_16x16x32_bf16 v[92:95], v[144:147], v[164:167], v[92:95]
    ds_write_b128 v244, v[36:39] offset:0
    ds_write_b128 v244, v[40:43] offset:1024
    ds_write_b128 v244, v[44:47] offset:2048
    ds_write_b128 v244, v[48:51] offset:3072
    ds_write_b128 v244, v[52:55] offset:4096
    ds_write_b128 v245, v[56:59] offset:0
    ds_write_b128 v245, v[60:63] offset:1024
    ds_write_b128 v245, v[64:67] offset:2048
    ds_write_b128 v245, v[68:71] offset:3072
    ds_write_b128 v245, v[72:75] offset:4096
    ds_write_b128 v246, v[76:79] offset:0
    ds_write_b128 v246, v[80:83] offset:1024
    ds_write_b128 v246, v[84:87] offset:2048
    ds_write_b128 v246, v[88:91] offset:3072
    ds_write_b128 v246, v[92:95] offset:4096
    s_waitcnt vmcnt(0)
    s_mov_b32 s62, 0
L_ps_10:
    v_cmp_ne_u32 vcc, s61, v236
    s_nop 0
    s_cmp_eq_u64 vcc, 0
    s_cbranch_scc1 L_psd_11
    s_sleep 8
    buffer_load_dword v236, v237, s[80:83], 0 offen sc1
    s_waitcnt vmcnt(0)
    s_add_u32 s62, s62, 1
    s_cmp_lt_u32 s62, 32768
    s_cbranch_scc1 L_ps_10
L_psd_11:
    s_add_u32 s6, s34, 0
    buffer_load_dwordx2 v[226:227], v224, s[16:19], s6 offen sc1
    s_add_u32 s6, s34, 65536
    buffer_load_dwordx2 v[228:229], v224, s[16:19], s6 offen sc1
    s_add_u32 s6, s34, 131072
    buffer_load_dwordx2 v[230:231], v224, s[16:19], s6 offen sc1
    s_add_u32 s6, s34, 196608
    buffer_load_dwordx2 v[232:233], v224, s[16:19], s6 offen sc1
    s_add_u32 s6, s34, 262144
    buffer_load_dwordx2 v[234:235], v224, s[16:19], s6 offen sc1
    s_waitcnt lgkmcnt(0)
    s_barrier
    ds_read_b128 v[96:99], v7 offset:0
    ds_read_b128 v[100:103], v7 offset:1024
    ds_read_b128 v[104:107], v7 offset:2048
    ds_read_b128 v[108:111], v7 offset:3072
    ds_read_b128 v[112:115], v7 offset:4096
    ds_read_b128 v[116:119], v7 offset:5120
    ds_read_b128 v[120:123], v7 offset:6144
    ds_read_b128 v[124:127], v7 offset:7168
    ds_read_b128 v[128:131], v7 offset:8192
    ds_read_b128 v[132:135], v7 offset:9216
    ds_read_b128 v[136:139], v7 offset:10240
    ds_read_b128 v[140:143], v7 offset:11264
    ds_read_b128 v[144:147], v7 offset:12288
    ds_read_b128 v[148:151], v7 offset:13312
    ds_read_b128 v[152:155], v7 offset:14336
    s_waitcnt lgkmcnt(10)
    v_pk_add_f32 v[16:17], v[16:17], v[96:97]
    v_pk_add_f32 v[18:19], v[18:19], v[98:99]
    v_pk_add_f32 v[20:21], v[20:21], v[100:101]
    v_pk_add_f32 v[22:23], v[22:23], v[102:103]
    v_pk_add_f32 v[24:25], v[24:25], v[104:105]
    v_pk_add_f32 v[26:27], v[26:27], v[106:107]
    v_pk_add_f32 v[28:29], v[28:29], v[108:109]
    v_pk_add_f32 v[30:31], v[30:31], v[110:111]
    v_pk_add_f32 v[32:33], v[32:33], v[112:113]
    v_pk_add_f32 v[34:35], v[34:35], v[114:115]
    s_waitcnt lgkmcnt(5)
    v_pk_add_f32 v[16:17], v[16:17], v[116:117]
    v_pk_add_f32 v[18:19], v[18:19], v[118:119]
    v_pk_add_f32 v[20:21], v[20:21], v[120:121]
    v_pk_add_f32 v[22:23], v[22:23], v[122:123]
    v_pk_add_f32 v[24:25], v[24:25], v[124:125]
    v_pk_add_f32 v[26:27], v[26:27], v[126:127]
    v_pk_add_f32 v[28:29], v[28:29], v[128:129]
    v_pk_add_f32 v[30:31], v[30:31], v[130:131]
    v_pk_add_f32 v[32:33], v[32:33], v[132:133]
    v_pk_add_f32 v[34:35], v[34:35], v[134:135]
    s_waitcnt lgkmcnt(0)
    v_pk_add_f32 v[16:17], v[16:17], v[136:137]
    v_pk_add_f32 v[18:19], v[18:19], v[138:139]
    v_pk_add_f32 v[20:21], v[20:21], v[140:141]
    v_pk_add_f32 v[22:23], v[22:23], v[142:143]
    v_pk_add_f32 v[24:25], v[24:25], v[144:145]
    v_pk_add_f32 v[26:27], v[26:27], v[146:147]
    v_pk_add_f32 v[28:29], v[28:29], v[148:149]
    v_pk_add_f32 v[30:31], v[30:31], v[150:151]
    v_pk_add_f32 v[32:33], v[32:33], v[152:153]
    v_pk_add_f32 v[34:35], v[34:35], v[154:155]
    v_mov_b32 v60, 0xbfb8aa3b
    v_mov_b32 v61, 0xbfb8aa3b
    v_mov_b32 v62, 1.0
    v_mov_b32 v63, 1.0
    v_pk_mul_f32 v[40:41], v[16:17], v[60:61]
    v_pk_mul_f32 v[42:43], v[18:19], v[60:61]
    v_pk_mul_f32 v[44:45], v[20:21], v[60:61]
    v_pk_mul_f32 v[46:47], v[22:23], v[60:61]
    v_pk_mul_f32 v[48:49], v[24:25], v[60:61]
    v_pk_mul_f32 v[50:51], v[26:27], v[60:61]
    v_pk_mul_f32 v[52:53], v[28:29], v[60:61]
    v_pk_mul_f32 v[54:55], v[30:31], v[60:61]
    v_pk_mul_f32 v[56:57], v[32:33], v[60:61]
    v_pk_mul_f32 v[58:59], v[34:35], v[60:61]
    v_exp_f32 v40, v40
    v_exp_f32 v41, v41
    v_exp_f32 v42, v42
    v_exp_f32 v43, v43
    v_exp_f32 v44, v44
    v_exp_f32 v45, v45
    v_exp_f32 v46, v46
    v_exp_f32 v47, v47
    v_exp_f32 v48, v48
    v_exp_f32 v49, v49
    v_exp_f32 v50, v50
    v_exp_f32 v51, v51
    v_exp_f32 v52, v52
    v_exp_f32 v53, v53
    v_exp_f32 v54, v54
    v_exp_f32 v55, v55
    v_exp_f32 v56, v56
    v_exp_f32 v57, v57
    v_exp_f32 v58, v58
    v_exp_f32 v59, v59
    v_pk_add_f32 v[40:41], v[40:41], v[62:63]
    v_pk_add_f32 v[42:43], v[42:43], v[62:63]
    v_pk_add_f32 v[44:45], v[44:45], v[62:63]
    v_pk_add_f32 v[46:47], v[46:47], v[62:63]
    v_pk_add_f32 v[48:49], v[48:49], v[62:63]
    v_pk_add_f32 v[50:51], v[50:51], v[62:63]
    v_pk_add_f32 v[52:53], v[52:53], v[62:63]
    v_pk_add_f32 v[54:55], v[54:55], v[62:63]
    v_pk_add_f32 v[56:57], v[56:57], v[62:63]
    v_pk_add_f32 v[58:59], v[58:59], v[62:63]
    v_rcp_f32 v40, v40
    v_rcp_f32 v41, v41
    v_rcp_f32 v42, v42
    v_rcp_f32 v43, v43
    v_rcp_f32 v44, v44
    v_rcp_f32 v45, v45
    v_rcp_f32 v46, v46
    v_rcp_f32 v47, v47
    v_rcp_f32 v48, v48
    v_rcp_f32 v49, v49
    v_rcp_f32 v50, v50
    v_rcp_f32 v51, v51
    v_rcp_f32 v52, v52
    v_rcp_f32 v53, v53
    v_rcp_f32 v54, v54
    v_rcp_f32 v55, v55
    v_rcp_f32 v56, v56
    v_rcp_f32 v57, v57
    v_rcp_f32 v58, v58
    v_rcp_f32 v59, v59
    v_pk_mul_f32 v[16:17], v[16:17], v[40:41]
    v_pk_mul_f32 v[18:19], v[18:19], v[42:43]
    v_pk_mul_f32 v[20:21], v[20:21], v[44:45]
    v_pk_mul_f32 v[22:23], v[22:23], v[46:47]
    v_pk_mul_f32 v[24:25], v[24:25], v[48:49]
    v_pk_mul_f32 v[26:27], v[26:27], v[50:51]
    v_pk_mul_f32 v[28:29], v[28:29], v[52:53]
    v_pk_mul_f32 v[30:31], v[30:31], v[54:55]
    v_pk_mul_f32 v[32:33], v[32:33], v[56:57]
    v_pk_mul_f32 v[34:35], v[34:35], v[58:59]
    s_waitcnt vmcnt(0)
    v_lshlrev_b32 v64, 16, v226
    v_and_b32 v65, 0xffff0000, v226
    v_lshlrev_b32 v66, 16, v227
    v_and_b32 v67, 0xffff0000, v227
    v_pk_mul_f32 v[64:65], v[64:65], v[16:17]
    v_pk_mul_f32 v[66:67], v[66:67], v[18:19]
    v_cvt_pk_bf16_f32 v68, v64, v65
    v_cvt_pk_bf16_f32 v69, v66, v67
    ds_write_b16 v225, v68 offset:0
    ds_write_b16_d16_hi v225, v68 offset:176
    ds_write_b16 v225, v69 offset:352
    ds_write_b16_d16_hi v225, v69 offset:528
    v_lshlrev_b32 v72, 16, v228
    v_and_b32 v73, 0xffff0000, v228
    v_lshlrev_b32 v74, 16, v229
    v_and_b32 v75, 0xffff0000, v229
    v_pk_mul_f32 v[72:73], v[72:73], v[20:21]
    v_pk_mul_f32 v[74:75], v[74:75], v[22:23]
    v_cvt_pk_bf16_f32 v76, v72, v73
    v_cvt_pk_bf16_f32 v77, v74, v75
    ds_write_b16 v225, v76 offset:32
    ds_write_b16_d16_hi v225, v76 offset:208
    ds_write_b16 v225, v77 offset:384
    ds_write_b16_d16_hi v225, v77 offset:560
    v_lshlrev_b32 v64, 16, v230
    v_and_b32 v65, 0xffff0000, v230
    v_lshlrev_b32 v66, 16, v231
    v_and_b32 v67, 0xffff0000, v231
    v_pk_mul_f32 v[64:65], v[64:65], v[24:25]
    v_pk_mul_f32 v[66:67], v[66:67], v[26:27]
    v_cvt_pk_bf16_f32 v68, v64, v65
    v_cvt_pk_bf16_f32 v69, v66, v67
    ds_write_b16 v225, v68 offset:64
    ds_write_b16_d16_hi v225, v68 offset:240
    ds_write_b16 v225, v69 offset:416
    ds_write_b16_d16_hi v225, v69 offset:592
    v_lshlrev_b32 v72, 16, v232
    v_and_b32 v73, 0xffff0000, v232
    v_lshlrev_b32 v74, 16, v233
    v_and_b32 v75, 0xffff0000, v233
    v_pk_mul_f32 v[72:73], v[72:73], v[28:29]
    v_pk_mul_f32 v[74:75], v[74:75], v[30:31]
    v_cvt_pk_bf16_f32 v76, v72, v73
    v_cvt_pk_bf16_f32 v77, v74, v75
    ds_write_b16 v225, v76 offset:96
    ds_write_b16_d16_hi v225, v76 offset:272
    ds_write_b16 v225, v77 offset:448
    ds_write_b16_d16_hi v225, v77 offset:624
    v_lshlrev_b32 v64, 16, v234
    v_and_b32 v65, 0xffff0000, v234
    v_lshlrev_b32 v66, 16, v235
    v_and_b32 v67, 0xffff0000, v235
    v_pk_mul_f32 v[64:65], v[64:65], v[32:33]
    v_pk_mul_f32 v[66:67], v[66:67], v[34:35]
    v_cvt_pk_bf16_f32 v68, v64, v65
    v_cvt_pk_bf16_f32 v69, v66, v67
    ds_write_b16 v225, v68 offset:128
    ds_write_b16_d16_hi v225, v68 offset:304
    ds_write_b16 v225, v69 offset:480
    ds_write_b16_d16_hi v225, v69 offset:656
    v_lshlrev_b32 v80, 16, v204
    v_and_b32 v81, 0xffff0000, v204
    v_lshlrev_b32 v82, 16, v205
    v_and_b32 v83, 0xffff0000, v205
    v_lshlrev_b32 v84, 16, v206
    v_and_b32 v85, 0xffff0000, v206
    v_lshlrev_b32 v86, 16, v207
    v_and_b32 v87, 0xffff0000, v207
    v_lshlrev_b32 v88, 16, v208
    v_and_b32 v89, 0xffff0000, v208
    v_lshlrev_b32 v90, 16, v209
    v_and_b32 v91, 0xffff0000, v209
    v_lshlrev_b32 v92, 16, v210
    v_and_b32 v93, 0xffff0000, v210
    v_lshlrev_b32 v94, 16, v211
    v_and_b32 v95, 0xffff0000, v211
    v_lshlrev_b32 v96, 16, v212
    v_and_b32 v97, 0xffff0000, v212
    v_lshlrev_b32 v98, 16, v213
    v_and_b32 v99, 0xffff0000, v213
    v_lshlrev_b32 v100, 16, v214
    v_and_b32 v101, 0xffff0000, v214
    v_lshlrev_b32 v102, 16, v215
    v_and_b32 v103, 0xffff0000, v215
    s_waitcnt lgkmcnt(0)
    s_barrier
    ds_read_b128 v[64:67], v220 offset:61440
    ds_read_b128 v[68:71], v221 offset:61440
    ds_read_b128 v[72:75], v222 offset:61440
    s_waitcnt lgkmcnt(2)
    v_lshlrev_b32 v44, 16, v64
    v_and_b32 v45, 0xffff0000, v64
    v_pk_add_f32 v[44:45], v[44:45], v[80:81]
    v_cvt_pk_bf16_f32 v64, v44, v45
    v_lshlrev_b32 v44, 16, v65
    v_and_b32 v45, 0xffff0000, v65
    v_pk_add_f32 v[44:45], v[44:45], v[82:83]
    v_cvt_pk_bf16_f32 v65, v44, v45
    v_lshlrev_b32 v44, 16, v66
    v_and_b32 v45, 0xffff0000, v66
    v_pk_add_f32 v[44:45], v[44:45], v[84:85]
    v_cvt_pk_bf16_f32 v66, v44, v45
    v_lshlrev_b32 v44, 16, v67
    v_and_b32 v45, 0xffff0000, v67
    v_pk_add_f32 v[44:45], v[44:45], v[86:87]
    v_cvt_pk_bf16_f32 v67, v44, v45
    buffer_store_dwordx4 v[64:67], v216, s[24:27], 0 offen
    s_waitcnt lgkmcnt(1)
    v_lshlrev_b32 v44, 16, v68
    v_and_b32 v45, 0xffff0000, v68
    v_pk_add_f32 v[44:45], v[44:45], v[88:89]
    v_cvt_pk_bf16_f32 v68, v44, v45
    v_lshlrev_b32 v44, 16, v69
    v_and_b32 v45, 0xffff0000, v69
    v_pk_add_f32 v[44:45], v[44:45], v[90:91]
    v_cvt_pk_bf16_f32 v69, v44, v45
    v_lshlrev_b32 v44, 16, v70
    v_and_b32 v45, 0xffff0000, v70
    v_pk_add_f32 v[44:45], v[44:45], v[92:93]
    v_cvt_pk_bf16_f32 v70, v44, v45
    v_lshlrev_b32 v44, 16, v71
    v_and_b32 v45, 0xffff0000, v71
    v_pk_add_f32 v[44:45], v[44:45], v[94:95]
    v_cvt_pk_bf16_f32 v71, v44, v45
    buffer_store_dwordx4 v[68:71], v217, s[24:27], 0 offen
    s_waitcnt lgkmcnt(0)
    v_lshlrev_b32 v44, 16, v72
    v_and_b32 v45, 0xffff0000, v72
    v_pk_add_f32 v[44:45], v[44:45], v[96:97]
    v_cvt_pk_bf16_f32 v72, v44, v45
    v_lshlrev_b32 v44, 16, v73
    v_and_b32 v45, 0xffff0000, v73
    v_pk_add_f32 v[44:45], v[44:45], v[98:99]
    v_cvt_pk_bf16_f32 v73, v44, v45
    v_lshlrev_b32 v44, 16, v74
    v_and_b32 v45, 0xffff0000, v74
    v_pk_add_f32 v[44:45], v[44:45], v[100:101]
    v_cvt_pk_bf16_f32 v74, v44, v45
    v_lshlrev_b32 v44, 16, v75
    v_and_b32 v45, 0xffff0000, v75
    v_pk_add_f32 v[44:45], v[44:45], v[102:103]
    v_cvt_pk_bf16_f32 v75, v44, v45
    buffer_store_dwordx4 v[72:75], v218, s[24:27], 0 offen
    s_endpgm
L_exit_k:
    s_endpgm
L_others_k:
    s_cmp_lt_u32 s2, 32
    s_cbranch_scc1 L_role_k_0
    s_cmp_lt_u32 s2, 256
    s_cbranch_scc1 L_role_k_1
    s_branch L_role_k_2
L_role_k_0:
    s_sub_u32 s3, s2, 0
L_body_k_0:
    s_load_dwordx2 s[40:41], s[0:1], 0
    s_load_dwordx2 s[42:43], s[0:1], 96
    v_and_b32 v1, 63, v0
    v_lshrrev_b32 v2, 6, v0
    s_nop 0
    v_readfirstlane_b32 s4, v2
    s_nop 0
    s_add_u32 s5, s3, s4
    s_cmp_lg_u32 s5, 0
    s_cbranch_scc1 L_ln_notag_12
    s_load_dwordx2 s[84:85], s[0:1], 88
    s_memrealtime s[86:87]
    s_waitcnt lgkmcnt(0)
    s_or_b32 s61, s86, 1
    s_mov_b32 s86, 256
    s_mov_b32 s87, 0x00020000
    v_mov_b32 v12, 0
    v_mov_b32 v13, s61
    s_mov_b64 exec, 1
    buffer_store_dword v13, v12, s[84:87], 0 offen sc1
    s_mov_b64 exec, -1
L_ln_notag_12:
    v_lshrrev_b32 v3, 3, v1
    v_and_b32 v4, 7, v1
    s_lshl_b32 s5, s3, 5
    s_lshl_b32 s6, s4, 3
    v_add_u32 v7, s6, v3
    v_add_u32 v5, s5, v7
    v_mul_u32_u24 v6, 1280, v5
    v_lshl_add_u32 v6, v4, 4, v6
    v_mul_u32_u24 v7, 1344, v7
    v_lshl_add_u32 v7, v4, 4, v7
    s_waitcnt lgkmcnt(0)
    s_mov_b32 s8, s40
    s_mov_b32 s9, s41
    s_mov_b32 s10, 0x280000
    s_mov_b32 s11, 0x00020000
    buffer_load_dwordx4 v[16:19], v6, s[8:11], 0 offen offset:0
    buffer_load_dwordx4 v[20:23], v6, s[8:11], 0 offen offset:128
    buffer_load_dwordx4 v[24:27], v6, s[8:11], 0 offen offset:256
    buffer_load_dwordx4 v[28:31], v6, s[8:11], 0 offen offset:384
    buffer_load_dwordx4 v[32:35], v6, s[8:11], 0 offen offset:512
    buffer_load_dwordx4 v[36:39], v6, s[8:11], 0 offen offset:640
    buffer_load_dwordx4 v[40:43], v6, s[8:11], 0 offen offset:768
    buffer_load_dwordx4 v[44:47], v6, s[8:11], 0 offen offset:896
    buffer_load_dwordx4 v[48:51], v6, s[8:11], 0 offen offset:1024
    buffer_load_dwordx4 v[52:55], v6, s[8:11], 0 offen offset:1152
    s_mov_b32 s12, s42
    s_mov_b32 s13, s43
    s_mov_b32 s14, 0x4000
    s_mov_b32 s15, 0x00020000
    s_add_u32 s16, s42, 0x10000
    s_addc_u32 s17, s43, 0
    s_mov_b32 s18, 0x280000
    s_mov_b32 s19, 0x00020000
    s_add_u32 s80, s42, 0x1400000
    s_addc_u32 s81, s43, 0
    s_mov_b32 s82, 0x17000
    s_mov_b32 s83, 0x00020000
    v_mov_b32 v15, 0x3f803f80
    v_mov_b32 v8, 0
    v_mov_b32 v14, 0
    s_waitcnt vmcnt(9)
    v_dot2c_f32_bf16 v8, v16, v15
    v_dot2c_f32_bf16 v14, v16, v16
    v_dot2c_f32_bf16 v8, v17, v15
    v_dot2c_f32_bf16 v14, v17, v17
    v_dot2c_f32_bf16 v8, v18, v15
    v_dot2c_f32_bf16 v14, v18, v18
    v_dot2c_f32_bf16 v8, v19, v15
    v_dot2c_f32_bf16 v14, v19, v19
    s_waitcnt vmcnt(8)
    v_dot2c_f32_bf16 v8, v20, v15
    v_dot2c_f32_bf16 v14, v20, v20
    v_dot2c_f32_bf16 v8, v21, v15
    v_dot2c_f32_bf16 v14, v21, v21
    v_dot2c_f32_bf16 v8, v22, v15
    v_dot2c_f32_bf16 v14, v22, v22
    v_dot2c_f32_bf16 v8, v23, v15
    v_dot2c_f32_bf16 v14, v23, v23
    s_waitcnt vmcnt(7)
    v_dot2c_f32_bf16 v8, v24, v15
    v_dot2c_f32_bf16 v14, v24, v24
    v_dot2c_f32_bf16 v8, v25, v15
    v_dot2c_f32_bf16 v14, v25, v25
    v_dot2c_f32_bf16 v8, v26, v15
    v_dot2c_f32_bf16 v14, v26, v26
    v_dot2c_f32_bf16 v8, v27, v15
    v_dot2c_f32_bf16 v14, v27, v27
    s_waitcnt vmcnt(6)
    v_dot2c_f32_bf16 v8, v28, v15
    v_dot2c_f32_bf16 v14, v28, v28
    v_dot2c_f32_bf16 v8, v29, v15
    v_dot2c_f32_bf16 v14, v29, v29
    v_dot2c_f32_bf16 v8, v30, v15
    v_dot2c_f32_bf16 v14, v30, v30
    v_dot2c_f32_bf16 v8, v31, v15
    v_dot2c_f32_bf16 v14, v31, v31
    s_waitcnt vmcnt(5)
    v_dot2c_f32_bf16 v8, v32, v15
    v_dot2c_f32_bf16 v14, v32, v32
    v_dot2c_f32_bf16 v8, v33, v15
    v_dot2c_f32_bf16 v14, v33, v33
    v_dot2c_f32_bf16 v8, v34, v15
    v_dot2c_f32_bf16 v14, v34, v34
    v_dot2c_f32_bf16 v8, v35, v15
    v_dot2c_f32_bf16 v14, v35, v35
    s_waitcnt vmcnt(4)
    v_dot2c_f32_bf16 v8, v36, v15
    v_dot2c_f32_bf16 v14, v36, v36
    v_dot2c_f32_bf16 v8, v37, v15
    v_dot2c_f32_bf16 v14, v37, v37
    v_dot2c_f32_bf16 v8, v38, v15
    v_dot2c_f32_bf16 v14, v38, v38
    v_dot2c_f32_bf16 v8, v39, v15
    v_dot2c_f32_bf16 v14, v39, v39
    s_waitcnt vmcnt(3)
    v_dot2c_f32_bf16 v8, v40, v15
    v_dot2c_f32_bf16 v14, v40, v40
    v_dot2c_f32_bf16 v8, v41, v15
    v_dot2c_f32_bf16 v14, v41, v41
    v_dot2c_f32_bf16 v8, v42, v15
    v_dot2c_f32_bf16 v14, v42, v42
    v_dot2c_f32_bf16 v8, v43, v15
    v_dot2c_f32_bf16 v14, v43, v43
    s_waitcnt vmcnt(2)
    v_dot2c_f32_bf16 v8, v44, v15
    v_dot2c_f32_bf16 v14, v44, v44
    v_dot2c_f32_bf16 v8, v45, v15
    v_dot2c_f32_bf16 v14, v45, v45
    v_dot2c_f32_bf16 v8, v46, v15
    v_dot2c_f32_bf16 v14, v46, v46
    v_dot2c_f32_bf16 v8, v47, v15
    v_dot2c_f32_bf16 v14, v47, v47
    s_waitcnt vmcnt(1)
    v_dot2c_f32_bf16 v8, v48, v15
    v_dot2c_f32_bf16 v14, v48, v48
    v_dot2c_f32_bf16 v8, v49, v15
    v_dot2c_f32_bf16 v14, v49, v49
    v_dot2c_f32_bf16 v8, v50, v15
    v_dot2c_f32_bf16 v14, v50, v50
    v_dot2c_f32_bf16 v8, v51, v15
    v_dot2c_f32_bf16 v14, v51, v51
    s_waitcnt vmcnt(0)
    v_dot2c_f32_bf16 v8, v52, v15
    v_dot2c_f32_bf16 v14, v52, v52
    v_dot2c_f32_bf16 v8, v53, v15
    v_dot2c_f32_bf16 v14, v53, v53
    v_dot2c_f32_bf16 v8, v54, v15
    v_dot2c_f32_bf16 v14, v54, v54
    v_dot2c_f32_bf16 v8, v55, v15
    v_dot2c_f32_bf16 v14, v55, v55
    s_nop 2
    v_add_f32_dpp v8, v8, v8 quad_perm:[1,0,3,2] row_mask:0xf bank_mask:0xf
    s_nop 1
    v_add_f32_dpp v8, v8, v8 quad_perm:[2,3,0,1] row_mask:0xf bank_mask:0xf
    s_nop 1
    v_add_f32_dpp v8, v8, v8 row_half_mirror row_mask:0xf bank_mask:0xf
    v_add_f32_dpp v14, v14, v14 quad_perm:[1,0,3,2] row_mask:0xf bank_mask:0xf
    s_nop 1
    v_add_f32_dpp v14, v14, v14 quad_perm:[2,3,0,1] row_mask:0xf bank_mask:0xf
    s_nop 1
    v_add_f32_dpp v14, v14, v14 row_half_mirror row_mask:0xf bank_mask:0xf
    v_mul_f32 v9, 0x3acccccd, v8
    v_mul_f32 v12, 0x3acccccd, v14
    v_fma_f32 v12, -v9, v9, v12
    v_max_f32 v12, 0, v12
    v_cvt_pk_bf16_f32 v12, v12, v12
    v_lshlrev_b32 v12, 16, v12
    v_add_f32 v12, 0x3727c5ac, v12
    v_cvt_pk_bf16_f32 v12, v12, v12
    v_lshlrev_b32 v12, 16, v12
    v_sqrt_f32 v12, v12
    s_nop 0
    v_cvt_pk_bf16_f32 v12, v12, v12
    v_lshlrev_b32 v12, 16, v12
    v_rcp_f32 v11, v12
    v_cvt_pk_bf16_f32 v10, v9, v9
    v_lshlrev_b32 v10, 16, v10
    v_lshlrev_b32 v13, 3, v5
    v_cmp_eq_u32 vcc, 0, v4
    s_nop 0
    s_and_saveexec_b64 s[6:7], vcc
    buffer_store_dwordx2 v[10:11], v13, s[12:15], 0 offen sc1
    s_mov_b64 exec, s[6:7]
    v_lshlrev_b32 v64, 16, v16
    v_and_b32 v65, 0xffff0000, v16
    v_sub_f32 v64, v64, v10
    v_sub_f32 v65, v65, v10
    v_mul_f32 v64, v64, v11
    v_mul_f32 v65, v65, v11
    v_cvt_pk_bf16_f32 v16, v64, v65
    v_lshlrev_b32 v66, 16, v17
    v_and_b32 v67, 0xffff0000, v17
    v_sub_f32 v66, v66, v10
    v_sub_f32 v67, v67, v10
    v_mul_f32 v66, v66, v11
    v_mul_f32 v67, v67, v11
    v_cvt_pk_bf16_f32 v17, v66, v67
    v_lshlrev_b32 v68, 16, v18
    v_and_b32 v69, 0xffff0000, v18
    v_sub_f32 v68, v68, v10
    v_sub_f32 v69, v69, v10
    v_mul_f32 v68, v68, v11
    v_mul_f32 v69, v69, v11
    v_cvt_pk_bf16_f32 v18, v68, v69
    v_lshlrev_b32 v70, 16, v19
    v_and_b32 v71, 0xffff0000, v19
    v_sub_f32 v70, v70, v10
    v_sub_f32 v71, v71, v10
    v_mul_f32 v70, v70, v11
    v_mul_f32 v71, v71, v11
    v_cvt_pk_bf16_f32 v19, v70, v71
    ds_write_b128 v7, v[16:19] offset:0
    v_lshlrev_b32 v64, 16, v20
    v_and_b32 v65, 0xffff0000, v20
    v_sub_f32 v64, v64, v10
    v_sub_f32 v65, v65, v10
    v_mul_f32 v64, v64, v11
    v_mul_f32 v65, v65, v11
    v_cvt_pk_bf16_f32 v20, v64, v65
    v_lshlrev_b32 v66, 16, v21
    v_and_b32 v67, 0xffff0000, v21
    v_sub_f32 v66, v66, v10
    v_sub_f32 v67, v67, v10
    v_mul_f32 v66, v66, v11
    v_mul_f32 v67, v67, v11
    v_cvt_pk_bf16_f32 v21, v66, v67
    v_lshlrev_b32 v68, 16, v22
    v_and_b32 v69, 0xffff0000, v22
    v_sub_f32 v68, v68, v10
    v_sub_f32 v69, v69, v10
    v_mul_f32 v68, v68, v11
    v_mul_f32 v69, v69, v11
    v_cvt_pk_bf16_f32 v22, v68, v69
    v_lshlrev_b32 v70, 16, v23
    v_and_b32 v71, 0xffff0000, v23
    v_sub_f32 v70, v70, v10
    v_sub_f32 v71, v71, v10
    v_mul_f32 v70, v70, v11
    v_mul_f32 v71, v71, v11
    v_cvt_pk_bf16_f32 v23, v70, v71
    ds_write_b128 v7, v[20:23] offset:128
    v_lshlrev_b32 v64, 16, v24
    v_and_b32 v65, 0xffff0000, v24
    v_sub_f32 v64, v64, v10
    v_sub_f32 v65, v65, v10
    v_mul_f32 v64, v64, v11
    v_mul_f32 v65, v65, v11
    v_cvt_pk_bf16_f32 v24, v64, v65
    v_lshlrev_b32 v66, 16, v25
    v_and_b32 v67, 0xffff0000, v25
    v_sub_f32 v66, v66, v10
    v_sub_f32 v67, v67, v10
    v_mul_f32 v66, v66, v11
    v_mul_f32 v67, v67, v11
    v_cvt_pk_bf16_f32 v25, v66, v67
    v_lshlrev_b32 v68, 16, v26
    v_and_b32 v69, 0xffff0000, v26
    v_sub_f32 v68, v68, v10
    v_sub_f32 v69, v69, v10
    v_mul_f32 v68, v68, v11
    v_mul_f32 v69, v69, v11
    v_cvt_pk_bf16_f32 v26, v68, v69
    v_lshlrev_b32 v70, 16, v27
    v_and_b32 v71, 0xffff0000, v27
    v_sub_f32 v70, v70, v10
    v_sub_f32 v71, v71, v10
    v_mul_f32 v70, v70, v11
    v_mul_f32 v71, v71, v11
    v_cvt_pk_bf16_f32 v27, v70, v71
    ds_write_b128 v7, v[24:27] offset:256
    v_lshlrev_b32 v64, 16, v28
    v_and_b32 v65, 0xffff0000, v28
    v_sub_f32 v64, v64, v10
    v_sub_f32 v65, v65, v10
    v_mul_f32 v64, v64, v11
    v_mul_f32 v65, v65, v11
    v_cvt_pk_bf16_f32 v28, v64, v65
    v_lshlrev_b32 v66, 16, v29
    v_and_b32 v67, 0xffff0000, v29
    v_sub_f32 v66, v66, v10
    v_sub_f32 v67, v67, v10
    v_mul_f32 v66, v66, v11
    v_mul_f32 v67, v67, v11
    v_cvt_pk_bf16_f32 v29, v66, v67
    v_lshlrev_b32 v68, 16, v30
    v_and_b32 v69, 0xffff0000, v30
    v_sub_f32 v68, v68, v10
    v_sub_f32 v69, v69, v10
    v_mul_f32 v68, v68, v11
    v_mul_f32 v69, v69, v11
    v_cvt_pk_bf16_f32 v30, v68, v69
    v_lshlrev_b32 v70, 16, v31
    v_and_b32 v71, 0xffff0000, v31
    v_sub_f32 v70, v70, v10
    v_sub_f32 v71, v71, v10
    v_mul_f32 v70, v70, v11
    v_mul_f32 v71, v71, v11
    v_cvt_pk_bf16_f32 v31, v70, v71
    ds_write_b128 v7, v[28:31] offset:384
    v_lshlrev_b32 v64, 16, v32
    v_and_b32 v65, 0xffff0000, v32
    v_sub_f32 v64, v64, v10
    v_sub_f32 v65, v65, v10
    v_mul_f32 v64, v64, v11
    v_mul_f32 v65, v65, v11
    v_cvt_pk_bf16_f32 v32, v64, v65
    v_lshlrev_b32 v66, 16, v33
    v_and_b32 v67, 0xffff0000, v33
    v_sub_f32 v66, v66, v10
    v_sub_f32 v67, v67, v10
    v_mul_f32 v66, v66, v11
    v_mul_f32 v67, v67, v11
    v_cvt_pk_bf16_f32 v33, v66, v67
    v_lshlrev_b32 v68, 16, v34
    v_and_b32 v69, 0xffff0000, v34
    v_sub_f32 v68, v68, v10
    v_sub_f32 v69, v69, v10
    v_mul_f32 v68, v68, v11
    v_mul_f32 v69, v69, v11
    v_cvt_pk_bf16_f32 v34, v68, v69
    v_lshlrev_b32 v70, 16, v35
    v_and_b32 v71, 0xffff0000, v35
    v_sub_f32 v70, v70, v10
    v_sub_f32 v71, v71, v10
    v_mul_f32 v70, v70, v11
    v_mul_f32 v71, v71, v11
    v_cvt_pk_bf16_f32 v35, v70, v71
    ds_write_b128 v7, v[32:35] offset:512
    v_lshlrev_b32 v64, 16, v36
    v_and_b32 v65, 0xffff0000, v36
    v_sub_f32 v64, v64, v10
    v_sub_f32 v65, v65, v10
    v_mul_f32 v64, v64, v11
    v_mul_f32 v65, v65, v11
    v_cvt_pk_bf16_f32 v36, v64, v65
    v_lshlrev_b32 v66, 16, v37
    v_and_b32 v67, 0xffff0000, v37
    v_sub_f32 v66, v66, v10
    v_sub_f32 v67, v67, v10
    v_mul_f32 v66, v66, v11
    v_mul_f32 v67, v67, v11
    v_cvt_pk_bf16_f32 v37, v66, v67
    v_lshlrev_b32 v68, 16, v38
    v_and_b32 v69, 0xffff0000, v38
    v_sub_f32 v68, v68, v10
    v_sub_f32 v69, v69, v10
    v_mul_f32 v68, v68, v11
    v_mul_f32 v69, v69, v11
    v_cvt_pk_bf16_f32 v38, v68, v69
    v_lshlrev_b32 v70, 16, v39
    v_and_b32 v71, 0xffff0000, v39
    v_sub_f32 v70, v70, v10
    v_sub_f32 v71, v71, v10
    v_mul_f32 v70, v70, v11
    v_mul_f32 v71, v71, v11
    v_cvt_pk_bf16_f32 v39, v70, v71
    ds_write_b128 v7, v[36:39] offset:640
    v_lshlrev_b32 v64, 16, v40
    v_and_b32 v65, 0xffff0000, v40
    v_sub_f32 v64, v64, v10
    v_sub_f32 v65, v65, v10
    v_mul_f32 v64, v64, v11
    v_mul_f32 v65, v65, v11
    v_cvt_pk_bf16_f32 v40, v64, v65
    v_lshlrev_b32 v66, 16, v41
    v_and_b32 v67, 0xffff0000, v41
    v_sub_f32 v66, v66, v10
    v_sub_f32 v67, v67, v10
    v_mul_f32 v66, v66, v11
    v_mul_f32 v67, v67, v11
    v_cvt_pk_bf16_f32 v41, v66, v67
    v_lshlrev_b32 v68, 16, v42
    v_and_b32 v69, 0xffff0000, v42
    v_sub_f32 v68, v68, v10
    v_sub_f32 v69, v69, v10
    v_mul_f32 v68, v68, v11
    v_mul_f32 v69, v69, v11
    v_cvt_pk_bf16_f32 v42, v68, v69
    v_lshlrev_b32 v70, 16, v43
    v_and_b32 v71, 0xffff0000, v43
    v_sub_f32 v70, v70, v10
    v_sub_f32 v71, v71, v10
    v_mul_f32 v70, v70, v11
    v_mul_f32 v71, v71, v11
    v_cvt_pk_bf16_f32 v43, v70, v71
    ds_write_b128 v7, v[40:43] offset:768
    v_lshlrev_b32 v64, 16, v44
    v_and_b32 v65, 0xffff0000, v44
    v_sub_f32 v64, v64, v10
    v_sub_f32 v65, v65, v10
    v_mul_f32 v64, v64, v11
    v_mul_f32 v65, v65, v11
    v_cvt_pk_bf16_f32 v44, v64, v65
    v_lshlrev_b32 v66, 16, v45
    v_and_b32 v67, 0xffff0000, v45
    v_sub_f32 v66, v66, v10
    v_sub_f32 v67, v67, v10
    v_mul_f32 v66, v66, v11
    v_mul_f32 v67, v67, v11
    v_cvt_pk_bf16_f32 v45, v66, v67
    v_lshlrev_b32 v68, 16, v46
    v_and_b32 v69, 0xffff0000, v46
    v_sub_f32 v68, v68, v10
    v_sub_f32 v69, v69, v10
    v_mul_f32 v68, v68, v11
    v_mul_f32 v69, v69, v11
    v_cvt_pk_bf16_f32 v46, v68, v69
    v_lshlrev_b32 v70, 16, v47
    v_and_b32 v71, 0xffff0000, v47
    v_sub_f32 v70, v70, v10
    v_sub_f32 v71, v71, v10
    v_mul_f32 v70, v70, v11
    v_mul_f32 v71, v71, v11
    v_cvt_pk_bf16_f32 v47, v70, v71
    ds_write_b128 v7, v[44:47] offset:896
    v_lshlrev_b32 v64, 16, v48
    v_and_b32 v65, 0xffff0000, v48
    v_sub_f32 v64, v64, v10
    v_sub_f32 v65, v65, v10
    v_mul_f32 v64, v64, v11
    v_mul_f32 v65, v65, v11
    v_cvt_pk_bf16_f32 v48, v64, v65
    v_lshlrev_b32 v66, 16, v49
    v_and_b32 v67, 0xffff0000, v49
    v_sub_f32 v66, v66, v10
    v_sub_f32 v67, v67, v10
    v_mul_f32 v66, v66, v11
    v_mul_f32 v67, v67, v11
    v_cvt_pk_bf16_f32 v49, v66, v67
    v_lshlrev_b32 v68, 16, v50
    v_and_b32 v69, 0xffff0000, v50
    v_sub_f32 v68, v68, v10
    v_sub_f32 v69, v69, v10
    v_mul_f32 v68, v68, v11
    v_mul_f32 v69, v69, v11
    v_cvt_pk_bf16_f32 v50, v68, v69
    v_lshlrev_b32 v70, 16, v51
    v_and_b32 v71, 0xffff0000, v51
    v_sub_f32 v70, v70, v10
    v_sub_f32 v71, v71, v10
    v_mul_f32 v70, v70, v11
    v_mul_f32 v71, v71, v11
    v_cvt_pk_bf16_f32 v51, v70, v71
    ds_write_b128 v7, v[48:51] offset:1024
    v_lshlrev_b32 v64, 16, v52
    v_and_b32 v65, 0xffff0000, v52
    v_sub_f32 v64, v64, v10
    v_sub_f32 v65, v65, v10
    v_mul_f32 v64, v64, v11
    v_mul_f32 v65, v65, v11
    v_cvt_pk_bf16_f32 v52, v64, v65
    v_lshlrev_b32 v66, 16, v53
    v_and_b32 v67, 0xffff0000, v53
    v_sub_f32 v66, v66, v10
    v_sub_f32 v67, v67, v10
    v_mul_f32 v66, v66, v11
    v_mul_f32 v67, v67, v11
    v_cvt_pk_bf16_f32 v53, v66, v67
    v_lshlrev_b32 v68, 16, v54
    v_and_b32 v69, 0xffff0000, v54
    v_sub_f32 v68, v68, v10
    v_sub_f32 v69, v69, v10
    v_mul_f32 v68, v68, v11
    v_mul_f32 v69, v69, v11
    v_cvt_pk_bf16_f32 v54, v68, v69
    v_lshlrev_b32 v70, 16, v55
    v_and_b32 v71, 0xffff0000, v55
    v_sub_f32 v70, v70, v10
    v_sub_f32 v71, v71, v10
    v_mul_f32 v70, v70, v11
    v_mul_f32 v71, v71, v11
    v_cvt_pk_bf16_f32 v55, v70, v71
    ds_write_b128 v7, v[52:55] offset:1152
    s_waitcnt vmcnt(0) lgkmcnt(0)
    s_barrier
    v_and_b32 v12, 15, v1
    v_lshrrev_b32 v13, 2, v12
    v_lshrrev_b32 v14, 4, v1
    v_lshl_add_u32 v13, v14, 3, v13
    v_lshrrev_b32 v15, 1, v12
    v_xor_b32 v15, v15, v14
    v_and_b32 v15, 3, v15
    v_lshlrev_b32 v15, 4, v15
    v_lshl_add_u32 v15, v12, 6, v15
    v_mul_u32_u24 v14, 1344, v13
    v_and_b32 v12, 3, v12
    v_lshl_add_u32 v14, v12, 3, v14
    s_mul_i32 s5, s4, 320
    v_add_u32 v14, s5, v14
    s_mul_i32 s5, s4, 5120
    s_add_u32 s5, s5, 43008
    v_add_u32 v15, s5, v15
    v_lshlrev_b32 v8, 4, v1
    v_add_u32 v8, s5, v8
    v_lshrrev_b32 v12, 2, v1
    v_lshlrev_b32 v9, 6, v12
    v_lshrrev_b32 v12, 3, v1
    v_xor_b32 v12, v12, v1
    v_and_b32 v12, 3, v12
    v_lshl_add_u32 v9, v12, 4, v9
    s_mul_i32 s5, s3, 40960
    s_mul_i32 s6, s4, 10240
    s_add_u32 s5, s5, s6
    ds_read_b64_tr_b16 v[64:65], v14 offset:0
    ds_read_b64_tr_b16 v[66:67], v14 offset:5376
    ds_read_b64_tr_b16 v[68:69], v14 offset:32
    ds_read_b64_tr_b16 v[70:71], v14 offset:5408
    ds_read_b64_tr_b16 v[72:73], v14 offset:64
    ds_read_b64_tr_b16 v[74:75], v14 offset:5440
    ds_read_b64_tr_b16 v[76:77], v14 offset:96
    ds_read_b64_tr_b16 v[78:79], v14 offset:5472
    ds_read_b64_tr_b16 v[80:81], v14 offset:128
    ds_read_b64_tr_b16 v[82:83], v14 offset:5504
    s_waitcnt lgkmcnt(8)
    ds_write_b128 v15, v[64:67] offset:0
    s_waitcnt lgkmcnt(7)
    ds_write_b128 v15, v[68:71] offset:1024
    s_waitcnt lgkmcnt(6)
    ds_write_b128 v15, v[72:75] offset:2048
    s_waitcnt lgkmcnt(5)
    ds_write_b128 v15, v[76:79] offset:3072
    s_waitcnt lgkmcnt(4)
    ds_write_b128 v15, v[80:83] offset:4096
    s_waitcnt lgkmcnt(0)
    ds_read_b128 v[84:87], v8 offset:0
    ds_read_b128 v[88:91], v8 offset:1024
    ds_read_b128 v[92:95], v8 offset:2048
    ds_read_b128 v[96:99], v8 offset:3072
    ds_read_b128 v[100:103], v8 offset:4096
    s_waitcnt lgkmcnt(4)
    buffer_store_dwordx4 v[84:87], v9, s[16:19], s5 offen sc1
    s_add_u32 s5, s5, 1024
    s_waitcnt lgkmcnt(3)
    buffer_store_dwordx4 v[88:91], v9, s[16:19], s5 offen sc1
    s_add_u32 s5, s5, 1024
    s_waitcnt lgkmcnt(2)
    buffer_store_dwordx4 v[92:95], v9, s[16:19], s5 offen sc1
    s_add_u32 s5, s5, 1024
    s_waitcnt lgkmcnt(1)
    buffer_store_dwordx4 v[96:99], v9, s[16:19], s5 offen sc1
    s_add_u32 s5, s5, 1024
    s_waitcnt lgkmcnt(0)
    buffer_store_dwordx4 v[100:103], v9, s[16:19], s5 offen sc1
    s_add_u32 s5, s5, 1024
    ds_read_b64_tr_b16 v[104:105], v14 offset:160
    ds_read_b64_tr_b16 v[106:107], v14 offset:5536
    ds_read_b64_tr_b16 v[108:109], v14 offset:192
    ds_read_b64_tr_b16 v[110:111], v14 offset:5568
    ds_read_b64_tr_b16 v[112:113], v14 offset:224
    ds_read_b64_tr_b16 v[114:115], v14 offset:5600
    ds_read_b64_tr_b16 v[116:117], v14 offset:256
    ds_read_b64_tr_b16 v[118:119], v14 offset:5632
    ds_read_b64_tr_b16 v[120:121], v14 offset:288
    ds_read_b64_tr_b16 v[122:123], v14 offset:5664
    s_waitcnt lgkmcnt(8)
    ds_write_b128 v15, v[104:107] offset:0
    s_waitcnt lgkmcnt(7)
    ds_write_b128 v15, v[108:111] offset:1024
    s_waitcnt lgkmcnt(6)
    ds_write_b128 v15, v[112:115] offset:2048
    s_waitcnt lgkmcnt(5)
    ds_write_b128 v15, v[116:119] offset:3072
    s_waitcnt lgkmcnt(4)
    ds_write_b128 v15, v[120:123] offset:4096
    s_waitcnt lgkmcnt(0)
    ds_read_b128 v[124:127], v8 offset:0
    ds_read_b128 v[128:131], v8 offset:1024
    ds_read_b128 v[132:135], v8 offset:2048
    ds_read_b128 v[136:139], v8 offset:3072
    ds_read_b128 v[140:143], v8 offset:4096
    s_waitcnt lgkmcnt(4)
    buffer_store_dwordx4 v[124:127], v9, s[16:19], s5 offen sc1
    s_add_u32 s5, s5, 1024
    s_waitcnt lgkmcnt(3)
    buffer_store_dwordx4 v[128:131], v9, s[16:19], s5 offen sc1
    s_add_u32 s5, s5, 1024
    s_waitcnt lgkmcnt(2)
    buffer_store_dwordx4 v[132:135], v9, s[16:19], s5 offen sc1
    s_add_u32 s5, s5, 1024
    s_waitcnt lgkmcnt(1)
    buffer_store_dwordx4 v[136:139], v9, s[16:19], s5 offen sc1
    s_add_u32 s5, s5, 1024
    s_waitcnt lgkmcnt(0)
    buffer_store_dwordx4 v[140:143], v9, s[16:19], s5 offen sc1
    s_add_u32 s5, s5, 1024
    s_waitcnt vmcnt(0)
    s_barrier
    s_cmp_lg_u32 s4, 0
    s_cbranch_scc1 L_ln_nosig_13
    s_load_dwordx2 s[84:85], s[0:1], 88
    v_mov_b32 v12, 0
    s_mov_b32 s62, 0
    s_waitcnt lgkmcnt(0)
    s_mov_b32 s86, 256
    s_mov_b32 s87, 0x00020000
L_tag_14:
    buffer_load_dword v13, v12, s[84:87], 0 offen sc1
    s_waitcnt vmcnt(0)
    v_readfirstlane_b32 s61, v13
    s_nop 0
    s_cmp_lg_u32 s61, 0
    s_cbranch_scc1 L_tagged_15
    s_sleep 24
    s_add_u32 s62, s62, 1
    s_cmp_lt_u32 s62, 32768
    s_cbranch_scc1 L_tag_14
L_tagged_15:
    s_add_u32 s5, s3, 0
    s_lshl_b32 s60, s5, 7
    v_mov_b32 v12, 0
    v_mov_b32 v13, s61
    s_mov_b64 exec, 1
    buffer_store_dword v13, v12, s[80:83], s60 offen sc1
    s_mov_b64 exec, -1
L_ln_nosig_13:
    s_cmp_lt_u32 s2, 256
    s_cbranch_scc1 L_lna_exit_16
    s_load_dwordx2 s[84:85], s[0:1], 88
    v_mov_b32 v8, 0
    s_mov_b32 s62, 0
    s_waitcnt lgkmcnt(0)
    s_mov_b32 s86, 256
    s_mov_b32 s87, 0x00020000
L_tag_17:
    buffer_load_dword v9, v8, s[84:87], 0 offen sc1
    s_waitcnt vmcnt(0)
    v_readfirstlane_b32 s61, v9
    s_nop 0
    s_cmp_lg_u32 s61, 0
    s_cbranch_scc1 L_tagged_18
    s_sleep 24
    s_add_u32 s62, s62, 1
    s_cmp_lt_u32 s62, 32768
    s_cbranch_scc1 L_tag_17
L_tagged_18:
    s_mov_b32 s63, 0
    s_branch L_gemm2_entry
L_lna_exit_16:
    s_endpgm
L_role_k_1:
    s_sub_u32 s3, s2, 32
L_body_k_1:
    s_load_dwordx2 s[40:41], s[0:1], 8
    s_load_dwordx2 s[42:43], s[0:1], 16
    s_load_dwordx2 s[44:45], s[0:1], 24
    s_load_dwordx2 s[46:47], s[0:1], 32
    s_load_dwordx2 s[48:49], s[0:1], 40
    s_load_dwordx2 s[50:51], s[0:1], 96
    s_load_dwordx2 s[52:53], s[0:1], 48
    v_and_b32 v1, 63, v0
    v_lshrrev_b32 v2, 6, v0
    s_nop 0
    v_readfirstlane_b32 s4, v2
    s_and_b32 s6, s3, 7
    s_lshr_b32 s7, s3, 3
    s_mul_i32 s6, s6, 80
    s_mul_i32 s30, s7, 3
    s_sub_u32 s31, s7, 24
    s_max_i32 s31, s31, 0
    s_sub_u32 s30, s30, s31
    s_add_u32 s37, s6, s30
    s_add_u32 s5, s37, s4
    s_cmp_lt_u32 s7, 24
    s_cselect_b32 s38, 3, 2
    s_mul_i32 s33, s4, 21248
    s_lshl_b32 s28, s5, 8
    v_lshlrev_b32 v2, 2, v1
    s_lshl_b32 s6, s5, 1
    s_and_b32 s6, s6, 0xfffffffc
    s_min_u32 s6, s6, 1276
    s_waitcnt lgkmcnt(0)
    s_mov_b32 s8, s40
    s_mov_b32 s9, s41
    s_mov_b32 s10, 0x28000
    s_mov_b32 s11, 0x00020000
    s_mov_b32 s12, s42
    s_mov_b32 s13, s43
    s_mov_b32 s14, 0x28000
    s_mov_b32 s15, 0x00020000
    s_mov_b32 s16, s44
    s_mov_b32 s17, s45
    s_mov_b32 s18, 0x28000
    s_mov_b32 s19, 0x00020000
    s_mov_b32 s20, s46
    s_mov_b32 s21, s47
    s_mov_b32 s22, 0x28000
    s_mov_b32 s23, 0x00020000
    s_add_u32 s80, s50, 0x1400000
    s_addc_u32 s81, s51, 0
    s_mov_b32 s82, 0x17000
    s_mov_b32 s83, 0x00020000
    s_cmp_ge_u32 s4, s38
    s_cbranch_scc1 L_kc_prep_done_19
    buffer_load_dword v4, v2, s[8:11], s28 offen nt
    buffer_load_dword v5, v2, s[12:15], s28 offen nt
    buffer_load_dword v6, v2, s[16:19], s28 offen nt
    buffer_load_dword v7, v2, s[20:23], s28 offen nt
    s_load_dword s7, s[48:49], s6
    s_waitcnt lgkmcnt(0)
    s_and_b32 s30, s5, 1
    s_lshl_b32 s30, s30, 4
    s_lshr_b32 s7, s7, s30
    s_lshl_b32 s7, s7, 16
    v_mov_b32 v8, s7
    v_mul_f32 v8, 0x3fb8aa3b, v8
    v_exp_f32 v8, v8
    s_nop 0
    v_cvt_pk_bf16_f32 v8, v8, v8
    v_lshlrev_b32 v8, 16, v8
    v_add_f32 v10, v8, v8
    v_mul_u32_u24 v12, 96, v1
    v_add_u32 v12, s33, v12
    s_waitcnt vmcnt(0)
    v_lshlrev_b32 v48, 16, v4
    v_mul_f32 v48, 0x3fb8aa3b, v48
    v_exp_f32 v48, v48
    s_nop 0
    v_cvt_pk_bf16_f32 v48, v48, v48
    v_lshlrev_b32 v48, 16, v48
    v_mul_f32_e64 v48, -v48, v8
    v_mul_f32 v16, 0x3fb8aa3b, v48
    v_lshlrev_b32 v48, 16, v5
    v_mul_f32 v48, v48, v8
    v_mul_f32 v48, 0x3e22f983, v48
    v_rndne_f32 v49, v48
    v_sub_f32 v17, v48, v49
    v_lshlrev_b32 v48, 16, v6
    v_mul_f32 v18, v48, v10
    v_lshlrev_b32 v48, 16, v7
    v_mul_f32 v19, v48, v10
    v_mul_f32 v48, 0x43800000, v16
    v_exp_f32 v48, v48
    v_mul_f32 v49, 0x43800000, v17
    v_rndne_f32 v50, v49
    v_sub_f32 v49, v49, v50
    v_cos_f32 v50, v49
    v_sin_f32 v51, v49
    v_mul_f32 v52, v48, v50
    v_mul_f32 v53, v48, v51
    v_mul_f32 v20, v18, v52
    v_mul_f32 v21, v18, v53
    v_fma_f32 v20, -v19, v53, v20
    v_fma_f32 v21, v19, v52, v21
    v_mul_f32 v54, v53, v53
    v_mul_f32_e64 v53, v52, v53 mul:2
    v_fma_f32 v52, v52, v52, -v54
    v_mul_f32 v22, v18, v52
    v_mul_f32 v23, v18, v53
    v_fma_f32 v22, -v19, v53, v22
    v_fma_f32 v23, v19, v52, v23
    v_mul_f32 v54, v53, v53
    v_mul_f32_e64 v53, v52, v53 mul:2
    v_fma_f32 v52, v52, v52, -v54
    v_mul_f32 v24, v18, v52
    v_mul_f32 v25, v18, v53
    v_fma_f32 v24, -v19, v53, v24
    v_fma_f32 v25, v19, v52, v25
    v_mul_f32 v54, v53, v53
    v_mul_f32_e64 v53, v52, v53 mul:2
    v_fma_f32 v52, v52, v52, -v54
    v_mul_f32 v11, v18, v52
    v_fma_f32 v11, -v19, v53, v11
    v_mov_b32 v26, 0
    v_mov_b32 v27, 0
    ds_write_b128 v12, v[16:19] offset:0
    ds_write_b128 v12, v[20:23] offset:16
    ds_write_b128 v12, v[24:27] offset:32
    v_and_b32 v48, 0xffff0000, v4
    v_mul_f32 v48, 0x3fb8aa3b, v48
    v_exp_f32 v48, v48
    s_nop 0
    v_cvt_pk_bf16_f32 v48, v48, v48
    v_lshlrev_b32 v48, 16, v48
    v_mul_f32_e64 v48, -v48, v8
    v_mul_f32 v28, 0x3fb8aa3b, v48
    v_and_b32 v48, 0xffff0000, v5
    v_mul_f32 v48, v48, v8
    v_mul_f32 v48, 0x3e22f983, v48
    v_rndne_f32 v49, v48
    v_sub_f32 v29, v48, v49
    v_and_b32 v48, 0xffff0000, v6
    v_mul_f32 v30, v48, v10
    v_and_b32 v48, 0xffff0000, v7
    v_mul_f32 v31, v48, v10
    v_mul_f32 v48, 0x43800000, v28
    v_exp_f32 v48, v48
    v_mul_f32 v49, 0x43800000, v29
    v_rndne_f32 v50, v49
    v_sub_f32 v49, v49, v50
    v_cos_f32 v50, v49
    v_sin_f32 v51, v49
    v_mul_f32 v52, v48, v50
    v_mul_f32 v53, v48, v51
    v_mul_f32 v32, v30, v52
    v_mul_f32 v33, v30, v53
    v_fma_f32 v32, -v31, v53, v32
    v_fma_f32 v33, v31, v52, v33
    v_mul_f32 v54, v53, v53
    v_mul_f32_e64 v53, v52, v53 mul:2
    v_fma_f32 v52, v52, v52, -v54
    v_mul_f32 v34, v30, v52
    v_mul_f32 v35, v30, v53
    v_fma_f32 v34, -v31, v53, v34
    v_fma_f32 v35, v31, v52, v35
    v_mul_f32 v54, v53, v53
    v_mul_f32_e64 v53, v52, v53 mul:2
    v_fma_f32 v52, v52, v52, -v54
    v_mul_f32 v36, v30, v52
    v_mul_f32 v37, v30, v53
    v_fma_f32 v36, -v31, v53, v36
    v_fma_f32 v37, v31, v52, v37
    v_mul_f32 v54, v53, v53
    v_mul_f32_e64 v53, v52, v53 mul:2
    v_fma_f32 v52, v52, v52, -v54
    v_fmac_f32 v11, v30, v52
    v_fma_f32 v11, -v31, v53, v11
    v_mov_b32 v38, 0
    v_mov_b32 v39, 0
    ds_write_b128 v12, v[28:31] offset:48
    ds_write_b128 v12, v[32:35] offset:64
    ds_write_b128 v12, v[36:39] offset:80
    v_add_f32_dpp v11, v11, v11 quad_perm:[1,0,3,2] row_mask:0xf bank_mask:0xf
    s_nop 1
    v_add_f32_dpp v11, v11, v11 quad_perm:[2,3,0,1] row_mask:0xf bank_mask:0xf
    s_nop 1
    v_add_f32_dpp v11, v11, v11 row_half_mirror row_mask:0xf bank_mask:0xf
    s_nop 1
    v_add_f32_dpp v11, v11, v11 row_mirror row_mask:0xf bank_mask:0xf
    s_nop 0
    v_readlane_b32 s56, v11, 0
    v_readlane_b32 s57, v11, 16
    v_readlane_b32 s58, v11, 32
    v_readlane_b32 s59, v11, 48
    v_mov_b32 v11, s56
    v_add_f32 v11, s57, v11
    v_add_f32 v11, s58, v11
    v_add_f32 v11, s59, v11
L_kc_prep_done_19:
    v_and_b32 v9, 15, v1
    v_cvt_f32_u32 v13, v9
    v_lshrrev_b32 v9, 4, v1
    v_mul_u32_u24 v15, 192, v9
    s_waitcnt lgkmcnt(0)
    s_barrier
    v_lshlrev_b32 v2, 4, v1
    s_cmp_eq_u32 s4, 3
    s_cbranch_scc1 L_kc_help_20
    s_cmp_ge_u32 s4, s38
    s_cbranch_scc1 L_kc_bar2_21
    v_add_u32 v14, s33, v15
    ds_read_b128 v[64:67], v14 offset:0
    ds_read_b128 v[68:71], v14 offset:16
    ds_read_b64 v[72:73], v14 offset:32
    ds_read_b128 v[76:79], v14 offset:48
    ds_read_b128 v[80:83], v14 offset:64
    ds_read_b64 v[84:85], v14 offset:80
    ds_read_b128 v[88:91], v14 offset:96
    ds_read_b128 v[92:95], v14 offset:112
    ds_read_b64 v[96:97], v14 offset:128
    ds_read_b128 v[100:103], v14 offset:144
    ds_read_b128 v[104:107], v14 offset:160
    ds_read_b64 v[108:109], v14 offset:176
    ds_read_b128 v[112:115], v14 offset:768
    ds_read_b128 v[116:119], v14 offset:784
    ds_read_b64 v[120:121], v14 offset:800
    ds_read_b128 v[124:127], v14 offset:816
    ds_read_b128 v[128:131], v14 offset:832
    ds_read_b64 v[132:133], v14 offset:848
    ds_read_b128 v[136:139], v14 offset:864
    ds_read_b128 v[140:143], v14 offset:880
    ds_read_b64 v[144:145], v14 offset:896
    ds_read_b128 v[148:151], v14 offset:912
    ds_read_b128 v[152:155], v14 offset:928
    ds_read_b64 v[156:157], v14 offset:944
    s_waitcnt lgkmcnt(12)
    v_mul_f32 v168, v64, v13
    v_mul_f32 v169, v65, v13
    v_mul_f32 v172, v76, v13
    v_mul_f32 v173, v77, v13
    v_mul_f32 v176, v88, v13
    v_mul_f32 v177, v89, v13
    v_mul_f32 v180, v100, v13
    v_mul_f32 v181, v101, v13
    v_exp_f32 v168, v168
    v_cos_f32 v170, v169
    v_sin_f32 v171, v169
    v_exp_f32 v172, v172
    v_cos_f32 v174, v173
    v_sin_f32 v175, v173
    v_exp_f32 v176, v176
    v_cos_f32 v178, v177
    v_sin_f32 v179, v177
    v_exp_f32 v180, v180
    v_cos_f32 v182, v181
    v_sin_f32 v183, v181
    v_mul_f32 v160, v168, v170
    v_mul_f32 v161, v168, v171
    v_mul_f32 v162, v172, v174
    v_mul_f32 v163, v172, v175
    v_mul_f32 v164, v176, v178
    v_mul_f32 v165, v176, v179
    v_mul_f32 v166, v180, v182
    v_mul_f32 v167, v180, v183
    v_cvt_pk_bf16_f32 v200, v160, v161
    v_cvt_pk_bf16_f32 v201, v162, v163
    v_cvt_pk_bf16_f32 v202, v164, v165
    v_cvt_pk_bf16_f32 v203, v166, v167
    v_mul_f32 v168, v161, v161
    v_mul_f32_e64 v161, v160, v161 mul:2
    v_fma_f32 v160, v160, v160, -v168
    v_mul_f32 v172, v163, v163
    v_mul_f32_e64 v163, v162, v163 mul:2
    v_fma_f32 v162, v162, v162, -v172
    v_mul_f32 v176, v165, v165
    v_mul_f32_e64 v165, v164, v165 mul:2
    v_fma_f32 v164, v164, v164, -v176
    v_mul_f32 v180, v167, v167
    v_mul_f32_e64 v167, v166, v167 mul:2
    v_fma_f32 v166, v166, v166, -v180
    v_mul_f32 v168, v161, v161
    v_mul_f32_e64 v161, v160, v161 mul:2
    v_fma_f32 v160, v160, v160, -v168
    v_mul_f32 v172, v163, v163
    v_mul_f32_e64 v163, v162, v163 mul:2
    v_fma_f32 v162, v162, v162, -v172
    v_mul_f32 v176, v165, v165
    v_mul_f32_e64 v165, v164, v165 mul:2
    v_fma_f32 v164, v164, v164, -v176
    v_mul_f32 v180, v167, v167
    v_mul_f32_e64 v167, v166, v167 mul:2
    v_fma_f32 v166, v166, v166, -v180
    v_cvt_pk_bf16_f32 v204, v160, v161
    v_cvt_pk_bf16_f32 v205, v162, v163
    v_cvt_pk_bf16_f32 v206, v164, v165
    v_cvt_pk_bf16_f32 v207, v166, v167
    v_mul_f32 v168, v161, v161
    v_mul_f32_e64 v161, v160, v161 mul:2
    v_fma_f32 v160, v160, v160, -v168
    v_mul_f32 v172, v163, v163
    v_mul_f32_e64 v163, v162, v163 mul:2
    v_fma_f32 v162, v162, v162, -v172
    v_mul_f32 v176, v165, v165
    v_mul_f32_e64 v165, v164, v165 mul:2
    v_fma_f32 v164, v164, v164, -v176
    v_mul_f32 v180, v167, v167
    v_mul_f32_e64 v167, v166, v167 mul:2
    v_fma_f32 v166, v166, v166, -v180
    v_mul_f32 v168, v161, v161
    v_mul_f32_e64 v161, v160, v161 mul:2
    v_fma_f32 v160, v160, v160, -v168
    v_mul_f32 v172, v163, v163
    v_mul_f32_e64 v163, v162, v163 mul:2
    v_fma_f32 v162, v162, v162, -v172
    v_mul_f32 v176, v165, v165
    v_mul_f32_e64 v165, v164, v165 mul:2
    v_fma_f32 v164, v164, v164, -v176
    v_mul_f32 v180, v167, v167
    v_mul_f32_e64 v167, v166, v167 mul:2
    v_fma_f32 v166, v166, v166, -v180
    v_mul_f32 v168, v66, v160
    v_mul_f32_e64 v169, -v66, v161
    v_fma_f32 v168, -v67, v161, v168
    v_fma_f32 v169, -v67, v160, v169
    v_cvt_pk_bf16_f32 v184, v168, v169
    v_mul_f32 v172, v78, v162
    v_mul_f32_e64 v173, -v78, v163
    v_fma_f32 v172, -v79, v163, v172
    v_fma_f32 v173, -v79, v162, v173
    v_cvt_pk_bf16_f32 v185, v172, v173
    v_mul_f32 v176, v90, v164
    v_mul_f32_e64 v177, -v90, v165
    v_fma_f32 v176, -v91, v165, v176
    v_fma_f32 v177, -v91, v164, v177
    v_cvt_pk_bf16_f32 v186, v176, v177
    v_mul_f32 v180, v102, v166
    v_mul_f32_e64 v181, -v102, v167
    v_fma_f32 v180, -v103, v167, v180
    v_fma_f32 v181, -v103, v166, v181
    v_cvt_pk_bf16_f32 v187, v180, v181
    v_mul_f32 v168, v68, v160
    v_mul_f32_e64 v169, -v68, v161
    v_fma_f32 v168, -v69, v161, v168
    v_fma_f32 v169, -v69, v160, v169
    v_cvt_pk_bf16_f32 v188, v168, v169
    v_mul_f32 v172, v80, v162
    v_mul_f32_e64 v173, -v80, v163
    v_fma_f32 v172, -v81, v163, v172
    v_fma_f32 v173, -v81, v162, v173
    v_cvt_pk_bf16_f32 v189, v172, v173
    v_mul_f32 v176, v92, v164
    v_mul_f32_e64 v177, -v92, v165
    v_fma_f32 v176, -v93, v165, v176
    v_fma_f32 v177, -v93, v164, v177
    v_cvt_pk_bf16_f32 v190, v176, v177
    v_mul_f32 v180, v104, v166
    v_mul_f32_e64 v181, -v104, v167
    v_fma_f32 v180, -v105, v167, v180
    v_fma_f32 v181, -v105, v166, v181
    v_cvt_pk_bf16_f32 v191, v180, v181
    v_mfma_f32_16x16x32_bf16 v[208:211], v[184:187], v[200:203], 0
    v_mul_f32 v168, v161, v161
    v_mul_f32_e64 v161, v160, v161 mul:2
    v_fma_f32 v160, v160, v160, -v168
    v_mul_f32 v172, v163, v163
    v_mul_f32_e64 v163, v162, v163 mul:2
    v_fma_f32 v162, v162, v162, -v172
    v_mul_f32 v176, v165, v165
    v_mul_f32_e64 v165, v164, v165 mul:2
    v_fma_f32 v164, v164, v164, -v176
    v_mul_f32 v180, v167, v167
    v_mul_f32_e64 v167, v166, v167 mul:2
    v_fma_f32 v166, v166, v166, -v180
    v_mfma_f32_16x16x32_bf16 v[212:215], v[188:191], v[200:203], 0
    v_mul_f32 v168, v161, v161
    v_mul_f32_e64 v161, v160, v161 mul:2
    v_fma_f32 v160, v160, v160, -v168
    v_mul_f32 v172, v163, v163
    v_mul_f32_e64 v163, v162, v163 mul:2
    v_fma_f32 v162, v162, v162, -v172
    v_mul_f32 v176, v165, v165
    v_mul_f32_e64 v165, v164, v165 mul:2
    v_fma_f32 v164, v164, v164, -v176
    v_mul_f32 v180, v167, v167
    v_mul_f32_e64 v167, v166, v167 mul:2
    v_fma_f32 v166, v166, v166, -v180
    v_mul_f32 v168, v70, v160
    v_mul_f32_e64 v169, -v70, v161
    v_fma_f32 v168, -v71, v161, v168
    v_fma_f32 v169, -v71, v160, v169
    v_cvt_pk_bf16_f32 v192, v168, v169
    v_mul_f32 v172, v82, v162
    v_mul_f32_e64 v173, -v82, v163
    v_fma_f32 v172, -v83, v163, v172
    v_fma_f32 v173, -v83, v162, v173
    v_cvt_pk_bf16_f32 v193, v172, v173
    v_mul_f32 v176, v94, v164
    v_mul_f32_e64 v177, -v94, v165
    v_fma_f32 v176, -v95, v165, v176
    v_fma_f32 v177, -v95, v164, v177
    v_cvt_pk_bf16_f32 v194, v176, v177
    v_mul_f32 v180, v106, v166
    v_mul_f32_e64 v181, -v106, v167
    v_fma_f32 v180, -v107, v167, v180
    v_fma_f32 v181, -v107, v166, v181
    v_cvt_pk_bf16_f32 v195, v180, v181
    v_mul_f32 v168, v72, v160
    v_mul_f32_e64 v169, -v72, v161
    v_fma_f32 v168, -v73, v161, v168
    v_fma_f32 v169, -v73, v160, v169
    v_cvt_pk_bf16_f32 v196, v168, v169
    v_mul_f32 v172, v84, v162
    v_mul_f32_e64 v173, -v84, v163
    v_fma_f32 v172, -v85, v163, v172
    v_fma_f32 v173, -v85, v162, v173
    v_cvt_pk_bf16_f32 v197, v172, v173
    v_mul_f32 v176, v96, v164
    v_mul_f32_e64 v177, -v96, v165
    v_fma_f32 v176, -v97, v165, v176
    v_fma_f32 v177, -v97, v164, v177
    v_cvt_pk_bf16_f32 v198, v176, v177
    v_mul_f32 v180, v108, v166
    v_mul_f32_e64 v181, -v108, v167
    v_fma_f32 v180, -v109, v167, v180
    v_fma_f32 v181, -v109, v166, v181
    v_cvt_pk_bf16_f32 v199, v180, v181
    v_mfma_f32_16x16x32_bf16 v[216:219], v[192:195], v[204:207], 0
    s_nop 0
    v_mfma_f32_16x16x32_bf16 v[220:223], v[196:199], v[204:207], 0
    ds_read_b128 v[64:67], v14 offset:1536
    ds_read_b128 v[68:71], v14 offset:1552
    ds_read_b64 v[72:73], v14 offset:1568
    ds_read_b128 v[76:79], v14 offset:1584
    ds_read_b128 v[80:83], v14 offset:1600
    ds_read_b64 v[84:85], v14 offset:1616
    ds_read_b128 v[88:91], v14 offset:1632
    ds_read_b128 v[92:95], v14 offset:1648
    ds_read_b64 v[96:97], v14 offset:1664
    ds_read_b128 v[100:103], v14 offset:1680
    ds_read_b128 v[104:107], v14 offset:1696
    ds_read_b64 v[108:109], v14 offset:1712
    s_waitcnt lgkmcnt(12)
    v_mul_f32 v168, v112, v13
    v_mul_f32 v169, v113, v13
    v_mul_f32 v172, v124, v13
    v_mul_f32 v173, v125, v13
    v_mul_f32 v176, v136, v13
    v_mul_f32 v177, v137, v13
    v_mul_f32 v180, v148, v13
    v_mul_f32 v181, v149, v13
    v_exp_f32 v168, v168
    v_cos_f32 v170, v169
    v_sin_f32 v171, v169
    v_exp_f32 v172, v172
    v_cos_f32 v174, v173
    v_sin_f32 v175, v173
    v_exp_f32 v176, v176
    v_cos_f32 v178, v177
    v_sin_f32 v179, v177
    v_exp_f32 v180, v180
    v_cos_f32 v182, v181
    v_sin_f32 v183, v181
    v_mul_f32 v160, v168, v170
    v_mul_f32 v161, v168, v171
    v_mul_f32 v162, v172, v174
    v_mul_f32 v163, v172, v175
    v_mul_f32 v164, v176, v178
    v_mul_f32 v165, v176, v179
    v_mul_f32 v166, v180, v182
    v_mul_f32 v167, v180, v183
    v_cvt_pk_bf16_f32 v200, v160, v161
    v_cvt_pk_bf16_f32 v201, v162, v163
    v_cvt_pk_bf16_f32 v202, v164, v165
    v_cvt_pk_bf16_f32 v203, v166, v167
    v_mul_f32 v168, v161, v161
    v_mul_f32_e64 v161, v160, v161 mul:2
    v_fma_f32 v160, v160, v160, -v168
    v_mul_f32 v172, v163, v163
    v_mul_f32_e64 v163, v162, v163 mul:2
    v_fma_f32 v162, v162, v162, -v172
    v_mul_f32 v176, v165, v165
    v_mul_f32_e64 v165, v164, v165 mul:2
    v_fma_f32 v164, v164, v164, -v176
    v_mul_f32 v180, v167, v167
    v_mul_f32_e64 v167, v166, v167 mul:2
    v_fma_f32 v166, v166, v166, -v180
    v_mul_f32 v168, v161, v161
    v_mul_f32_e64 v161, v160, v161 mul:2
    v_fma_f32 v160, v160, v160, -v168
    v_mul_f32 v172, v163, v163
    v_mul_f32_e64 v163, v162, v163 mul:2
    v_fma_f32 v162, v162, v162, -v172
    v_mul_f32 v176, v165, v165
    v_mul_f32_e64 v165, v164, v165 mul:2
    v_fma_f32 v164, v164, v164, -v176
    v_mul_f32 v180, v167, v167
    v_mul_f32_e64 v167, v166, v167 mul:2
    v_fma_f32 v166, v166, v166, -v180
    v_cvt_pk_bf16_f32 v204, v160, v161
    v_cvt_pk_bf16_f32 v205, v162, v163
    v_cvt_pk_bf16_f32 v206, v164, v165
    v_cvt_pk_bf16_f32 v207, v166, v167
    v_mul_f32 v168, v161, v161
    v_mul_f32_e64 v161, v160, v161 mul:2
    v_fma_f32 v160, v160, v160, -v168
    v_mul_f32 v172, v163, v163
    v_mul_f32_e64 v163, v162, v163 mul:2
    v_fma_f32 v162, v162, v162, -v172
    v_mul_f32 v176, v165, v165
    v_mul_f32_e64 v165, v164, v165 mul:2
    v_fma_f32 v164, v164, v164, -v176
    v_mul_f32 v180, v167, v167
    v_mul_f32_e64 v167, v166, v167 mul:2
    v_fma_f32 v166, v166, v166, -v180
    v_mul_f32 v168, v161, v161
    v_mul_f32_e64 v161, v160, v161 mul:2
    v_fma_f32 v160, v160, v160, -v168
    v_mul_f32 v172, v163, v163
    v_mul_f32_e64 v163, v162, v163 mul:2
    v_fma_f32 v162, v162, v162, -v172
    v_mul_f32 v176, v165, v165
    v_mul_f32_e64 v165, v164, v165 mul:2
    v_fma_f32 v164, v164, v164, -v176
    v_mul_f32 v180, v167, v167
    v_mul_f32_e64 v167, v166, v167 mul:2
    v_fma_f32 v166, v166, v166, -v180
    v_mul_f32 v168, v114, v160
    v_mul_f32_e64 v169, -v114, v161
    v_fma_f32 v168, -v115, v161, v168
    v_fma_f32 v169, -v115, v160, v169
    v_cvt_pk_bf16_f32 v184, v168, v169
    v_mul_f32 v172, v126, v162
    v_mul_f32_e64 v173, -v126, v163
    v_fma_f32 v172, -v127, v163, v172
    v_fma_f32 v173, -v127, v162, v173
    v_cvt_pk_bf16_f32 v185, v172, v173
    v_mul_f32 v176, v138, v164
    v_mul_f32_e64 v177, -v138, v165
    v_fma_f32 v176, -v139, v165, v176
    v_fma_f32 v177, -v139, v164, v177
    v_cvt_pk_bf16_f32 v186, v176, v177
    v_mul_f32 v180, v150, v166
    v_mul_f32_e64 v181, -v150, v167
    v_fma_f32 v180, -v151, v167, v180
    v_fma_f32 v181, -v151, v166, v181
    v_cvt_pk_bf16_f32 v187, v180, v181
    v_mul_f32 v168, v116, v160
    v_mul_f32_e64 v169, -v116, v161
    v_fma_f32 v168, -v117, v161, v168
    v_fma_f32 v169, -v117, v160, v169
    v_cvt_pk_bf16_f32 v188, v168, v169
    v_mul_f32 v172, v128, v162
    v_mul_f32_e64 v173, -v128, v163
    v_fma_f32 v172, -v129, v163, v172
    v_fma_f32 v173, -v129, v162, v173
    v_cvt_pk_bf16_f32 v189, v172, v173
    v_mul_f32 v176, v140, v164
    v_mul_f32_e64 v177, -v140, v165
    v_fma_f32 v176, -v141, v165, v176
    v_fma_f32 v177, -v141, v164, v177
    v_cvt_pk_bf16_f32 v190, v176, v177
    v_mul_f32 v180, v152, v166
    v_mul_f32_e64 v181, -v152, v167
    v_fma_f32 v180, -v153, v167, v180
    v_fma_f32 v181, -v153, v166, v181
    v_cvt_pk_bf16_f32 v191, v180, v181
    v_mfma_f32_16x16x32_bf16 v[208:211], v[184:187], v[200:203], v[208:211]
    v_mul_f32 v168, v161, v161
    v_mul_f32_e64 v161, v160, v161 mul:2
    v_fma_f32 v160, v160, v160, -v168
    v_mul_f32 v172, v163, v163
    v_mul_f32_e64 v163, v162, v163 mul:2
    v_fma_f32 v162, v162, v162, -v172
    v_mul_f32 v176, v165, v165
    v_mul_f32_e64 v165, v164, v165 mul:2
    v_fma_f32 v164, v164, v164, -v176
    v_mul_f32 v180, v167, v167
    v_mul_f32_e64 v167, v166, v167 mul:2
    v_fma_f32 v166, v166, v166, -v180
    v_mfma_f32_16x16x32_bf16 v[212:215], v[188:191], v[200:203], v[212:215]
    v_mul_f32 v168, v161, v161
    v_mul_f32_e64 v161, v160, v161 mul:2
    v_fma_f32 v160, v160, v160, -v168
    v_mul_f32 v172, v163, v163
    v_mul_f32_e64 v163, v162, v163 mul:2
    v_fma_f32 v162, v162, v162, -v172
    v_mul_f32 v176, v165, v165
    v_mul_f32_e64 v165, v164, v165 mul:2
    v_fma_f32 v164, v164, v164, -v176
    v_mul_f32 v180, v167, v167
    v_mul_f32_e64 v167, v166, v167 mul:2
    v_fma_f32 v166, v166, v166, -v180
    v_mul_f32 v168, v118, v160
    v_mul_f32_e64 v169, -v118, v161
    v_fma_f32 v168, -v119, v161, v168
    v_fma_f32 v169, -v119, v160, v169
    v_cvt_pk_bf16_f32 v192, v168, v169
    v_mul_f32 v172, v130, v162
    v_mul_f32_e64 v173, -v130, v163
    v_fma_f32 v172, -v131, v163, v172
    v_fma_f32 v173, -v131, v162, v173
    v_cvt_pk_bf16_f32 v193, v172, v173
    v_mul_f32 v176, v142, v164
    v_mul_f32_e64 v177, -v142, v165
    v_fma_f32 v176, -v143, v165, v176
    v_fma_f32 v177, -v143, v164, v177
    v_cvt_pk_bf16_f32 v194, v176, v177
    v_mul_f32 v180, v154, v166
    v_mul_f32_e64 v181, -v154, v167
    v_fma_f32 v180, -v155, v167, v180
    v_fma_f32 v181, -v155, v166, v181
    v_cvt_pk_bf16_f32 v195, v180, v181
    v_mul_f32 v168, v120, v160
    v_mul_f32_e64 v169, -v120, v161
    v_fma_f32 v168, -v121, v161, v168
    v_fma_f32 v169, -v121, v160, v169
    v_cvt_pk_bf16_f32 v196, v168, v169
    v_mul_f32 v172, v132, v162
    v_mul_f32_e64 v173, -v132, v163
    v_fma_f32 v172, -v133, v163, v172
    v_fma_f32 v173, -v133, v162, v173
    v_cvt_pk_bf16_f32 v197, v172, v173
    v_mul_f32 v176, v144, v164
    v_mul_f32_e64 v177, -v144, v165
    v_fma_f32 v176, -v145, v165, v176
    v_fma_f32 v177, -v145, v164, v177
    v_cvt_pk_bf16_f32 v198, v176, v177
    v_mul_f32 v180, v156, v166
    v_mul_f32_e64 v181, -v156, v167
    v_fma_f32 v180, -v157, v167, v180
    v_fma_f32 v181, -v157, v166, v181
    v_cvt_pk_bf16_f32 v199, v180, v181
    v_mfma_f32_16x16x32_bf16 v[216:219], v[192:195], v[204:207], v[216:219]
    s_nop 0
    v_mfma_f32_16x16x32_bf16 v[220:223], v[196:199], v[204:207], v[220:223]
    ds_read_b128 v[112:115], v14 offset:2304
    ds_read_b128 v[116:119], v14 offset:2320
    ds_read_b64 v[120:121], v14 offset:2336
    ds_read_b128 v[124:127], v14 offset:2352
    ds_read_b128 v[128:131], v14 offset:2368
    ds_read_b64 v[132:133], v14 offset:2384
    ds_read_b128 v[136:139], v14 offset:2400
    ds_read_b128 v[140:143], v14 offset:2416
    ds_read_b64 v[144:145], v14 offset:2432
    ds_read_b128 v[148:151], v14 offset:2448
    ds_read_b128 v[152:155], v14 offset:2464
    ds_read_b64 v[156:157], v14 offset:2480
    s_waitcnt lgkmcnt(12)
    v_mul_f32 v168, v64, v13
    v_mul_f32 v169, v65, v13
    v_mul_f32 v172, v76, v13
    v_mul_f32 v173, v77, v13
    v_mul_f32 v176, v88, v13
    v_mul_f32 v177, v89, v13
    v_mul_f32 v180, v100, v13
    v_mul_f32 v181, v101, v13
    v_exp_f32 v168, v168
    v_cos_f32 v170, v169
    v_sin_f32 v171, v169
    v_exp_f32 v172, v172
    v_cos_f32 v174, v173
    v_sin_f32 v175, v173
    v_exp_f32 v176, v176
    v_cos_f32 v178, v177
    v_sin_f32 v179, v177
    v_exp_f32 v180, v180
    v_cos_f32 v182, v181
    v_sin_f32 v183, v181
    v_mul_f32 v160, v168, v170
    v_mul_f32 v161, v168, v171
    v_mul_f32 v162, v172, v174
    v_mul_f32 v163, v172, v175
    v_mul_f32 v164, v176, v178
    v_mul_f32 v165, v176, v179
    v_mul_f32 v166, v180, v182
    v_mul_f32 v167, v180, v183
    v_cvt_pk_bf16_f32 v200, v160, v161
    v_cvt_pk_bf16_f32 v201, v162, v163
    v_cvt_pk_bf16_f32 v202, v164, v165
    v_cvt_pk_bf16_f32 v203, v166, v167
    v_mul_f32 v168, v161, v161
    v_mul_f32_e64 v161, v160, v161 mul:2
    v_fma_f32 v160, v160, v160, -v168
    v_mul_f32 v172, v163, v163
    v_mul_f32_e64 v163, v162, v163 mul:2
    v_fma_f32 v162, v162, v162, -v172
    v_mul_f32 v176, v165, v165
    v_mul_f32_e64 v165, v164, v165 mul:2
    v_fma_f32 v164, v164, v164, -v176
    v_mul_f32 v180, v167, v167
    v_mul_f32_e64 v167, v166, v167 mul:2
    v_fma_f32 v166, v166, v166, -v180
    v_mul_f32 v168, v161, v161
    v_mul_f32_e64 v161, v160, v161 mul:2
    v_fma_f32 v160, v160, v160, -v168
    v_mul_f32 v172, v163, v163
    v_mul_f32_e64 v163, v162, v163 mul:2
    v_fma_f32 v162, v162, v162, -v172
    v_mul_f32 v176, v165, v165
    v_mul_f32_e64 v165, v164, v165 mul:2
    v_fma_f32 v164, v164, v164, -v176
    v_mul_f32 v180, v167, v167
    v_mul_f32_e64 v167, v166, v167 mul:2
    v_fma_f32 v166, v166, v166, -v180
    v_cvt_pk_bf16_f32 v204, v160, v161
    v_cvt_pk_bf16_f32 v205, v162, v163
    v_cvt_pk_bf16_f32 v206, v164, v165
    v_cvt_pk_bf16_f32 v207, v166, v167
    v_mul_f32 v168, v161, v161
    v_mul_f32_e64 v161, v160, v161 mul:2
    v_fma_f32 v160, v160, v160, -v168
    v_mul_f32 v172, v163, v163
    v_mul_f32_e64 v163, v162, v163 mul:2
    v_fma_f32 v162, v162, v162, -v172
    v_mul_f32 v176, v165, v165
    v_mul_f32_e64 v165, v164, v165 mul:2
    v_fma_f32 v164, v164, v164, -v176
    v_mul_f32 v180, v167, v167
    v_mul_f32_e64 v167, v166, v167 mul:2
    v_fma_f32 v166, v166, v166, -v180
    v_mul_f32 v168, v161, v161
    v_mul_f32_e64 v161, v160, v161 mul:2
    v_fma_f32 v160, v160, v160, -v168
    v_mul_f32 v172, v163, v163
    v_mul_f32_e64 v163, v162, v163 mul:2
    v_fma_f32 v162, v162, v162, -v172
    v_mul_f32 v176, v165, v165
    v_mul_f32_e64 v165, v164, v165 mul:2
    v_fma_f32 v164, v164, v164, -v176
    v_mul_f32 v180, v167, v167
    v_mul_f32_e64 v167, v166, v167 mul:2
    v_fma_f32 v166, v166, v166, -v180
    v_mul_f32 v168, v66, v160
    v_mul_f32_e64 v169, -v66, v161
    v_fma_f32 v168, -v67, v161, v168
    v_fma_f32 v169, -v67, v160, v169
    v_cvt_pk_bf16_f32 v184, v168, v169
    v_mul_f32 v172, v78, v162
    v_mul_f32_e64 v173, -v78, v163
    v_fma_f32 v172, -v79, v163, v172
    v_fma_f32 v173, -v79, v162, v173
    v_cvt_pk_bf16_f32 v185, v172, v173
    v_mul_f32 v176, v90, v164
    v_mul_f32_e64 v177, -v90, v165
    v_fma_f32 v176, -v91, v165, v176
    v_fma_f32 v177, -v91, v164, v177
    v_cvt_pk_bf16_f32 v186, v176, v177
    v_mul_f32 v180, v102, v166
    v_mul_f32_e64 v181, -v102, v167
    v_fma_f32 v180, -v103, v167, v180
    v_fma_f32 v181, -v103, v166, v181
    v_cvt_pk_bf16_f32 v187, v180, v181
    v_mul_f32 v168, v68, v160
    v_mul_f32_e64 v169, -v68, v161
    v_fma_f32 v168, -v69, v161, v168
    v_fma_f32 v169, -v69, v160, v169
    v_cvt_pk_bf16_f32 v188, v168, v169
    v_mul_f32 v172, v80, v162
    v_mul_f32_e64 v173, -v80, v163
    v_fma_f32 v172, -v81, v163, v172
    v_fma_f32 v173, -v81, v162, v173
    v_cvt_pk_bf16_f32 v189, v172, v173
    v_mul_f32 v176, v92, v164
    v_mul_f32_e64 v177, -v92, v165
    v_fma_f32 v176, -v93, v165, v176
    v_fma_f32 v177, -v93, v164, v177
    v_cvt_pk_bf16_f32 v190, v176, v177
    v_mul_f32 v180, v104, v166
    v_mul_f32_e64 v181, -v104, v167
    v_fma_f32 v180, -v105, v167, v180
    v_fma_f32 v181, -v105, v166, v181
    v_cvt_pk_bf16_f32 v191, v180, v181
    v_mfma_f32_16x16x32_bf16 v[208:211], v[184:187], v[200:203], v[208:211]
    v_mul_f32 v168, v161, v161
    v_mul_f32_e64 v161, v160, v161 mul:2
    v_fma_f32 v160, v160, v160, -v168
    v_mul_f32 v172, v163, v163
    v_mul_f32_e64 v163, v162, v163 mul:2
    v_fma_f32 v162, v162, v162, -v172
    v_mul_f32 v176, v165, v165
    v_mul_f32_e64 v165, v164, v165 mul:2
    v_fma_f32 v164, v164, v164, -v176
    v_mul_f32 v180, v167, v167
    v_mul_f32_e64 v167, v166, v167 mul:2
    v_fma_f32 v166, v166, v166, -v180
    v_mfma_f32_16x16x32_bf16 v[212:215], v[188:191], v[200:203], v[212:215]
    v_mul_f32 v168, v161, v161
    v_mul_f32_e64 v161, v160, v161 mul:2
    v_fma_f32 v160, v160, v160, -v168
    v_mul_f32 v172, v163, v163
    v_mul_f32_e64 v163, v162, v163 mul:2
    v_fma_f32 v162, v162, v162, -v172
    v_mul_f32 v176, v165, v165
    v_mul_f32_e64 v165, v164, v165 mul:2
    v_fma_f32 v164, v164, v164, -v176
    v_mul_f32 v180, v167, v167
    v_mul_f32_e64 v167, v166, v167 mul:2
    v_fma_f32 v166, v166, v166, -v180
    v_mul_f32 v168, v70, v160
    v_mul_f32_e64 v169, -v70, v161
    v_fma_f32 v168, -v71, v161, v168
    v_fma_f32 v169, -v71, v160, v169
    v_cvt_pk_bf16_f32 v192, v168, v169
    v_mul_f32 v172, v82, v162
    v_mul_f32_e64 v173, -v82, v163
    v_fma_f32 v172, -v83, v163, v172
    v_fma_f32 v173, -v83, v162, v173
    v_cvt_pk_bf16_f32 v193, v172, v173
    v_mul_f32 v176, v94, v164
    v_mul_f32_e64 v177, -v94, v165
    v_fma_f32 v176, -v95, v165, v176
    v_fma_f32 v177, -v95, v164, v177
    v_cvt_pk_bf16_f32 v194, v176, v177
    v_mul_f32 v180, v106, v166
    v_mul_f32_e64 v181, -v106, v167
    v_fma_f32 v180, -v107, v167, v180
    v_fma_f32 v181, -v107, v166, v181
    v_cvt_pk_bf16_f32 v195, v180, v181
    v_mul_f32 v168, v72, v160
    v_mul_f32_e64 v169, -v72, v161
    v_fma_f32 v168, -v73, v161, v168
    v_fma_f32 v169, -v73, v160, v169
    v_cvt_pk_bf16_f32 v196, v168, v169
    v_mul_f32 v172, v84, v162
    v_mul_f32_e64 v173, -v84, v163
    v_fma_f32 v172, -v85, v163, v172
    v_fma_f32 v173, -v85, v162, v173
    v_cvt_pk_bf16_f32 v197, v172, v173
    v_mul_f32 v176, v96, v164
    v_mul_f32_e64 v177, -v96, v165
    v_fma_f32 v176, -v97, v165, v176
    v_fma_f32 v177, -v97, v164, v177
    v_cvt_pk_bf16_f32 v198, v176, v177
    v_mul_f32 v180, v108, v166
    v_mul_f32_e64 v181, -v108, v167
    v_fma_f32 v180, -v109, v167, v180
    v_fma_f32 v181, -v109, v166, v181
    v_cvt_pk_bf16_f32 v199, v180, v181
    v_mfma_f32_16x16x32_bf16 v[216:219], v[192:195], v[204:207], v[216:219]
    s_nop 0
    v_mfma_f32_16x16x32_bf16 v[220:223], v[196:199], v[204:207], v[220:223]
    ds_read_b128 v[64:67], v14 offset:3072
    ds_read_b128 v[68:71], v14 offset:3088
    ds_read_b64 v[72:73], v14 offset:3104
    ds_read_b128 v[76:79], v14 offset:3120
    ds_read_b128 v[80:83], v14 offset:3136
    ds_read_b64 v[84:85], v14 offset:3152
    ds_read_b128 v[88:91], v14 offset:3168
    ds_read_b128 v[92:95], v14 offset:3184
    ds_read_b64 v[96:97], v14 offset:3200
    ds_read_b128 v[100:103], v14 offset:3216
    ds_read_b128 v[104:107], v14 offset:3232
    ds_read_b64 v[108:109], v14 offset:3248
    s_waitcnt lgkmcnt(12)
    v_mul_f32 v168, v112, v13
    v_mul_f32 v169, v113, v13
    v_mul_f32 v172, v124, v13
    v_mul_f32 v173, v125, v13
    v_mul_f32 v176, v136, v13
    v_mul_f32 v177, v137, v13
    v_mul_f32 v180, v148, v13
    v_mul_f32 v181, v149, v13
    v_exp_f32 v168, v168
    v_cos_f32 v170, v169
    v_sin_f32 v171, v169
    v_exp_f32 v172, v172
    v_cos_f32 v174, v173
    v_sin_f32 v175, v173
    v_exp_f32 v176, v176
    v_cos_f32 v178, v177
    v_sin_f32 v179, v177
    v_exp_f32 v180, v180
    v_cos_f32 v182, v181
    v_sin_f32 v183, v181
    v_mul_f32 v160, v168, v170
    v_mul_f32 v161, v168, v171
    v_mul_f32 v162, v172, v174
    v_mul_f32 v163, v172, v175
    v_mul_f32 v164, v176, v178
    v_mul_f32 v165, v176, v179
    v_mul_f32 v166, v180, v182
    v_mul_f32 v167, v180, v183
    v_cvt_pk_bf16_f32 v200, v160, v161
    v_cvt_pk_bf16_f32 v201, v162, v163
    v_cvt_pk_bf16_f32 v202, v164, v165
    v_cvt_pk_bf16_f32 v203, v166, v167
    v_mul_f32 v168, v161, v161
    v_mul_f32_e64 v161, v160, v161 mul:2
    v_fma_f32 v160, v160, v160, -v168
    v_mul_f32 v172, v163, v163
    v_mul_f32_e64 v163, v162, v163 mul:2
    v_fma_f32 v162, v162, v162, -v172
    v_mul_f32 v176, v165, v165
    v_mul_f32_e64 v165, v164, v165 mul:2
    v_fma_f32 v164, v164, v164, -v176
    v_mul_f32 v180, v167, v167
    v_mul_f32_e64 v167, v166, v167 mul:2
    v_fma_f32 v166, v166, v166, -v180
    v_mul_f32 v168, v161, v161
    v_mul_f32_e64 v161, v160, v161 mul:2
    v_fma_f32 v160, v160, v160, -v168
    v_mul_f32 v172, v163, v163
    v_mul_f32_e64 v163, v162, v163 mul:2
    v_fma_f32 v162, v162, v162, -v172
    v_mul_f32 v176, v165, v165
    v_mul_f32_e64 v165, v164, v165 mul:2
    v_fma_f32 v164, v164, v164, -v176
    v_mul_f32 v180, v167, v167
    v_mul_f32_e64 v167, v166, v167 mul:2
    v_fma_f32 v166, v166, v166, -v180
    v_cvt_pk_bf16_f32 v204, v160, v161
    v_cvt_pk_bf16_f32 v205, v162, v163
    v_cvt_pk_bf16_f32 v206, v164, v165
    v_cvt_pk_bf16_f32 v207, v166, v167
    v_mul_f32 v168, v161, v161
    v_mul_f32_e64 v161, v160, v161 mul:2
    v_fma_f32 v160, v160, v160, -v168
    v_mul_f32 v172, v163, v163
    v_mul_f32_e64 v163, v162, v163 mul:2
    v_fma_f32 v162, v162, v162, -v172
    v_mul_f32 v176, v165, v165
    v_mul_f32_e64 v165, v164, v165 mul:2
    v_fma_f32 v164, v164, v164, -v176
    v_mul_f32 v180, v167, v167
    v_mul_f32_e64 v167, v166, v167 mul:2
    v_fma_f32 v166, v166, v166, -v180
    v_mul_f32 v168, v161, v161
    v_mul_f32_e64 v161, v160, v161 mul:2
    v_fma_f32 v160, v160, v160, -v168
    v_mul_f32 v172, v163, v163
    v_mul_f32_e64 v163, v162, v163 mul:2
    v_fma_f32 v162, v162, v162, -v172
    v_mul_f32 v176, v165, v165
    v_mul_f32_e64 v165, v164, v165 mul:2
    v_fma_f32 v164, v164, v164, -v176
    v_mul_f32 v180, v167, v167
    v_mul_f32_e64 v167, v166, v167 mul:2
    v_fma_f32 v166, v166, v166, -v180
    v_mul_f32 v168, v114, v160
    v_mul_f32_e64 v169, -v114, v161
    v_fma_f32 v168, -v115, v161, v168
    v_fma_f32 v169, -v115, v160, v169
    v_cvt_pk_bf16_f32 v184, v168, v169
    v_mul_f32 v172, v126, v162
    v_mul_f32_e64 v173, -v126, v163
    v_fma_f32 v172, -v127, v163, v172
    v_fma_f32 v173, -v127, v162, v173
    v_cvt_pk_bf16_f32 v185, v172, v173
    v_mul_f32 v176, v138, v164
    v_mul_f32_e64 v177, -v138, v165
    v_fma_f32 v176, -v139, v165, v176
    v_fma_f32 v177, -v139, v164, v177
    v_cvt_pk_bf16_f32 v186, v176, v177
    v_mul_f32 v180, v150, v166
    v_mul_f32_e64 v181, -v150, v167
    v_fma_f32 v180, -v151, v167, v180
    v_fma_f32 v181, -v151, v166, v181
    v_cvt_pk_bf16_f32 v187, v180, v181
    v_mul_f32 v168, v116, v160
    v_mul_f32_e64 v169, -v116, v161
    v_fma_f32 v168, -v117, v161, v168
    v_fma_f32 v169, -v117, v160, v169
    v_cvt_pk_bf16_f32 v188, v168, v169
    v_mul_f32 v172, v128, v162
    v_mul_f32_e64 v173, -v128, v163
    v_fma_f32 v172, -v129, v163, v172
    v_fma_f32 v173, -v129, v162, v173
    v_cvt_pk_bf16_f32 v189, v172, v173
    v_mul_f32 v176, v140, v164
    v_mul_f32_e64 v177, -v140, v165
    v_fma_f32 v176, -v141, v165, v176
    v_fma_f32 v177, -v141, v164, v177
    v_cvt_pk_bf16_f32 v190, v176, v177
    v_mul_f32 v180, v152, v166
    v_mul_f32_e64 v181, -v152, v167
    v_fma_f32 v180, -v153, v167, v180
    v_fma_f32 v181, -v153, v166, v181
    v_cvt_pk_bf16_f32 v191, v180, v181
    v_mfma_f32_16x16x32_bf16 v[208:211], v[184:187], v[200:203], v[208:211]
    v_mul_f32 v168, v161, v161
    v_mul_f32_e64 v161, v160, v161 mul:2
    v_fma_f32 v160, v160, v160, -v168
    v_mul_f32 v172, v163, v163
    v_mul_f32_e64 v163, v162, v163 mul:2
    v_fma_f32 v162, v162, v162, -v172
    v_mul_f32 v176, v165, v165
    v_mul_f32_e64 v165, v164, v165 mul:2
    v_fma_f32 v164, v164, v164, -v176
    v_mul_f32 v180, v167, v167
    v_mul_f32_e64 v167, v166, v167 mul:2
    v_fma_f32 v166, v166, v166, -v180
    v_mfma_f32_16x16x32_bf16 v[212:215], v[188:191], v[200:203], v[212:215]
    v_mul_f32 v168, v161, v161
    v_mul_f32_e64 v161, v160, v161 mul:2
    v_fma_f32 v160, v160, v160, -v168
    v_mul_f32 v172, v163, v163
    v_mul_f32_e64 v163, v162, v163 mul:2
    v_fma_f32 v162, v162, v162, -v172
    v_mul_f32 v176, v165, v165
    v_mul_f32_e64 v165, v164, v165 mul:2
    v_fma_f32 v164, v164, v164, -v176
    v_mul_f32 v180, v167, v167
    v_mul_f32_e64 v167, v166, v167 mul:2
    v_fma_f32 v166, v166, v166, -v180
    v_mul_f32 v168, v118, v160
    v_mul_f32_e64 v169, -v118, v161
    v_fma_f32 v168, -v119, v161, v168
    v_fma_f32 v169, -v119, v160, v169
    v_cvt_pk_bf16_f32 v192, v168, v169
    v_mul_f32 v172, v130, v162
    v_mul_f32_e64 v173, -v130, v163
    v_fma_f32 v172, -v131, v163, v172
    v_fma_f32 v173, -v131, v162, v173
    v_cvt_pk_bf16_f32 v193, v172, v173
    v_mul_f32 v176, v142, v164
    v_mul_f32_e64 v177, -v142, v165
    v_fma_f32 v176, -v143, v165, v176
    v_fma_f32 v177, -v143, v164, v177
    v_cvt_pk_bf16_f32 v194, v176, v177
    v_mul_f32 v180, v154, v166
    v_mul_f32_e64 v181, -v154, v167
    v_fma_f32 v180, -v155, v167, v180
    v_fma_f32 v181, -v155, v166, v181
    v_cvt_pk_bf16_f32 v195, v180, v181
    v_mul_f32 v168, v120, v160
    v_mul_f32_e64 v169, -v120, v161
    v_fma_f32 v168, -v121, v161, v168
    v_fma_f32 v169, -v121, v160, v169
    v_cvt_pk_bf16_f32 v196, v168, v169
    v_mul_f32 v172, v132, v162
    v_mul_f32_e64 v173, -v132, v163
    v_fma_f32 v172, -v133, v163, v172
    v_fma_f32 v173, -v133, v162, v173
    v_cvt_pk_bf16_f32 v197, v172, v173
    v_mul_f32 v176, v144, v164
    v_mul_f32_e64 v177, -v144, v165
    v_fma_f32 v176, -v145, v165, v176
    v_fma_f32 v177, -v145, v164, v177
    v_cvt_pk_bf16_f32 v198, v176, v177
    v_mul_f32 v180, v156, v166
    v_mul_f32_e64 v181, -v156, v167
    v_fma_f32 v180, -v157, v167, v180
    v_fma_f32 v181, -v157, v166, v181
    v_cvt_pk_bf16_f32 v199, v180, v181
    v_mfma_f32_16x16x32_bf16 v[216:219], v[192:195], v[204:207], v[216:219]
    s_nop 0
    v_mfma_f32_16x16x32_bf16 v[220:223], v[196:199], v[204:207], v[220:223]
    ds_read_b128 v[112:115], v14 offset:3840
    ds_read_b128 v[116:119], v14 offset:3856
    ds_read_b64 v[120:121], v14 offset:3872
    ds_read_b128 v[124:127], v14 offset:3888
    ds_read_b128 v[128:131], v14 offset:3904
    ds_read_b64 v[132:133], v14 offset:3920
    ds_read_b128 v[136:139], v14 offset:3936
    ds_read_b128 v[140:143], v14 offset:3952
    ds_read_b64 v[144:145], v14 offset:3968
    ds_read_b128 v[148:151], v14 offset:3984
    ds_read_b128 v[152:155], v14 offset:4000
    ds_read_b64 v[156:157], v14 offset:4016
    s_waitcnt lgkmcnt(12)
    v_mul_f32 v168, v64, v13
    v_mul_f32 v169, v65, v13
    v_mul_f32 v172, v76, v13
    v_mul_f32 v173, v77, v13
    v_mul_f32 v176, v88, v13
    v_mul_f32 v177, v89, v13
    v_mul_f32 v180, v100, v13
    v_mul_f32 v181, v101, v13
    v_exp_f32 v168, v168
    v_cos_f32 v170, v169
    v_sin_f32 v171, v169
    v_exp_f32 v172, v172
    v_cos_f32 v174, v173
    v_sin_f32 v175, v173
    v_exp_f32 v176, v176
    v_cos_f32 v178, v177
    v_sin_f32 v179, v177
    v_exp_f32 v180, v180
    v_cos_f32 v182, v181
    v_sin_f32 v183, v181
    v_mul_f32 v160, v168, v170
    v_mul_f32 v161, v168, v171
    v_mul_f32 v162, v172, v174
    v_mul_f32 v163, v172, v175
    v_mul_f32 v164, v176, v178
    v_mul_f32 v165, v176, v179
    v_mul_f32 v166, v180, v182
    v_mul_f32 v167, v180, v183
    v_cvt_pk_bf16_f32 v200, v160, v161
    v_cvt_pk_bf16_f32 v201, v162, v163
    v_cvt_pk_bf16_f32 v202, v164, v165
    v_cvt_pk_bf16_f32 v203, v166, v167
    v_mul_f32 v168, v161, v161
    v_mul_f32_e64 v161, v160, v161 mul:2
    v_fma_f32 v160, v160, v160, -v168
    v_mul_f32 v172, v163, v163
    v_mul_f32_e64 v163, v162, v163 mul:2
    v_fma_f32 v162, v162, v162, -v172
    v_mul_f32 v176, v165, v165
    v_mul_f32_e64 v165, v164, v165 mul:2
    v_fma_f32 v164, v164, v164, -v176
    v_mul_f32 v180, v167, v167
    v_mul_f32_e64 v167, v166, v167 mul:2
    v_fma_f32 v166, v166, v166, -v180
    v_mul_f32 v168, v161, v161
    v_mul_f32_e64 v161, v160, v161 mul:2
    v_fma_f32 v160, v160, v160, -v168
    v_mul_f32 v172, v163, v163
    v_mul_f32_e64 v163, v162, v163 mul:2
    v_fma_f32 v162, v162, v162, -v172
    v_mul_f32 v176, v165, v165
    v_mul_f32_e64 v165, v164, v165 mul:2
    v_fma_f32 v164, v164, v164, -v176
    v_mul_f32 v180, v167, v167
    v_mul_f32_e64 v167, v166, v167 mul:2
    v_fma_f32 v166, v166, v166, -v180
    v_cvt_pk_bf16_f32 v204, v160, v161
    v_cvt_pk_bf16_f32 v205, v162, v163
    v_cvt_pk_bf16_f32 v206, v164, v165
    v_cvt_pk_bf16_f32 v207, v166, v167
    v_mul_f32 v168, v161, v161
    v_mul_f32_e64 v161, v160, v161 mul:2
    v_fma_f32 v160, v160, v160, -v168
    v_mul_f32 v172, v163, v163
    v_mul_f32_e64 v163, v162, v163 mul:2
    v_fma_f32 v162, v162, v162, -v172
    v_mul_f32 v176, v165, v165
    v_mul_f32_e64 v165, v164, v165 mul:2
    v_fma_f32 v164, v164, v164, -v176
    v_mul_f32 v180, v167, v167
    v_mul_f32_e64 v167, v166, v167 mul:2
    v_fma_f32 v166, v166, v166, -v180
    v_mul_f32 v168, v161, v161
    v_mul_f32_e64 v161, v160, v161 mul:2
    v_fma_f32 v160, v160, v160, -v168
    v_mul_f32 v172, v163, v163
    v_mul_f32_e64 v163, v162, v163 mul:2
    v_fma_f32 v162, v162, v162, -v172
    v_mul_f32 v176, v165, v165
    v_mul_f32_e64 v165, v164, v165 mul:2
    v_fma_f32 v164, v164, v164, -v176
    v_mul_f32 v180, v167, v167
    v_mul_f32_e64 v167, v166, v167 mul:2
    v_fma_f32 v166, v166, v166, -v180
    v_mul_f32 v168, v66, v160
    v_mul_f32_e64 v169, -v66, v161
    v_fma_f32 v168, -v67, v161, v168
    v_fma_f32 v169, -v67, v160, v169
    v_cvt_pk_bf16_f32 v184, v168, v169
    v_mul_f32 v172, v78, v162
    v_mul_f32_e64 v173, -v78, v163
    v_fma_f32 v172, -v79, v163, v172
    v_fma_f32 v173, -v79, v162, v173
    v_cvt_pk_bf16_f32 v185, v172, v173
    v_mul_f32 v176, v90, v164
    v_mul_f32_e64 v177, -v90, v165
    v_fma_f32 v176, -v91, v165, v176
    v_fma_f32 v177, -v91, v164, v177
    v_cvt_pk_bf16_f32 v186, v176, v177
    v_mul_f32 v180, v102, v166
    v_mul_f32_e64 v181, -v102, v167
    v_fma_f32 v180, -v103, v167, v180
    v_fma_f32 v181, -v103, v166, v181
    v_cvt_pk_bf16_f32 v187, v180, v181
    v_mul_f32 v168, v68, v160
    v_mul_f32_e64 v169, -v68, v161
    v_fma_f32 v168, -v69, v161, v168
    v_fma_f32 v169, -v69, v160, v169
    v_cvt_pk_bf16_f32 v188, v168, v169
    v_mul_f32 v172, v80, v162
    v_mul_f32_e64 v173, -v80, v163
    v_fma_f32 v172, -v81, v163, v172
    v_fma_f32 v173, -v81, v162, v173
    v_cvt_pk_bf16_f32 v189, v172, v173
    v_mul_f32 v176, v92, v164
    v_mul_f32_e64 v177, -v92, v165
    v_fma_f32 v176, -v93, v165, v176
    v_fma_f32 v177, -v93, v164, v177
    v_cvt_pk_bf16_f32 v190, v176, v177
    v_mul_f32 v180, v104, v166
    v_mul_f32_e64 v181, -v104, v167
    v_fma_f32 v180, -v105, v167, v180
    v_fma_f32 v181, -v105, v166, v181
    v_cvt_pk_bf16_f32 v191, v180, v181
    v_mfma_f32_16x16x32_bf16 v[208:211], v[184:187], v[200:203], v[208:211]
    v_mul_f32 v168, v161, v161
    v_mul_f32_e64 v161, v160, v161 mul:2
    v_fma_f32 v160, v160, v160, -v168
    v_mul_f32 v172, v163, v163
    v_mul_f32_e64 v163, v162, v163 mul:2
    v_fma_f32 v162, v162, v162, -v172
    v_mul_f32 v176, v165, v165
    v_mul_f32_e64 v165, v164, v165 mul:2
    v_fma_f32 v164, v164, v164, -v176
    v_mul_f32 v180, v167, v167
    v_mul_f32_e64 v167, v166, v167 mul:2
    v_fma_f32 v166, v166, v166, -v180
    v_mfma_f32_16x16x32_bf16 v[212:215], v[188:191], v[200:203], v[212:215]
    v_mul_f32 v168, v161, v161
    v_mul_f32_e64 v161, v160, v161 mul:2
    v_fma_f32 v160, v160, v160, -v168
    v_mul_f32 v172, v163, v163
    v_mul_f32_e64 v163, v162, v163 mul:2
    v_fma_f32 v162, v162, v162, -v172
    v_mul_f32 v176, v165, v165
    v_mul_f32_e64 v165, v164, v165 mul:2
    v_fma_f32 v164, v164, v164, -v176
    v_mul_f32 v180, v167, v167
    v_mul_f32_e64 v167, v166, v167 mul:2
    v_fma_f32 v166, v166, v166, -v180
    v_mul_f32 v168, v70, v160
    v_mul_f32_e64 v169, -v70, v161
    v_fma_f32 v168, -v71, v161, v168
    v_fma_f32 v169, -v71, v160, v169
    v_cvt_pk_bf16_f32 v192, v168, v169
    v_mul_f32 v172, v82, v162
    v_mul_f32_e64 v173, -v82, v163
    v_fma_f32 v172, -v83, v163, v172
    v_fma_f32 v173, -v83, v162, v173
    v_cvt_pk_bf16_f32 v193, v172, v173
    v_mul_f32 v176, v94, v164
    v_mul_f32_e64 v177, -v94, v165
    v_fma_f32 v176, -v95, v165, v176
    v_fma_f32 v177, -v95, v164, v177
    v_cvt_pk_bf16_f32 v194, v176, v177
    v_mul_f32 v180, v106, v166
    v_mul_f32_e64 v181, -v106, v167
    v_fma_f32 v180, -v107, v167, v180
    v_fma_f32 v181, -v107, v166, v181
    v_cvt_pk_bf16_f32 v195, v180, v181
    v_mul_f32 v168, v72, v160
    v_mul_f32_e64 v169, -v72, v161
    v_fma_f32 v168, -v73, v161, v168
    v_fma_f32 v169, -v73, v160, v169
    v_cvt_pk_bf16_f32 v196, v168, v169
    v_mul_f32 v172, v84, v162
    v_mul_f32_e64 v173, -v84, v163
    v_fma_f32 v172, -v85, v163, v172
    v_fma_f32 v173, -v85, v162, v173
    v_cvt_pk_bf16_f32 v197, v172, v173
    v_mul_f32 v176, v96, v164
    v_mul_f32_e64 v177, -v96, v165
    v_fma_f32 v176, -v97, v165, v176
    v_fma_f32 v177, -v97, v164, v177
    v_cvt_pk_bf16_f32 v198, v176, v177
    v_mul_f32 v180, v108, v166
    v_mul_f32_e64 v181, -v108, v167
    v_fma_f32 v180, -v109, v167, v180
    v_fma_f32 v181, -v109, v166, v181
    v_cvt_pk_bf16_f32 v199, v180, v181
    v_mfma_f32_16x16x32_bf16 v[216:219], v[192:195], v[204:207], v[216:219]
    s_nop 0
    v_mfma_f32_16x16x32_bf16 v[220:223], v[196:199], v[204:207], v[220:223]
    ds_read_b128 v[64:67], v14 offset:4608
    ds_read_b128 v[68:71], v14 offset:4624
    ds_read_b64 v[72:73], v14 offset:4640
    ds_read_b128 v[76:79], v14 offset:4656
    ds_read_b128 v[80:83], v14 offset:4672
    ds_read_b64 v[84:85], v14 offset:4688
    ds_read_b128 v[88:91], v14 offset:4704
    ds_read_b128 v[92:95], v14 offset:4720
    ds_read_b64 v[96:97], v14 offset:4736
    ds_read_b128 v[100:103], v14 offset:4752
    ds_read_b128 v[104:107], v14 offset:4768
    ds_read_b64 v[108:109], v14 offset:4784
    s_waitcnt lgkmcnt(12)
    v_mul_f32 v168, v112, v13
    v_mul_f32 v169, v113, v13
    v_mul_f32 v172, v124, v13
    v_mul_f32 v173, v125, v13
    v_mul_f32 v176, v136, v13
    v_mul_f32 v177, v137, v13
    v_mul_f32 v180, v148, v13
    v_mul_f32 v181, v149, v13
    v_exp_f32 v168, v168
    v_cos_f32 v170, v169
    v_sin_f32 v171, v169
    v_exp_f32 v172, v172
    v_cos_f32 v174, v173
    v_sin_f32 v175, v173
    v_exp_f32 v176, v176
    v_cos_f32 v178, v177
    v_sin_f32 v179, v177
    v_exp_f32 v180, v180
    v_cos_f32 v182, v181
    v_sin_f32 v183, v181
    v_mul_f32 v160, v168, v170
    v_mul_f32 v161, v168, v171
    v_mul_f32 v162, v172, v174
    v_mul_f32 v163, v172, v175
    v_mul_f32 v164, v176, v178
    v_mul_f32 v165, v176, v179
    v_mul_f32 v166, v180, v182
    v_mul_f32 v167, v180, v183
    v_cvt_pk_bf16_f32 v200, v160, v161
    v_cvt_pk_bf16_f32 v201, v162, v163
    v_cvt_pk_bf16_f32 v202, v164, v165
    v_cvt_pk_bf16_f32 v203, v166, v167
    v_mul_f32 v168, v161, v161
    v_mul_f32_e64 v161, v160, v161 mul:2
    v_fma_f32 v160, v160, v160, -v168
    v_mul_f32 v172, v163, v163
    v_mul_f32_e64 v163, v162, v163 mul:2
    v_fma_f32 v162, v162, v162, -v172
    v_mul_f32 v176, v165, v165
    v_mul_f32_e64 v165, v164, v165 mul:2
    v_fma_f32 v164, v164, v164, -v176
    v_mul_f32 v180, v167, v167
    v_mul_f32_e64 v167, v166, v167 mul:2
    v_fma_f32 v166, v166, v166, -v180
    v_mul_f32 v168, v161, v161
    v_mul_f32_e64 v161, v160, v161 mul:2
    v_fma_f32 v160, v160, v160, -v168
    v_mul_f32 v172, v163, v163
    v_mul_f32_e64 v163, v162, v163 mul:2
    v_fma_f32 v162, v162, v162, -v172
    v_mul_f32 v176, v165, v165
    v_mul_f32_e64 v165, v164, v165 mul:2
    v_fma_f32 v164, v164, v164, -v176
    v_mul_f32 v180, v167, v167
    v_mul_f32_e64 v167, v166, v167 mul:2
    v_fma_f32 v166, v166, v166, -v180
    v_cvt_pk_bf16_f32 v204, v160, v161
    v_cvt_pk_bf16_f32 v205, v162, v163
    v_cvt_pk_bf16_f32 v206, v164, v165
    v_cvt_pk_bf16_f32 v207, v166, v167
    v_mul_f32 v168, v161, v161
    v_mul_f32_e64 v161, v160, v161 mul:2
    v_fma_f32 v160, v160, v160, -v168
    v_mul_f32 v172, v163, v163
    v_mul_f32_e64 v163, v162, v163 mul:2
    v_fma_f32 v162, v162, v162, -v172
    v_mul_f32 v176, v165, v165
    v_mul_f32_e64 v165, v164, v165 mul:2
    v_fma_f32 v164, v164, v164, -v176
    v_mul_f32 v180, v167, v167
    v_mul_f32_e64 v167, v166, v167 mul:2
    v_fma_f32 v166, v166, v166, -v180
    v_mul_f32 v168, v161, v161
    v_mul_f32_e64 v161, v160, v161 mul:2
    v_fma_f32 v160, v160, v160, -v168
    v_mul_f32 v172, v163, v163
    v_mul_f32_e64 v163, v162, v163 mul:2
    v_fma_f32 v162, v162, v162, -v172
    v_mul_f32 v176, v165, v165
    v_mul_f32_e64 v165, v164, v165 mul:2
    v_fma_f32 v164, v164, v164, -v176
    v_mul_f32 v180, v167, v167
    v_mul_f32_e64 v167, v166, v167 mul:2
    v_fma_f32 v166, v166, v166, -v180
    v_mul_f32 v168, v114, v160
    v_mul_f32_e64 v169, -v114, v161
    v_fma_f32 v168, -v115, v161, v168
    v_fma_f32 v169, -v115, v160, v169
    v_cvt_pk_bf16_f32 v184, v168, v169
    v_mul_f32 v172, v126, v162
    v_mul_f32_e64 v173, -v126, v163
    v_fma_f32 v172, -v127, v163, v172
    v_fma_f32 v173, -v127, v162, v173
    v_cvt_pk_bf16_f32 v185, v172, v173
    v_mul_f32 v176, v138, v164
    v_mul_f32_e64 v177, -v138, v165
    v_fma_f32 v176, -v139, v165, v176
    v_fma_f32 v177, -v139, v164, v177
    v_cvt_pk_bf16_f32 v186, v176, v177
    v_mul_f32 v180, v150, v166
    v_mul_f32_e64 v181, -v150, v167
    v_fma_f32 v180, -v151, v167, v180
    v_fma_f32 v181, -v151, v166, v181
    v_cvt_pk_bf16_f32 v187, v180, v181
    v_mul_f32 v168, v116, v160
    v_mul_f32_e64 v169, -v116, v161
    v_fma_f32 v168, -v117, v161, v168
    v_fma_f32 v169, -v117, v160, v169
    v_cvt_pk_bf16_f32 v188, v168, v169
    v_mul_f32 v172, v128, v162
    v_mul_f32_e64 v173, -v128, v163
    v_fma_f32 v172, -v129, v163, v172
    v_fma_f32 v173, -v129, v162, v173
    v_cvt_pk_bf16_f32 v189, v172, v173
    v_mul_f32 v176, v140, v164
    v_mul_f32_e64 v177, -v140, v165
    v_fma_f32 v176, -v141, v165, v176
    v_fma_f32 v177, -v141, v164, v177
    v_cvt_pk_bf16_f32 v190, v176, v177
    v_mul_f32 v180, v152, v166
    v_mul_f32_e64 v181, -v152, v167
    v_fma_f32 v180, -v153, v167, v180
    v_fma_f32 v181, -v153, v166, v181
    v_cvt_pk_bf16_f32 v191, v180, v181
    v_mfma_f32_16x16x32_bf16 v[208:211], v[184:187], v[200:203], v[208:211]
    v_mul_f32 v168, v161, v161
    v_mul_f32_e64 v161, v160, v161 mul:2
    v_fma_f32 v160, v160, v160, -v168
    v_mul_f32 v172, v163, v163
    v_mul_f32_e64 v163, v162, v163 mul:2
    v_fma_f32 v162, v162, v162, -v172
    v_mul_f32 v176, v165, v165
    v_mul_f32_e64 v165, v164, v165 mul:2
    v_fma_f32 v164, v164, v164, -v176
    v_mul_f32 v180, v167, v167
    v_mul_f32_e64 v167, v166, v167 mul:2
    v_fma_f32 v166, v166, v166, -v180
    v_mfma_f32_16x16x32_bf16 v[212:215], v[188:191], v[200:203], v[212:215]
    v_mul_f32 v168, v161, v161
    v_mul_f32_e64 v161, v160, v161 mul:2
    v_fma_f32 v160, v160, v160, -v168
    v_mul_f32 v172, v163, v163
    v_mul_f32_e64 v163, v162, v163 mul:2
    v_fma_f32 v162, v162, v162, -v172
    v_mul_f32 v176, v165, v165
    v_mul_f32_e64 v165, v164, v165 mul:2
    v_fma_f32 v164, v164, v164, -v176
    v_mul_f32 v180, v167, v167
    v_mul_f32_e64 v167, v166, v167 mul:2
    v_fma_f32 v166, v166, v166, -v180
    v_mul_f32 v168, v118, v160
    v_mul_f32_e64 v169, -v118, v161
    v_fma_f32 v168, -v119, v161, v168
    v_fma_f32 v169, -v119, v160, v169
    v_cvt_pk_bf16_f32 v192, v168, v169
    v_mul_f32 v172, v130, v162
    v_mul_f32_e64 v173, -v130, v163
    v_fma_f32 v172, -v131, v163, v172
    v_fma_f32 v173, -v131, v162, v173
    v_cvt_pk_bf16_f32 v193, v172, v173
    v_mul_f32 v176, v142, v164
    v_mul_f32_e64 v177, -v142, v165
    v_fma_f32 v176, -v143, v165, v176
    v_fma_f32 v177, -v143, v164, v177
    v_cvt_pk_bf16_f32 v194, v176, v177
    v_mul_f32 v180, v154, v166
    v_mul_f32_e64 v181, -v154, v167
    v_fma_f32 v180, -v155, v167, v180
    v_fma_f32 v181, -v155, v166, v181
    v_cvt_pk_bf16_f32 v195, v180, v181
    v_mul_f32 v168, v120, v160
    v_mul_f32_e64 v169, -v120, v161
    v_fma_f32 v168, -v121, v161, v168
    v_fma_f32 v169, -v121, v160, v169
    v_cvt_pk_bf16_f32 v196, v168, v169
    v_mul_f32 v172, v132, v162
    v_mul_f32_e64 v173, -v132, v163
    v_fma_f32 v172, -v133, v163, v172
    v_fma_f32 v173, -v133, v162, v173
    v_cvt_pk_bf16_f32 v197, v172, v173
    v_mul_f32 v176, v144, v164
    v_mul_f32_e64 v177, -v144, v165
    v_fma_f32 v176, -v145, v165, v176
    v_fma_f32 v177, -v145, v164, v177
    v_cvt_pk_bf16_f32 v198, v176, v177
    v_mul_f32 v180, v156, v166
    v_mul_f32_e64 v181, -v156, v167
    v_fma_f32 v180, -v157, v167, v180
    v_fma_f32 v181, -v157, v166, v181
    v_cvt_pk_bf16_f32 v199, v180, v181
    v_mfma_f32_16x16x32_bf16 v[216:219], v[192:195], v[204:207], v[216:219]
    s_nop 0
    v_mfma_f32_16x16x32_bf16 v[220:223], v[196:199], v[204:207], v[220:223]
    s_waitcnt lgkmcnt(0)
    v_mul_f32 v168, v64, v13
    v_mul_f32 v169, v65, v13
    v_mul_f32 v172, v76, v13
    v_mul_f32 v173, v77, v13
    v_mul_f32 v176, v88, v13
    v_mul_f32 v177, v89, v13
    v_mul_f32 v180, v100, v13
    v_mul_f32 v181, v101, v13
    v_exp_f32 v168, v168
    v_cos_f32 v170, v169
    v_sin_f32 v171, v169
    v_exp_f32 v172, v172
    v_cos_f32 v174, v173
    v_sin_f32 v175, v173
    v_exp_f32 v176, v176
    v_cos_f32 v178, v177
    v_sin_f32 v179, v177
    v_exp_f32 v180, v180
    v_cos_f32 v182, v181
    v_sin_f32 v183, v181
    v_mul_f32 v160, v168, v170
    v_mul_f32 v161, v168, v171
    v_mul_f32 v162, v172, v174
    v_mul_f32 v163, v172, v175
    v_mul_f32 v164, v176, v178
    v_mul_f32 v165, v176, v179
    v_mul_f32 v166, v180, v182
    v_mul_f32 v167, v180, v183
    v_cvt_pk_bf16_f32 v200, v160, v161
    v_cvt_pk_bf16_f32 v201, v162, v163
    v_cvt_pk_bf16_f32 v202, v164, v165
    v_cvt_pk_bf16_f32 v203, v166, v167
    v_mul_f32 v168, v161, v161
    v_mul_f32_e64 v161, v160, v161 mul:2
    v_fma_f32 v160, v160, v160, -v168
    v_mul_f32 v172, v163, v163
    v_mul_f32_e64 v163, v162, v163 mul:2
    v_fma_f32 v162, v162, v162, -v172
    v_mul_f32 v176, v165, v165
    v_mul_f32_e64 v165, v164, v165 mul:2
    v_fma_f32 v164, v164, v164, -v176
    v_mul_f32 v180, v167, v167
    v_mul_f32_e64 v167, v166, v167 mul:2
    v_fma_f32 v166, v166, v166, -v180
    v_mul_f32 v168, v161, v161
    v_mul_f32_e64 v161, v160, v161 mul:2
    v_fma_f32 v160, v160, v160, -v168
    v_mul_f32 v172, v163, v163
    v_mul_f32_e64 v163, v162, v163 mul:2
    v_fma_f32 v162, v162, v162, -v172
    v_mul_f32 v176, v165, v165
    v_mul_f32_e64 v165, v164, v165 mul:2
    v_fma_f32 v164, v164, v164, -v176
    v_mul_f32 v180, v167, v167
    v_mul_f32_e64 v167, v166, v167 mul:2
    v_fma_f32 v166, v166, v166, -v180
    v_cvt_pk_bf16_f32 v204, v160, v161
    v_cvt_pk_bf16_f32 v205, v162, v163
    v_cvt_pk_bf16_f32 v206, v164, v165
    v_cvt_pk_bf16_f32 v207, v166, v167
    v_mul_f32 v168, v161, v161
    v_mul_f32_e64 v161, v160, v161 mul:2
    v_fma_f32 v160, v160, v160, -v168
    v_mul_f32 v172, v163, v163
    v_mul_f32_e64 v163, v162, v163 mul:2
    v_fma_f32 v162, v162, v162, -v172
    v_mul_f32 v176, v165, v165
    v_mul_f32_e64 v165, v164, v165 mul:2
    v_fma_f32 v164, v164, v164, -v176
    v_mul_f32 v180, v167, v167
    v_mul_f32_e64 v167, v166, v167 mul:2
    v_fma_f32 v166, v166, v166, -v180
    v_mul_f32 v168, v161, v161
    v_mul_f32_e64 v161, v160, v161 mul:2
    v_fma_f32 v160, v160, v160, -v168
    v_mul_f32 v172, v163, v163
    v_mul_f32_e64 v163, v162, v163 mul:2
    v_fma_f32 v162, v162, v162, -v172
    v_mul_f32 v176, v165, v165
    v_mul_f32_e64 v165, v164, v165 mul:2
    v_fma_f32 v164, v164, v164, -v176
    v_mul_f32 v180, v167, v167
    v_mul_f32_e64 v167, v166, v167 mul:2
    v_fma_f32 v166, v166, v166, -v180
    v_mul_f32 v168, v66, v160
    v_mul_f32_e64 v169, -v66, v161
    v_fma_f32 v168, -v67, v161, v168
    v_fma_f32 v169, -v67, v160, v169
    v_cvt_pk_bf16_f32 v184, v168, v169
    v_mul_f32 v172, v78, v162
    v_mul_f32_e64 v173, -v78, v163
    v_fma_f32 v172, -v79, v163, v172
    v_fma_f32 v173, -v79, v162, v173
    v_cvt_pk_bf16_f32 v185, v172, v173
    v_mul_f32 v176, v90, v164
    v_mul_f32_e64 v177, -v90, v165
    v_fma_f32 v176, -v91, v165, v176
    v_fma_f32 v177, -v91, v164, v177
    v_cvt_pk_bf16_f32 v186, v176, v177
    v_mul_f32 v180, v102, v166
    v_mul_f32_e64 v181, -v102, v167
    v_fma_f32 v180, -v103, v167, v180
    v_fma_f32 v181, -v103, v166, v181
    v_cvt_pk_bf16_f32 v187, v180, v181
    v_mul_f32 v168, v68, v160
    v_mul_f32_e64 v169, -v68, v161
    v_fma_f32 v168, -v69, v161, v168
    v_fma_f32 v169, -v69, v160, v169
    v_cvt_pk_bf16_f32 v188, v168, v169
    v_mul_f32 v172, v80, v162
    v_mul_f32_e64 v173, -v80, v163
    v_fma_f32 v172, -v81, v163, v172
    v_fma_f32 v173, -v81, v162, v173
    v_cvt_pk_bf16_f32 v189, v172, v173
    v_mul_f32 v176, v92, v164
    v_mul_f32_e64 v177, -v92, v165
    v_fma_f32 v176, -v93, v165, v176
    v_fma_f32 v177, -v93, v164, v177
    v_cvt_pk_bf16_f32 v190, v176, v177
    v_mul_f32 v180, v104, v166
    v_mul_f32_e64 v181, -v104, v167
    v_fma_f32 v180, -v105, v167, v180
    v_fma_f32 v181, -v105, v166, v181
    v_cvt_pk_bf16_f32 v191, v180, v181
    v_mfma_f32_16x16x32_bf16 v[208:211], v[184:187], v[200:203], v[208:211]
    v_mul_f32 v168, v161, v161
    v_mul_f32_e64 v161, v160, v161 mul:2
    v_fma_f32 v160, v160, v160, -v168
    v_mul_f32 v172, v163, v163
    v_mul_f32_e64 v163, v162, v163 mul:2
    v_fma_f32 v162, v162, v162, -v172
    v_mul_f32 v176, v165, v165
    v_mul_f32_e64 v165, v164, v165 mul:2
    v_fma_f32 v164, v164, v164, -v176
    v_mul_f32 v180, v167, v167
    v_mul_f32_e64 v167, v166, v167 mul:2
    v_fma_f32 v166, v166, v166, -v180
    v_mfma_f32_16x16x32_bf16 v[212:215], v[188:191], v[200:203], v[212:215]
    v_mul_f32 v168, v161, v161
    v_mul_f32_e64 v161, v160, v161 mul:2
    v_fma_f32 v160, v160, v160, -v168
    v_mul_f32 v172, v163, v163
    v_mul_f32_e64 v163, v162, v163 mul:2
    v_fma_f32 v162, v162, v162, -v172
    v_mul_f32 v176, v165, v165
    v_mul_f32_e64 v165, v164, v165 mul:2
    v_fma_f32 v164, v164, v164, -v176
    v_mul_f32 v180, v167, v167
    v_mul_f32_e64 v167, v166, v167 mul:2
    v_fma_f32 v166, v166, v166, -v180
    v_mul_f32 v168, v70, v160
    v_mul_f32_e64 v169, -v70, v161
    v_fma_f32 v168, -v71, v161, v168
    v_fma_f32 v169, -v71, v160, v169
    v_cvt_pk_bf16_f32 v192, v168, v169
    v_mul_f32 v172, v82, v162
    v_mul_f32_e64 v173, -v82, v163
    v_fma_f32 v172, -v83, v163, v172
    v_fma_f32 v173, -v83, v162, v173
    v_cvt_pk_bf16_f32 v193, v172, v173
    v_mul_f32 v176, v94, v164
    v_mul_f32_e64 v177, -v94, v165
    v_fma_f32 v176, -v95, v165, v176
    v_fma_f32 v177, -v95, v164, v177
    v_cvt_pk_bf16_f32 v194, v176, v177
    v_mul_f32 v180, v106, v166
    v_mul_f32_e64 v181, -v106, v167
    v_fma_f32 v180, -v107, v167, v180
    v_fma_f32 v181, -v107, v166, v181
    v_cvt_pk_bf16_f32 v195, v180, v181
    v_mul_f32 v168, v72, v160
    v_mul_f32_e64 v169, -v72, v161
    v_fma_f32 v168, -v73, v161, v168
    v_fma_f32 v169, -v73, v160, v169
    v_cvt_pk_bf16_f32 v196, v168, v169
    v_mul_f32 v172, v84, v162
    v_mul_f32_e64 v173, -v84, v163
    v_fma_f32 v172, -v85, v163, v172
    v_fma_f32 v173, -v85, v162, v173
    v_cvt_pk_bf16_f32 v197, v172, v173
    v_mul_f32 v176, v96, v164
    v_mul_f32_e64 v177, -v96, v165
    v_fma_f32 v176, -v97, v165, v176
    v_fma_f32 v177, -v97, v164, v177
    v_cvt_pk_bf16_f32 v198, v176, v177
    v_mul_f32 v180, v108, v166
    v_mul_f32_e64 v181, -v108, v167
    v_fma_f32 v180, -v109, v167, v180
    v_fma_f32 v181, -v109, v166, v181
    v_cvt_pk_bf16_f32 v199, v180, v181
    v_mfma_f32_16x16x32_bf16 v[216:219], v[192:195], v[204:207], v[216:219]
    s_nop 0
    v_mfma_f32_16x16x32_bf16 v[220:223], v[196:199], v[204:207], v[220:223]
    s_branch L_kc_bar2_21
L_kc_help_20:
    v_add_u32 v14, 0, v15
    ds_read_b128 v[64:67], v14 offset:5376
    ds_read_b128 v[68:71], v14 offset:5392
    ds_read_b64 v[72:73], v14 offset:5408
    ds_read_b128 v[76:79], v14 offset:5424
    ds_read_b128 v[80:83], v14 offset:5440
    ds_read_b64 v[84:85], v14 offset:5456
    ds_read_b128 v[88:91], v14 offset:5472
    ds_read_b128 v[92:95], v14 offset:5488
    ds_read_b64 v[96:97], v14 offset:5504
    ds_read_b128 v[100:103], v14 offset:5520
    ds_read_b128 v[104:107], v14 offset:5536
    ds_read_b64 v[108:109], v14 offset:5552
    s_waitcnt lgkmcnt(0)
    v_mul_f32 v168, v64, v13
    v_mul_f32 v169, v65, v13
    v_mul_f32 v172, v76, v13
    v_mul_f32 v173, v77, v13
    v_mul_f32 v176, v88, v13
    v_mul_f32 v177, v89, v13
    v_mul_f32 v180, v100, v13
    v_mul_f32 v181, v101, v13
    v_exp_f32 v168, v168
    v_cos_f32 v170, v169
    v_sin_f32 v171, v169
    v_exp_f32 v172, v172
    v_cos_f32 v174, v173
    v_sin_f32 v175, v173
    v_exp_f32 v176, v176
    v_cos_f32 v178, v177
    v_sin_f32 v179, v177
    v_exp_f32 v180, v180
    v_cos_f32 v182, v181
    v_sin_f32 v183, v181
    v_mul_f32 v160, v168, v170
    v_mul_f32 v161, v168, v171
    v_mul_f32 v162, v172, v174
    v_mul_f32 v163, v172, v175
    v_mul_f32 v164, v176, v178
    v_mul_f32 v165, v176, v179
    v_mul_f32 v166, v180, v182
    v_mul_f32 v167, v180, v183
    v_cvt_pk_bf16_f32 v200, v160, v161
    v_cvt_pk_bf16_f32 v201, v162, v163
    v_cvt_pk_bf16_f32 v202, v164, v165
    v_cvt_pk_bf16_f32 v203, v166, v167
    v_mul_f32 v168, v161, v161
    v_mul_f32_e64 v161, v160, v161 mul:2
    v_fma_f32 v160, v160, v160, -v168
    v_mul_f32 v172, v163, v163
    v_mul_f32_e64 v163, v162, v163 mul:2
    v_fma_f32 v162, v162, v162, -v172
    v_mul_f32 v176, v165, v165
    v_mul_f32_e64 v165, v164, v165 mul:2
    v_fma_f32 v164, v164, v164, -v176
    v_mul_f32 v180, v167, v167
    v_mul_f32_e64 v167, v166, v167 mul:2
    v_fma_f32 v166, v166, v166, -v180
    v_mul_f32 v168, v161, v161
    v_mul_f32_e64 v161, v160, v161 mul:2
    v_fma_f32 v160, v160, v160, -v168
    v_mul_f32 v172, v163, v163
    v_mul_f32_e64 v163, v162, v163 mul:2
    v_fma_f32 v162, v162, v162, -v172
    v_mul_f32 v176, v165, v165
    v_mul_f32_e64 v165, v164, v165 mul:2
    v_fma_f32 v164, v164, v164, -v176
    v_mul_f32 v180, v167, v167
    v_mul_f32_e64 v167, v166, v167 mul:2
    v_fma_f32 v166, v166, v166, -v180
    v_cvt_pk_bf16_f32 v204, v160, v161
    v_cvt_pk_bf16_f32 v205, v162, v163
    v_cvt_pk_bf16_f32 v206, v164, v165
    v_cvt_pk_bf16_f32 v207, v166, v167
    v_mul_f32 v168, v161, v161
    v_mul_f32_e64 v161, v160, v161 mul:2
    v_fma_f32 v160, v160, v160, -v168
    v_mul_f32 v172, v163, v163
    v_mul_f32_e64 v163, v162, v163 mul:2
    v_fma_f32 v162, v162, v162, -v172
    v_mul_f32 v176, v165, v165
    v_mul_f32_e64 v165, v164, v165 mul:2
    v_fma_f32 v164, v164, v164, -v176
    v_mul_f32 v180, v167, v167
    v_mul_f32_e64 v167, v166, v167 mul:2
    v_fma_f32 v166, v166, v166, -v180
    v_mul_f32 v168, v161, v161
    v_mul_f32_e64 v161, v160, v161 mul:2
    v_fma_f32 v160, v160, v160, -v168
    v_mul_f32 v172, v163, v163
    v_mul_f32_e64 v163, v162, v163 mul:2
    v_fma_f32 v162, v162, v162, -v172
    v_mul_f32 v176, v165, v165
    v_mul_f32_e64 v165, v164, v165 mul:2
    v_fma_f32 v164, v164, v164, -v176
    v_mul_f32 v180, v167, v167
    v_mul_f32_e64 v167, v166, v167 mul:2
    v_fma_f32 v166, v166, v166, -v180
    v_mul_f32 v168, v66, v160
    v_mul_f32_e64 v169, -v66, v161
    v_fma_f32 v168, -v67, v161, v168
    v_fma_f32 v169, -v67, v160, v169
    v_cvt_pk_bf16_f32 v184, v168, v169
    v_mul_f32 v172, v78, v162
    v_mul_f32_e64 v173, -v78, v163
    v_fma_f32 v172, -v79, v163, v172
    v_fma_f32 v173, -v79, v162, v173
    v_cvt_pk_bf16_f32 v185, v172, v173
    v_mul_f32 v176, v90, v164
    v_mul_f32_e64 v177, -v90, v165
    v_fma_f32 v176, -v91, v165, v176
    v_fma_f32 v177, -v91, v164, v177
    v_cvt_pk_bf16_f32 v186, v176, v177
    v_mul_f32 v180, v102, v166
    v_mul_f32_e64 v181, -v102, v167
    v_fma_f32 v180, -v103, v167, v180
    v_fma_f32 v181, -v103, v166, v181
    v_cvt_pk_bf16_f32 v187, v180, v181
    v_mul_f32 v168, v68, v160
    v_mul_f32_e64 v169, -v68, v161
    v_fma_f32 v168, -v69, v161, v168
    v_fma_f32 v169, -v69, v160, v169
    v_cvt_pk_bf16_f32 v188, v168, v169
    v_mul_f32 v172, v80, v162
    v_mul_f32_e64 v173, -v80, v163
    v_fma_f32 v172, -v81, v163, v172
    v_fma_f32 v173, -v81, v162, v173
    v_cvt_pk_bf16_f32 v189, v172, v173
    v_mul_f32 v176, v92, v164
    v_mul_f32_e64 v177, -v92, v165
    v_fma_f32 v176, -v93, v165, v176
    v_fma_f32 v177, -v93, v164, v177
    v_cvt_pk_bf16_f32 v190, v176, v177
    v_mul_f32 v180, v104, v166
    v_mul_f32_e64 v181, -v104, v167
    v_fma_f32 v180, -v105, v167, v180
    v_fma_f32 v181, -v105, v166, v181
    v_cvt_pk_bf16_f32 v191, v180, v181
    v_mfma_f32_16x16x32_bf16 v[208:211], v[184:187], v[200:203], 0
    v_mul_f32 v168, v161, v161
    v_mul_f32_e64 v161, v160, v161 mul:2
    v_fma_f32 v160, v160, v160, -v168
    v_mul_f32 v172, v163, v163
    v_mul_f32_e64 v163, v162, v163 mul:2
    v_fma_f32 v162, v162, v162, -v172
    v_mul_f32 v176, v165, v165
    v_mul_f32_e64 v165, v164, v165 mul:2
    v_fma_f32 v164, v164, v164, -v176
    v_mul_f32 v180, v167, v167
    v_mul_f32_e64 v167, v166, v167 mul:2
    v_fma_f32 v166, v166, v166, -v180
    v_mfma_f32_16x16x32_bf16 v[212:215], v[188:191], v[200:203], 0
    v_mul_f32 v168, v161, v161
    v_mul_f32_e64 v161, v160, v161 mul:2
    v_fma_f32 v160, v160, v160, -v168
    v_mul_f32 v172, v163, v163
    v_mul_f32_e64 v163, v162, v163 mul:2
    v_fma_f32 v162, v162, v162, -v172
    v_mul_f32 v176, v165, v165
    v_mul_f32_e64 v165, v164, v165 mul:2
    v_fma_f32 v164, v164, v164, -v176
    v_mul_f32 v180, v167, v167
    v_mul_f32_e64 v167, v166, v167 mul:2
    v_fma_f32 v166, v166, v166, -v180
    v_mul_f32 v168, v70, v160
    v_mul_f32_e64 v169, -v70, v161
    v_fma_f32 v168, -v71, v161, v168
    v_fma_f32 v169, -v71, v160, v169
    v_cvt_pk_bf16_f32 v192, v168, v169
    v_mul_f32 v172, v82, v162
    v_mul_f32_e64 v173, -v82, v163
    v_fma_f32 v172, -v83, v163, v172
    v_fma_f32 v173, -v83, v162, v173
    v_cvt_pk_bf16_f32 v193, v172, v173
    v_mul_f32 v176, v94, v164
    v_mul_f32_e64 v177, -v94, v165
    v_fma_f32 v176, -v95, v165, v176
    v_fma_f32 v177, -v95, v164, v177
    v_cvt_pk_bf16_f32 v194, v176, v177
    v_mul_f32 v180, v106, v166
    v_mul_f32_e64 v181, -v106, v167
    v_fma_f32 v180, -v107, v167, v180
    v_fma_f32 v181, -v107, v166, v181
    v_cvt_pk_bf16_f32 v195, v180, v181
    v_mul_f32 v168, v72, v160
    v_mul_f32_e64 v169, -v72, v161
    v_fma_f32 v168, -v73, v161, v168
    v_fma_f32 v169, -v73, v160, v169
    v_cvt_pk_bf16_f32 v196, v168, v169
    v_mul_f32 v172, v84, v162
    v_mul_f32_e64 v173, -v84, v163
    v_fma_f32 v172, -v85, v163, v172
    v_fma_f32 v173, -v85, v162, v173
    v_cvt_pk_bf16_f32 v197, v172, v173
    v_mul_f32 v176, v96, v164
    v_mul_f32_e64 v177, -v96, v165
    v_fma_f32 v176, -v97, v165, v176
    v_fma_f32 v177, -v97, v164, v177
    v_cvt_pk_bf16_f32 v198, v176, v177
    v_mul_f32 v180, v108, v166
    v_mul_f32_e64 v181, -v108, v167
    v_fma_f32 v180, -v109, v167, v180
    v_fma_f32 v181, -v109, v166, v181
    v_cvt_pk_bf16_f32 v199, v180, v181
    v_mfma_f32_16x16x32_bf16 v[216:219], v[192:195], v[204:207], 0
    s_nop 0
    v_mfma_f32_16x16x32_bf16 v[220:223], v[196:199], v[204:207], 0
    ds_write_b128 v2, v[208:211] offset:16640
    ds_write_b128 v2, v[212:215] offset:17664
    s_nop 3
    ds_write_b128 v2, v[216:219] offset:18688
    s_nop 0
    ds_write_b128 v2, v[220:223] offset:19712
    s_waitcnt lgkmcnt(0)
    v_add_u32 v14, 21248, v15
    ds_read_b128 v[64:67], v14 offset:5376
    ds_read_b128 v[68:71], v14 offset:5392
    ds_read_b64 v[72:73], v14 offset:5408
    ds_read_b128 v[76:79], v14 offset:5424
    ds_read_b128 v[80:83], v14 offset:5440
    ds_read_b64 v[84:85], v14 offset:5456
    ds_read_b128 v[88:91], v14 offset:5472
    ds_read_b128 v[92:95], v14 offset:5488
    ds_read_b64 v[96:97], v14 offset:5504
    ds_read_b128 v[100:103], v14 offset:5520
    ds_read_b128 v[104:107], v14 offset:5536
    ds_read_b64 v[108:109], v14 offset:5552
    s_waitcnt lgkmcnt(0)
    v_mul_f32 v168, v64, v13
    v_mul_f32 v169, v65, v13
    v_mul_f32 v172, v76, v13
    v_mul_f32 v173, v77, v13
    v_mul_f32 v176, v88, v13
    v_mul_f32 v177, v89, v13
    v_mul_f32 v180, v100, v13
    v_mul_f32 v181, v101, v13
    v_exp_f32 v168, v168
    v_cos_f32 v170, v169
    v_sin_f32 v171, v169
    v_exp_f32 v172, v172
    v_cos_f32 v174, v173
    v_sin_f32 v175, v173
    v_exp_f32 v176, v176
    v_cos_f32 v178, v177
    v_sin_f32 v179, v177
    v_exp_f32 v180, v180
    v_cos_f32 v182, v181
    v_sin_f32 v183, v181
    v_mul_f32 v160, v168, v170
    v_mul_f32 v161, v168, v171
    v_mul_f32 v162, v172, v174
    v_mul_f32 v163, v172, v175
    v_mul_f32 v164, v176, v178
    v_mul_f32 v165, v176, v179
    v_mul_f32 v166, v180, v182
    v_mul_f32 v167, v180, v183
    v_cvt_pk_bf16_f32 v200, v160, v161
    v_cvt_pk_bf16_f32 v201, v162, v163
    v_cvt_pk_bf16_f32 v202, v164, v165
    v_cvt_pk_bf16_f32 v203, v166, v167
    v_mul_f32 v168, v161, v161
    v_mul_f32_e64 v161, v160, v161 mul:2
    v_fma_f32 v160, v160, v160, -v168
    v_mul_f32 v172, v163, v163
    v_mul_f32_e64 v163, v162, v163 mul:2
    v_fma_f32 v162, v162, v162, -v172
    v_mul_f32 v176, v165, v165
    v_mul_f32_e64 v165, v164, v165 mul:2
    v_fma_f32 v164, v164, v164, -v176
    v_mul_f32 v180, v167, v167
    v_mul_f32_e64 v167, v166, v167 mul:2
    v_fma_f32 v166, v166, v166, -v180
    v_mul_f32 v168, v161, v161
    v_mul_f32_e64 v161, v160, v161 mul:2
    v_fma_f32 v160, v160, v160, -v168
    v_mul_f32 v172, v163, v163
    v_mul_f32_e64 v163, v162, v163 mul:2
    v_fma_f32 v162, v162, v162, -v172
    v_mul_f32 v176, v165, v165
    v_mul_f32_e64 v165, v164, v165 mul:2
    v_fma_f32 v164, v164, v164, -v176
    v_mul_f32 v180, v167, v167
    v_mul_f32_e64 v167, v166, v167 mul:2
    v_fma_f32 v166, v166, v166, -v180
    v_cvt_pk_bf16_f32 v204, v160, v161
    v_cvt_pk_bf16_f32 v205, v162, v163
    v_cvt_pk_bf16_f32 v206, v164, v165
    v_cvt_pk_bf16_f32 v207, v166, v167
    v_mul_f32 v168, v161, v161
    v_mul_f32_e64 v161, v160, v161 mul:2
    v_fma_f32 v160, v160, v160, -v168
    v_mul_f32 v172, v163, v163
    v_mul_f32_e64 v163, v162, v163 mul:2
    v_fma_f32 v162, v162, v162, -v172
    v_mul_f32 v176, v165, v165
    v_mul_f32_e64 v165, v164, v165 mul:2
    v_fma_f32 v164, v164, v164, -v176
    v_mul_f32 v180, v167, v167
    v_mul_f32_e64 v167, v166, v167 mul:2
    v_fma_f32 v166, v166, v166, -v180
    v_mul_f32 v168, v161, v161
    v_mul_f32_e64 v161, v160, v161 mul:2
    v_fma_f32 v160, v160, v160, -v168
    v_mul_f32 v172, v163, v163
    v_mul_f32_e64 v163, v162, v163 mul:2
    v_fma_f32 v162, v162, v162, -v172
    v_mul_f32 v176, v165, v165
    v_mul_f32_e64 v165, v164, v165 mul:2
    v_fma_f32 v164, v164, v164, -v176
    v_mul_f32 v180, v167, v167
    v_mul_f32_e64 v167, v166, v167 mul:2
    v_fma_f32 v166, v166, v166, -v180
    v_mul_f32 v168, v66, v160
    v_mul_f32_e64 v169, -v66, v161
    v_fma_f32 v168, -v67, v161, v168
    v_fma_f32 v169, -v67, v160, v169
    v_cvt_pk_bf16_f32 v184, v168, v169
    v_mul_f32 v172, v78, v162
    v_mul_f32_e64 v173, -v78, v163
    v_fma_f32 v172, -v79, v163, v172
    v_fma_f32 v173, -v79, v162, v173
    v_cvt_pk_bf16_f32 v185, v172, v173
    v_mul_f32 v176, v90, v164
    v_mul_f32_e64 v177, -v90, v165
    v_fma_f32 v176, -v91, v165, v176
    v_fma_f32 v177, -v91, v164, v177
    v_cvt_pk_bf16_f32 v186, v176, v177
    v_mul_f32 v180, v102, v166
    v_mul_f32_e64 v181, -v102, v167
    v_fma_f32 v180, -v103, v167, v180
    v_fma_f32 v181, -v103, v166, v181
    v_cvt_pk_bf16_f32 v187, v180, v181
    v_mul_f32 v168, v68, v160
    v_mul_f32_e64 v169, -v68, v161
    v_fma_f32 v168, -v69, v161, v168
    v_fma_f32 v169, -v69, v160, v169
    v_cvt_pk_bf16_f32 v188, v168, v169
    v_mul_f32 v172, v80, v162
    v_mul_f32_e64 v173, -v80, v163
    v_fma_f32 v172, -v81, v163, v172
    v_fma_f32 v173, -v81, v162, v173
    v_cvt_pk_bf16_f32 v189, v172, v173
    v_mul_f32 v176, v92, v164
    v_mul_f32_e64 v177, -v92, v165
    v_fma_f32 v176, -v93, v165, v176
    v_fma_f32 v177, -v93, v164, v177
    v_cvt_pk_bf16_f32 v190, v176, v177
    v_mul_f32 v180, v104, v166
    v_mul_f32_e64 v181, -v104, v167
    v_fma_f32 v180, -v105, v167, v180
    v_fma_f32 v181, -v105, v166, v181
    v_cvt_pk_bf16_f32 v191, v180, v181
    v_mfma_f32_16x16x32_bf16 v[208:211], v[184:187], v[200:203], 0
    v_mul_f32 v168, v161, v161
    v_mul_f32_e64 v161, v160, v161 mul:2
    v_fma_f32 v160, v160, v160, -v168
    v_mul_f32 v172, v163, v163
    v_mul_f32_e64 v163, v162, v163 mul:2
    v_fma_f32 v162, v162, v162, -v172
    v_mul_f32 v176, v165, v165
    v_mul_f32_e64 v165, v164, v165 mul:2
    v_fma_f32 v164, v164, v164, -v176
    v_mul_f32 v180, v167, v167
    v_mul_f32_e64 v167, v166, v167 mul:2
    v_fma_f32 v166, v166, v166, -v180
    v_mfma_f32_16x16x32_bf16 v[212:215], v[188:191], v[200:203], 0
    v_mul_f32 v168, v161, v161
    v_mul_f32_e64 v161, v160, v161 mul:2
    v_fma_f32 v160, v160, v160, -v168
    v_mul_f32 v172, v163, v163
    v_mul_f32_e64 v163, v162, v163 mul:2
    v_fma_f32 v162, v162, v162, -v172
    v_mul_f32 v176, v165, v165
    v_mul_f32_e64 v165, v164, v165 mul:2
    v_fma_f32 v164, v164, v164, -v176
    v_mul_f32 v180, v167, v167
    v_mul_f32_e64 v167, v166, v167 mul:2
    v_fma_f32 v166, v166, v166, -v180
    v_mul_f32 v168, v70, v160
    v_mul_f32_e64 v169, -v70, v161
    v_fma_f32 v168, -v71, v161, v168
    v_fma_f32 v169, -v71, v160, v169
    v_cvt_pk_bf16_f32 v192, v168, v169
    v_mul_f32 v172, v82, v162
    v_mul_f32_e64 v173, -v82, v163
    v_fma_f32 v172, -v83, v163, v172
    v_fma_f32 v173, -v83, v162, v173
    v_cvt_pk_bf16_f32 v193, v172, v173
    v_mul_f32 v176, v94, v164
    v_mul_f32_e64 v177, -v94, v165
    v_fma_f32 v176, -v95, v165, v176
    v_fma_f32 v177, -v95, v164, v177
    v_cvt_pk_bf16_f32 v194, v176, v177
    v_mul_f32 v180, v106, v166
    v_mul_f32_e64 v181, -v106, v167
    v_fma_f32 v180, -v107, v167, v180
    v_fma_f32 v181, -v107, v166, v181
    v_cvt_pk_bf16_f32 v195, v180, v181
    v_mul_f32 v168, v72, v160
    v_mul_f32_e64 v169, -v72, v161
    v_fma_f32 v168, -v73, v161, v168
    v_fma_f32 v169, -v73, v160, v169
    v_cvt_pk_bf16_f32 v196, v168, v169
    v_mul_f32 v172, v84, v162
    v_mul_f32_e64 v173, -v84, v163
    v_fma_f32 v172, -v85, v163, v172
    v_fma_f32 v173, -v85, v162, v173
    v_cvt_pk_bf16_f32 v197, v172, v173
    v_mul_f32 v176, v96, v164
    v_mul_f32_e64 v177, -v96, v165
    v_fma_f32 v176, -v97, v165, v176
    v_fma_f32 v177, -v97, v164, v177
    v_cvt_pk_bf16_f32 v198, v176, v177
    v_mul_f32 v180, v108, v166
    v_mul_f32_e64 v181, -v108, v167
    v_fma_f32 v180, -v109, v167, v180
    v_fma_f32 v181, -v109, v166, v181
    v_cvt_pk_bf16_f32 v199, v180, v181
    v_mfma_f32_16x16x32_bf16 v[216:219], v[192:195], v[204:207], 0
    s_nop 0
    v_mfma_f32_16x16x32_bf16 v[220:223], v[196:199], v[204:207], 0
    ds_write_b128 v2, v[208:211] offset:37888
    ds_write_b128 v2, v[212:215] offset:38912
    s_nop 3
    ds_write_b128 v2, v[216:219] offset:39936
    s_nop 0
    ds_write_b128 v2, v[220:223] offset:40960
    s_waitcnt lgkmcnt(0)
    s_cmp_ge_u32 s3, 216
    s_cbranch_scc1 L_rp_nold_23
    s_load_dwordx2 s[44:45], s[0:1], 72
    v_add_u32 v61, 0, v1
    v_mul_u32_u24 v62, 6554, v61
    v_lshrrev_b32 v62, 16, v62
    v_mul_u32_u24 v56, 10, v62
    v_sub_u32 v61, v61, v56
    v_mul_u32_u24 v56, 1280, v62
    v_lshl_add_u32 v56, v61, 4, v56
    v_add_u32 v61, 64, v1
    v_mul_u32_u24 v62, 6554, v61
    v_lshrrev_b32 v62, 16, v62
    v_mul_u32_u24 v57, 10, v62
    v_sub_u32 v61, v61, v57
    v_mul_u32_u24 v57, 1280, v62
    v_lshl_add_u32 v57, v61, 4, v57
    v_add_u32 v61, 128, v1
    v_mul_u32_u24 v62, 6554, v61
    v_lshrrev_b32 v62, 16, v62
    v_mul_u32_u24 v58, 10, v62
    v_sub_u32 v61, v61, v58
    v_mul_u32_u24 v58, 1280, v62
    v_lshl_add_u32 v58, v61, 4, v58
    v_add_u32 v61, 192, v1
    v_mul_u32_u24 v62, 6554, v61
    v_lshrrev_b32 v62, 16, v62
    v_mul_u32_u24 v59, 10, v62
    v_sub_u32 v61, v61, v59
    v_mul_u32_u24 v59, 1280, v62
    v_lshl_add_u32 v59, v61, 4, v59
    v_add_u32 v61, 256, v1
    v_mul_u32_u24 v62, 6554, v61
    v_lshrrev_b32 v62, 16, v62
    v_mul_u32_u24 v60, 10, v62
    v_sub_u32 v61, v61, v60
    v_mul_u32_u24 v60, 1280, v62
    v_lshl_add_u32 v60, v61, 4, v60
    s_mul_i32 s6, s3, 2428
    s_lshr_b32 s6, s6, 16
    s_mul_i32 s7, s6, 27
    s_sub_u32 s7, s3, s7
    s_lshl_b32 s7, s7, 1
    s_mul_i32 s30, s7, 40960
    s_mul_i32 s31, s6, 160
    s_add_u32 s30, s30, s31
    s_waitcnt lgkmcnt(0)
    s_mov_b32 s8, s44
    s_mov_b32 s9, s45
    s_mov_b32 s10, 0x21c000
    s_mov_b32 s11, 0x00020000
    buffer_load_dwordx4 v[16:19], v56, s[8:11], s30 offen nt
    buffer_load_dwordx4 v[20:23], v57, s[8:11], s30 offen nt
    buffer_load_dwordx4 v[24:27], v58, s[8:11], s30 offen nt
    buffer_load_dwordx4 v[28:31], v59, s[8:11], s30 offen nt
    buffer_load_dwordx4 v[32:35], v60, s[8:11], s30 offen nt
    s_add_u32 s30, s30, 40960
    buffer_load_dwordx4 v[36:39], v56, s[8:11], s30 offen nt
    buffer_load_dwordx4 v[40:43], v57, s[8:11], s30 offen nt
    buffer_load_dwordx4 v[44:47], v58, s[8:11], s30 offen nt
    buffer_load_dwordx4 v[48:51], v59, s[8:11], s30 offen nt
    buffer_load_dwordx4 v[52:55], v60, s[8:11], s30 offen nt
L_rp_nold_23:
    s_cmp_lt_u32 s38, 3
    s_cbranch_scc1 L_kc_rp_22
    v_add_u32 v14, 42496, v15
    ds_read_b128 v[64:67], v14 offset:5376
    ds_read_b128 v[68:71], v14 offset:5392
    ds_read_b64 v[72:73], v14 offset:5408
    ds_read_b128 v[76:79], v14 offset:5424
    ds_read_b128 v[80:83], v14 offset:5440
    ds_read_b64 v[84:85], v14 offset:5456
    ds_read_b128 v[88:91], v14 offset:5472
    ds_read_b128 v[92:95], v14 offset:5488
    ds_read_b64 v[96:97], v14 offset:5504
    ds_read_b128 v[100:103], v14 offset:5520
    ds_read_b128 v[104:107], v14 offset:5536
    ds_read_b64 v[108:109], v14 offset:5552
    s_waitcnt lgkmcnt(0)
    v_mul_f32 v168, v64, v13
    v_mul_f32 v169, v65, v13
    v_mul_f32 v172, v76, v13
    v_mul_f32 v173, v77, v13
    v_mul_f32 v176, v88, v13
    v_mul_f32 v177, v89, v13
    v_mul_f32 v180, v100, v13
    v_mul_f32 v181, v101, v13
    v_exp_f32 v168, v168
    v_cos_f32 v170, v169
    v_sin_f32 v171, v169
    v_exp_f32 v172, v172
    v_cos_f32 v174, v173
    v_sin_f32 v175, v173
    v_exp_f32 v176, v176
    v_cos_f32 v178, v177
    v_sin_f32 v179, v177
    v_exp_f32 v180, v180
    v_cos_f32 v182, v181
    v_sin_f32 v183, v181
    v_mul_f32 v160, v168, v170
    v_mul_f32 v161, v168, v171
    v_mul_f32 v162, v172, v174
    v_mul_f32 v163, v172, v175
    v_mul_f32 v164, v176, v178
    v_mul_f32 v165, v176, v179
    v_mul_f32 v166, v180, v182
    v_mul_f32 v167, v180, v183
    v_cvt_pk_bf16_f32 v200, v160, v161
    v_cvt_pk_bf16_f32 v201, v162, v163
    v_cvt_pk_bf16_f32 v202, v164, v165
    v_cvt_pk_bf16_f32 v203, v166, v167
    v_mul_f32 v168, v161, v161
    v_mul_f32_e64 v161, v160, v161 mul:2
    v_fma_f32 v160, v160, v160, -v168
    v_mul_f32 v172, v163, v163
    v_mul_f32_e64 v163, v162, v163 mul:2
    v_fma_f32 v162, v162, v162, -v172
    v_mul_f32 v176, v165, v165
    v_mul_f32_e64 v165, v164, v165 mul:2
    v_fma_f32 v164, v164, v164, -v176
    v_mul_f32 v180, v167, v167
    v_mul_f32_e64 v167, v166, v167 mul:2
    v_fma_f32 v166, v166, v166, -v180
    v_mul_f32 v168, v161, v161
    v_mul_f32_e64 v161, v160, v161 mul:2
    v_fma_f32 v160, v160, v160, -v168
    v_mul_f32 v172, v163, v163
    v_mul_f32_e64 v163, v162, v163 mul:2
    v_fma_f32 v162, v162, v162, -v172
    v_mul_f32 v176, v165, v165
    v_mul_f32_e64 v165, v164, v165 mul:2
    v_fma_f32 v164, v164, v164, -v176
    v_mul_f32 v180, v167, v167
    v_mul_f32_e64 v167, v166, v167 mul:2
    v_fma_f32 v166, v166, v166, -v180
    v_cvt_pk_bf16_f32 v204, v160, v161
    v_cvt_pk_bf16_f32 v205, v162, v163
    v_cvt_pk_bf16_f32 v206, v164, v165
    v_cvt_pk_bf16_f32 v207, v166, v167
    v_mul_f32 v168, v161, v161
    v_mul_f32_e64 v161, v160, v161 mul:2
    v_fma_f32 v160, v160, v160, -v168
    v_mul_f32 v172, v163, v163
    v_mul_f32_e64 v163, v162, v163 mul:2
    v_fma_f32 v162, v162, v162, -v172
    v_mul_f32 v176, v165, v165
    v_mul_f32_e64 v165, v164, v165 mul:2
    v_fma_f32 v164, v164, v164, -v176
    v_mul_f32 v180, v167, v167
    v_mul_f32_e64 v167, v166, v167 mul:2
    v_fma_f32 v166, v166, v166, -v180
    v_mul_f32 v168, v161, v161
    v_mul_f32_e64 v161, v160, v161 mul:2
    v_fma_f32 v160, v160, v160, -v168
    v_mul_f32 v172, v163, v163
    v_mul_f32_e64 v163, v162, v163 mul:2
    v_fma_f32 v162, v162, v162, -v172
    v_mul_f32 v176, v165, v165
    v_mul_f32_e64 v165, v164, v165 mul:2
    v_fma_f32 v164, v164, v164, -v176
    v_mul_f32 v180, v167, v167
    v_mul_f32_e64 v167, v166, v167 mul:2
    v_fma_f32 v166, v166, v166, -v180
    v_mul_f32 v168, v66, v160
    v_mul_f32_e64 v169, -v66, v161
    v_fma_f32 v168, -v67, v161, v168
    v_fma_f32 v169, -v67, v160, v169
    v_cvt_pk_bf16_f32 v184, v168, v169
    v_mul_f32 v172, v78, v162
    v_mul_f32_e64 v173, -v78, v163
    v_fma_f32 v172, -v79, v163, v172
    v_fma_f32 v173, -v79, v162, v173
    v_cvt_pk_bf16_f32 v185, v172, v173
    v_mul_f32 v176, v90, v164
    v_mul_f32_e64 v177, -v90, v165
    v_fma_f32 v176, -v91, v165, v176
    v_fma_f32 v177, -v91, v164, v177
    v_cvt_pk_bf16_f32 v186, v176, v177
    v_mul_f32 v180, v102, v166
    v_mul_f32_e64 v181, -v102, v167
    v_fma_f32 v180, -v103, v167, v180
    v_fma_f32 v181, -v103, v166, v181
    v_cvt_pk_bf16_f32 v187, v180, v181
    v_mul_f32 v168, v68, v160
    v_mul_f32_e64 v169, -v68, v161
    v_fma_f32 v168, -v69, v161, v168
    v_fma_f32 v169, -v69, v160, v169
    v_cvt_pk_bf16_f32 v188, v168, v169
    v_mul_f32 v172, v80, v162
    v_mul_f32_e64 v173, -v80, v163
    v_fma_f32 v172, -v81, v163, v172
    v_fma_f32 v173, -v81, v162, v173
    v_cvt_pk_bf16_f32 v189, v172, v173
    v_mul_f32 v176, v92, v164
    v_mul_f32_e64 v177, -v92, v165
    v_fma_f32 v176, -v93, v165, v176
    v_fma_f32 v177, -v93, v164, v177
    v_cvt_pk_bf16_f32 v190, v176, v177
    v_mul_f32 v180, v104, v166
    v_mul_f32_e64 v181, -v104, v167
    v_fma_f32 v180, -v105, v167, v180
    v_fma_f32 v181, -v105, v166, v181
    v_cvt_pk_bf16_f32 v191, v180, v181
    v_mfma_f32_16x16x32_bf16 v[208:211], v[184:187], v[200:203], 0
    v_mul_f32 v168, v161, v161
    v_mul_f32_e64 v161, v160, v161 mul:2
    v_fma_f32 v160, v160, v160, -v168
    v_mul_f32 v172, v163, v163
    v_mul_f32_e64 v163, v162, v163 mul:2
    v_fma_f32 v162, v162, v162, -v172
    v_mul_f32 v176, v165, v165
    v_mul_f32_e64 v165, v164, v165 mul:2
    v_fma_f32 v164, v164, v164, -v176
    v_mul_f32 v180, v167, v167
    v_mul_f32_e64 v167, v166, v167 mul:2
    v_fma_f32 v166, v166, v166, -v180
    v_mfma_f32_16x16x32_bf16 v[212:215], v[188:191], v[200:203], 0
    v_mul_f32 v168, v161, v161
    v_mul_f32_e64 v161, v160, v161 mul:2
    v_fma_f32 v160, v160, v160, -v168
    v_mul_f32 v172, v163, v163
    v_mul_f32_e64 v163, v162, v163 mul:2
    v_fma_f32 v162, v162, v162, -v172
    v_mul_f32 v176, v165, v165
    v_mul_f32_e64 v165, v164, v165 mul:2
    v_fma_f32 v164, v164, v164, -v176
    v_mul_f32 v180, v167, v167
    v_mul_f32_e64 v167, v166, v167 mul:2
    v_fma_f32 v166, v166, v166, -v180
    v_mul_f32 v168, v70, v160
    v_mul_f32_e64 v169, -v70, v161
    v_fma_f32 v168, -v71, v161, v168
    v_fma_f32 v169, -v71, v160, v169
    v_cvt_pk_bf16_f32 v192, v168, v169
    v_mul_f32 v172, v82, v162
    v_mul_f32_e64 v173, -v82, v163
    v_fma_f32 v172, -v83, v163, v172
    v_fma_f32 v173, -v83, v162, v173
    v_cvt_pk_bf16_f32 v193, v172, v173
    v_mul_f32 v176, v94, v164
    v_mul_f32_e64 v177, -v94, v165
    v_fma_f32 v176, -v95, v165, v176
    v_fma_f32 v177, -v95, v164, v177
    v_cvt_pk_bf16_f32 v194, v176, v177
    v_mul_f32 v180, v106, v166
    v_mul_f32_e64 v181, -v106, v167
    v_fma_f32 v180, -v107, v167, v180
    v_fma_f32 v181, -v107, v166, v181
    v_cvt_pk_bf16_f32 v195, v180, v181
    v_mul_f32 v168, v72, v160
    v_mul_f32_e64 v169, -v72, v161
    v_fma_f32 v168, -v73, v161, v168
    v_fma_f32 v169, -v73, v160, v169
    v_cvt_pk_bf16_f32 v196, v168, v169
    v_mul_f32 v172, v84, v162
    v_mul_f32_e64 v173, -v84, v163
    v_fma_f32 v172, -v85, v163, v172
    v_fma_f32 v173, -v85, v162, v173
    v_cvt_pk_bf16_f32 v197, v172, v173
    v_mul_f32 v176, v96, v164
    v_mul_f32_e64 v177, -v96, v165
    v_fma_f32 v176, -v97, v165, v176
    v_fma_f32 v177, -v97, v164, v177
    v_cvt_pk_bf16_f32 v198, v176, v177
    v_mul_f32 v180, v108, v166
    v_mul_f32_e64 v181, -v108, v167
    v_fma_f32 v180, -v109, v167, v180
    v_fma_f32 v181, -v109, v166, v181
    v_cvt_pk_bf16_f32 v199, v180, v181
    v_mfma_f32_16x16x32_bf16 v[216:219], v[192:195], v[204:207], 0
    s_nop 0
    v_mfma_f32_16x16x32_bf16 v[220:223], v[196:199], v[204:207], 0
    ds_write_b128 v2, v[208:211] offset:59136
    ds_write_b128 v2, v[212:215] offset:60160
    s_nop 3
    ds_write_b128 v2, v[216:219] offset:61184
    s_nop 0
    ds_write_b128 v2, v[220:223] offset:62208
    s_waitcnt lgkmcnt(0)
L_kc_rp_22:
    s_cmp_ge_u32 s3, 216
    s_cbranch_scc1 L_rp_done_24
    s_add_u32 s12, s50, 0xa00000
    s_addc_u32 s13, s51, 0
    s_mov_b32 s14, 0x21c000
    s_mov_b32 s15, 0x00020000
    v_lshrrev_b32 v56, 4, v1
    v_and_b32 v57, 1, v56
    v_lshlrev_b32 v57, 4, v57
    v_lshrrev_b32 v56, 1, v56
    v_lshl_add_u32 v57, v56, 2, v57
    v_and_b32 v56, 15, v1
    v_lshrrev_b32 v58, 2, v56
    v_add_u32 v57, v57, v58
    v_mul_u32_u24 v58, 160, v57
    v_and_b32 v56, 3, v56
    v_lshl_add_u32 v58, v56, 3, v58
    v_add_u32 v58, 68352, v58
    v_add_u32 v56, 68352, v2
    v_add_u32 v59, 4096, v2
    s_load_dwordx2 s[84:85], s[0:1], 88
    v_mov_b32 v60, 0
    s_mov_b32 s62, 0
    s_waitcnt lgkmcnt(0)
    s_mov_b32 s86, 256
    s_mov_b32 s87, 0x00020000
L_tag_25:
    buffer_load_dword v61, v60, s[84:87], 0 offen sc1
    s_waitcnt vmcnt(0)
    v_readfirstlane_b32 s61, v61
    s_nop 0
    s_cmp_lg_u32 s61, 0
    s_cbranch_scc1 L_tagged_26
    s_sleep 24
    s_add_u32 s62, s62, 1
    s_cmp_lt_u32 s62, 32768
    s_cbranch_scc1 L_tag_25
L_tagged_26:
    ds_write_b128 v56, v[16:19] offset:0
    ds_write_b128 v56, v[20:23] offset:1024
    ds_write_b128 v56, v[24:27] offset:2048
    ds_write_b128 v56, v[28:31] offset:3072
    ds_write_b128 v56, v[32:35] offset:4096
    ds_write_b128 v56, v[36:39] offset:5120
    ds_write_b128 v56, v[40:43] offset:6144
    ds_write_b128 v56, v[44:47] offset:7168
    ds_write_b128 v56, v[48:51] offset:8192
    ds_write_b128 v56, v[52:55] offset:9216
    s_waitcnt lgkmcnt(0)
    ds_read_b64_tr_b16 v[16:17], v58 offset:0
    ds_read_b64_tr_b16 v[18:19], v58 offset:1280
    ds_read_b64_tr_b16 v[20:21], v58 offset:32
    ds_read_b64_tr_b16 v[22:23], v58 offset:1312
    ds_read_b64_tr_b16 v[24:25], v58 offset:64
    ds_read_b64_tr_b16 v[26:27], v58 offset:1344
    ds_read_b64_tr_b16 v[28:29], v58 offset:96
    ds_read_b64_tr_b16 v[30:31], v58 offset:1376
    ds_read_b64_tr_b16 v[32:33], v58 offset:128
    ds_read_b64_tr_b16 v[34:35], v58 offset:1408
    ds_read_b64_tr_b16 v[36:37], v58 offset:5120
    ds_read_b64_tr_b16 v[38:39], v58 offset:6400
    ds_read_b64_tr_b16 v[40:41], v58 offset:5152
    ds_read_b64_tr_b16 v[42:43], v58 offset:6432
    ds_read_b64_tr_b16 v[44:45], v58 offset:5184
    ds_read_b64_tr_b16 v[46:47], v58 offset:6464
    ds_read_b64_tr_b16 v[48:49], v58 offset:5216
    ds_read_b64_tr_b16 v[50:51], v58 offset:6496
    ds_read_b64_tr_b16 v[52:53], v58 offset:5248
    ds_read_b64_tr_b16 v[54:55], v58 offset:6528
    s_mul_i32 s30, s6, 54
    s_add_u32 s30, s30, s7
    s_mul_i32 s30, s30, 5120
    s_waitcnt lgkmcnt(10)
    buffer_store_dwordx4 v[16:19], v2, s[12:15], s30 offen offset:0 sc1
    buffer_store_dwordx4 v[20:23], v2, s[12:15], s30 offen offset:1024 sc1
    buffer_store_dwordx4 v[24:27], v2, s[12:15], s30 offen offset:2048 sc1
    buffer_store_dwordx4 v[28:31], v2, s[12:15], s30 offen offset:3072 sc1
    buffer_store_dwordx4 v[32:35], v59, s[12:15], s30 offen sc1
    s_add_u32 s30, s30, 5120
    s_waitcnt lgkmcnt(0)
    buffer_store_dwordx4 v[36:39], v2, s[12:15], s30 offen offset:0 sc1
    buffer_store_dwordx4 v[40:43], v2, s[12:15], s30 offen offset:1024 sc1
    buffer_store_dwordx4 v[44:47], v2, s[12:15], s30 offen offset:2048 sc1
    buffer_store_dwordx4 v[48:51], v2, s[12:15], s30 offen offset:3072 sc1
    buffer_store_dwordx4 v[52:55], v59, s[12:15], s30 offen sc1
L_rp_done_24:
    s_cmp_ge_u32 s3, 216
    s_cbranch_scc1 L_rp_nosig_27
    s_waitcnt vmcnt(0)
    s_add_u32 s6, s3, 64
    s_lshl_b32 s60, s6, 7
    v_mov_b32 v60, 0
    v_mov_b32 v61, s61
    s_mov_b64 exec, 1
    buffer_store_dword v61, v60, s[80:83], s60 offen sc1
    s_mov_b64 exec, -1
L_rp_nosig_27:
L_kc_bar2_21:
    s_cmp_lg_u32 s4, 0
    s_cbranch_scc1 L_kc_nopoll_28
    s_load_dwordx2 s[84:85], s[0:1], 88
    v_mov_b32 v3, 0
    s_mov_b32 s62, 0
    s_waitcnt lgkmcnt(0)
    s_mov_b32 s86, 256
    s_mov_b32 s87, 0x00020000
L_tag_29:
    buffer_load_dword v4, v3, s[84:87], 0 offen sc1
    s_waitcnt vmcnt(0)
    v_readfirstlane_b32 s61, v4
    s_nop 0
    s_cmp_lg_u32 s61, 0
    s_cbranch_scc1 L_tagged_30
    s_sleep 24
    s_add_u32 s62, s62, 1
    s_cmp_lt_u32 s62, 32768
    s_cbranch_scc1 L_tag_29
L_tagged_30:
    v_lshlrev_b32 v5, 7, v1
    s_mov_b32 s62, 0
L_fw_31:
    buffer_load_dword v3, v5, s[80:83], 0 offen sc1
    s_waitcnt vmcnt(0)
    v_cmp_ne_u32 vcc, s61, v3
    s_nop 0
    s_cmp_eq_u64 vcc, 0
    s_cbranch_scc1 L_fwd_32
    s_sleep 24
    s_add_u32 s62, s62, 1
    s_cmp_lt_u32 s62, 32768
    s_cbranch_scc1 L_fw_31
L_fwd_32:
L_kc_nopoll_28:
    s_waitcnt lgkmcnt(0)
    s_barrier
    s_cmp_ge_u32 s4, s38
    s_cbranch_scc1 L_kc_bar3_33
    v_add_u32 v5, s33, v2
    ds_read_b128 v[64:67], v5 offset:16640
    ds_read_b128 v[68:71], v5 offset:17664
    ds_read_b128 v[72:75], v5 offset:18688
    ds_read_b128 v[76:79], v5 offset:19712
    s_add_u32 s24, s50, 0x10000
    s_addc_u32 s25, s51, 0
    s_mov_b32 s26, 0x280000
    s_mov_b32 s27, 0x00020000
    s_lshl_b32 s35, s5, 12
    v_lshrrev_b32 v19, 2, v1
    v_mul_u32_u24 v19, 40960, v19
    v_and_b32 v40, 3, v1
    v_lshl_add_u32 v19, v40, 4, v19
    s_lshl_b32 s36, s5, 6
    buffer_load_dwordx4 v[40:43], v19, s[24:27], s36 offen sc1
    s_add_u32 s36, s36, 655360
    buffer_load_dwordx4 v[44:47], v19, s[24:27], s36 offen sc1
    s_add_u32 s36, s36, 655360
    buffer_load_dwordx4 v[48:51], v19, s[24:27], s36 offen sc1
    s_add_u32 s36, s36, 655360
    buffer_load_dwordx4 v[52:55], v19, s[24:27], s36 offen sc1
    s_waitcnt lgkmcnt(0)
    v_add_f32 v208, v208, v64
    v_add_f32 v209, v209, v65
    v_add_f32 v210, v210, v66
    v_add_f32 v211, v211, v67
    v_add_f32 v212, v212, v68
    v_add_f32 v213, v213, v69
    v_add_f32 v214, v214, v70
    v_add_f32 v215, v215, v71
    v_add_f32 v216, v216, v72
    v_add_f32 v217, v217, v73
    v_add_f32 v218, v218, v74
    v_add_f32 v219, v219, v75
    v_add_f32 v220, v220, v76
    v_add_f32 v221, v221, v77
    v_add_f32 v222, v222, v78
    v_add_f32 v223, v223, v79
    v_lshrrev_b32 v9, 4, v1
    v_and_b32 v20, 15, v1
    s_mul_i32 s30, s4, 1536
    s_add_u32 s30, s30, 63744
    v_lshlrev_b32 v16, 7, v9
    v_lshl_add_u32 v16, v20, 1, v16
    v_add_u32 v16, s30, v16
    v_lshlrev_b32 v17, 6, v9
    v_add_u32 v17, v17, v20
    v_add_u32 v17, s30, v17
    v_cvt_pk_bf16_f32 v20, v208, v209
    v_cvt_pk_bf16_f32 v21, v210, v211
    v_cvt_pk_bf16_f32 v22, v212, v213
    v_cvt_pk_bf16_f32 v23, v214, v215
    v_cvt_pk_bf16_f32 v24, v216, v217
    v_cvt_pk_bf16_f32 v25, v218, v219
    v_cvt_pk_bf16_f32 v26, v220, v221
    v_cvt_pk_bf16_f32 v27, v222, v223
    ds_write_b16 v16, v20 offset:0
    ds_write_b16_d16_hi v16, v20 offset:32
    ds_write_b16 v16, v21 offset:64
    ds_write_b16_d16_hi v16, v21 offset:96
    s_mov_b32 exec_hi, 0
    ds_write_b16 v16, v24 offset:768
    ds_write_b16_d16_hi v16, v24 offset:800
    ds_write_b16 v16, v25 offset:832
    ds_write_b16_d16_hi v16, v25 offset:864
    s_mov_b32 exec_lo, 0x55555555
    s_mov_b32 exec_hi, 0x55555555
    ds_write_b16 v17, v22 offset:512
    ds_write_b16_d16_hi v17, v22 offset:528
    ds_write_b16 v17, v23 offset:544
    ds_write_b16_d16_hi v17, v23 offset:560
    ds_write_b16 v17, v26 offset:1024
    ds_write_b16_d16_hi v17, v26 offset:1040
    ds_write_b16 v17, v27 offset:1056
    ds_write_b16_d16_hi v17, v27 offset:1072
    s_mov_b64 exec, 1
    v_cvt_pk_bf16_f32 v11, v11, v11
    v_mov_b32 v9, s30
    ds_write_b16 v9, v11 offset:1280
    s_mov_b64 exec, -1
    v_lshlrev_b32 v9, 3, v1
    v_sub_u32 v9, 2047, v9
    v_cvt_f32_u32 v16, v9
    s_sub_u32 s31, s30, 34048
    v_mov_b32 v17, s31
    v_lshlrev_b32 v18, 4, v1
    s_add_u32 s31, s30, 1022
    v_sub_u32 v18, s31, v18
    v_cmp_le_u32 s[56:57], 48, v1
    s_waitcnt lgkmcnt(0)
    v_add_f32 v20, 0x00000000, v16
    v_add_f32 v21, 0xbf800000, v16
    v_cvt_pk_bf16_f32 v22, v20, v21
    v_mad_u32_u16 v24, v22, 2, v17
    v_mad_u32_u16 v25, v22, 2, v17 op_sel:[1,0,0,0]
    ds_read_u16 v64, v24
    ds_read_u16 v65, v25
    v_add_f32 v20, 0xc0000000, v16
    v_add_f32 v21, 0xc0400000, v16
    v_cvt_pk_bf16_f32 v22, v20, v21
    v_mad_u32_u16 v26, v22, 2, v17
    v_mad_u32_u16 v27, v22, 2, v17 op_sel:[1,0,0,0]
    ds_read_u16 v66, v26
    ds_read_u16 v67, v27
    v_add_f32 v20, 0xc0800000, v16
    v_add_f32 v21, 0xc0a00000, v16
    v_cvt_pk_bf16_f32 v22, v20, v21
    v_mad_u32_u16 v28, v22, 2, v17
    v_mad_u32_u16 v29, v22, 2, v17 op_sel:[1,0,0,0]
    ds_read_u16 v68, v28
    ds_read_u16 v69, v29
    v_add_f32 v20, 0xc0c00000, v16
    v_add_f32 v21, 0xc0e00000, v16
    v_cvt_pk_bf16_f32 v22, v20, v21
    v_mad_u32_u16 v30, v22, 2, v17
    v_mad_u32_u16 v31, v22, 2, v17 op_sel:[1,0,0,0]
    ds_read_u16 v70, v30
    ds_read_u16 v71, v31
    v_add_f32 v20, 0xc4000000, v16
    v_add_f32 v21, 0xc4004000, v16
    v_cvt_pk_bf16_f32 v22, v20, v21
    v_mad_u32_u16 v24, v22, 2, v17
    v_mad_u32_u16 v25, v22, 2, v17 op_sel:[1,0,0,0]
    ds_read_u16 v72, v24
    ds_read_u16 v73, v25
    v_add_f32 v20, 0xc4008000, v16
    v_add_f32 v21, 0xc400c000, v16
    v_cvt_pk_bf16_f32 v22, v20, v21
    v_mad_u32_u16 v26, v22, 2, v17
    v_mad_u32_u16 v27, v22, 2, v17 op_sel:[1,0,0,0]
    ds_read_u16 v74, v26
    ds_read_u16 v75, v27
    v_add_f32 v20, 0xc4010000, v16
    v_add_f32 v21, 0xc4014000, v16
    v_cvt_pk_bf16_f32 v22, v20, v21
    v_mad_u32_u16 v28, v22, 2, v17
    v_mad_u32_u16 v29, v22, 2, v17 op_sel:[1,0,0,0]
    ds_read_u16 v76, v28
    ds_read_u16 v77, v29
    v_add_f32 v20, 0xc4018000, v16
    v_add_f32 v21, 0xc401c000, v16
    v_cvt_pk_bf16_f32 v22, v20, v21
    v_mad_u32_u16 v30, v22, 2, v17
    v_mad_u32_u16 v31, v22, 2, v17 op_sel:[1,0,0,0]
    ds_read_u16 v78, v30
    ds_read_u16 v79, v31
    v_add_f32 v20, 0xc4800000, v16
    v_add_f32 v21, 0xc4802000, v16
    v_cvt_pk_bf16_f32 v22, v20, v21
    v_mad_u32_u16 v24, v22, 2, v17
    v_mad_u32_u16 v25, v22, 2, v17 op_sel:[1,0,0,0]
    ds_read_u16 v80, v24
    ds_read_u16 v81, v25
    v_add_f32 v20, 0xc4804000, v16
    v_add_f32 v21, 0xc4806000, v16
    v_cvt_pk_bf16_f32 v22, v20, v21
    v_mad_u32_u16 v26, v22, 2, v17
    v_mad_u32_u16 v27, v22, 2, v17 op_sel:[1,0,0,0]
    ds_read_u16 v82, v26
    ds_read_u16 v83, v27
    v_add_f32 v20, 0xc4808000, v16
    v_add_f32 v21, 0xc480a000, v16
    v_cvt_pk_bf16_f32 v22, v20, v21
    v_mad_u32_u16 v28, v22, 2, v17
    v_mad_u32_u16 v29, v22, 2, v17 op_sel:[1,0,0,0]
    ds_read_u16 v84, v28
    ds_read_u16 v85, v29
    v_add_f32 v20, 0xc480c000, v16
    v_add_f32 v21, 0xc480e000, v16
    v_cvt_pk_bf16_f32 v22, v20, v21
    v_mad_u32_u16 v30, v22, 2, v17
    v_mad_u32_u16 v31, v22, 2, v17 op_sel:[1,0,0,0]
    ds_read_u16 v86, v30
    ds_read_u16 v87, v31
    v_add_f32 v20, 0xc4c00000, v16
    v_add_f32 v21, 0xc4c02000, v16
    v_cvt_pk_bf16_f32 v22, v20, v21
    v_mad_u32_u16 v24, v22, 2, v17
    v_mad_u32_u16 v25, v22, 2, v17 op_sel:[1,0,0,0]
    v_mov_b32 v20, v18
    v_add_u32 v21, -2, v18
    v_cndmask_b32 v24, v24, v20, s[56:57]
    v_cndmask_b32 v25, v25, v21, s[56:57]
    ds_read_u16 v88, v24
    ds_read_u16 v89, v25
    v_add_f32 v20, 0xc4c04000, v16
    v_add_f32 v21, 0xc4c06000, v16
    v_cvt_pk_bf16_f32 v22, v20, v21
    v_mad_u32_u16 v26, v22, 2, v17
    v_mad_u32_u16 v27, v22, 2, v17 op_sel:[1,0,0,0]
    v_add_u32 v20, -4, v18
    v_add_u32 v21, -6, v18
    v_cndmask_b32 v26, v26, v20, s[56:57]
    v_cndmask_b32 v27, v27, v21, s[56:57]
    ds_read_u16 v90, v26
    ds_read_u16 v91, v27
    v_add_f32 v20, 0xc4c08000, v16
    v_add_f32 v21, 0xc4c0a000, v16
    v_cvt_pk_bf16_f32 v22, v20, v21
    v_mad_u32_u16 v28, v22, 2, v17
    v_mad_u32_u16 v29, v22, 2, v17 op_sel:[1,0,0,0]
    v_add_u32 v20, -8, v18
    v_add_u32 v21, -10, v18
    v_cndmask_b32 v28, v28, v20, s[56:57]
    v_cndmask_b32 v29, v29, v21, s[56:57]
    ds_read_u16 v92, v28
    ds_read_u16 v93, v29
    v_add_f32 v20, 0xc4c0c000, v16
    v_add_f32 v21, 0xc4c0e000, v16
    v_cvt_pk_bf16_f32 v22, v20, v21
    v_mad_u32_u16 v30, v22, 2, v17
    v_mad_u32_u16 v31, v22, 2, v17 op_sel:[1,0,0,0]
    v_add_u32 v20, -12, v18
    v_add_u32 v21, -14, v18
    v_cndmask_b32 v30, v30, v20, s[56:57]
    v_cndmask_b32 v31, v31, v21, s[56:57]
    ds_read_u16 v94, v30
    ds_read_u16 v95, v31
    s_waitcnt lgkmcnt(0)
    v_lshl_or_b32 v96, v65, 16, v64
    v_lshl_or_b32 v97, v67, 16, v66
    v_lshl_or_b32 v98, v69, 16, v68
    v_lshl_or_b32 v99, v71, 16, v70
    v_lshl_or_b32 v100, v73, 16, v72
    v_lshl_or_b32 v101, v75, 16, v74
    v_lshl_or_b32 v102, v77, 16, v76
    v_lshl_or_b32 v103, v79, 16, v78
    v_lshl_or_b32 v104, v81, 16, v80
    v_lshl_or_b32 v105, v83, 16, v82
    v_lshl_or_b32 v106, v85, 16, v84
    v_lshl_or_b32 v107, v87, 16, v86
    v_lshl_or_b32 v108, v89, 16, v88
    v_lshl_or_b32 v109, v91, 16, v90
    v_lshl_or_b32 v110, v93, 16, v92
    v_lshl_or_b32 v111, v95, 16, v94
    v_mov_b32 v20, 0
    v_mov_b32 v21, 0
    v_mov_b32 v22, 0
    v_mov_b32 v23, 0
    ds_write_b128 v5, v[96:99] offset:0
    ds_write_b128 v5, v[100:103] offset:1024
    ds_write_b128 v5, v[104:107] offset:2048
    ds_write_b128 v5, v[108:111] offset:3072
    s_mov_b64 exec, 3
    ds_write_b128 v5, v[20:23] offset:4096
    ds_write_b128 v5, v[20:23] offset:8256
    ds_write_b128 v5, v[20:23] offset:12416
    ds_write_b128 v5, v[20:23] offset:16576
    s_mov_b64 exec, -1
    s_mov_b32 exec_hi, 0
    ds_write_b128 v5, v[20:23] offset:16640
    s_mov_b64 exec, -1
    s_waitcnt lgkmcnt(0)
    ds_read_b64 v[112:113], v5 offset:16
    ds_read_b64 v[114:115], v5 offset:1040
    ds_read_b64 v[116:117], v5 offset:2064
    ds_read_b64 v[118:119], v5 offset:3088
    s_waitcnt lgkmcnt(3)
    v_alignbit_b32 v128, v97, v96, 16
    v_alignbit_b32 v129, v98, v97, 16
    v_alignbit_b32 v130, v99, v98, 16
    v_alignbit_b32 v131, v112, v99, 16
    v_alignbit_b32 v132, v113, v112, 16
    v_mov_b32 v160, v97
    v_mov_b32 v161, v98
    v_mov_b32 v162, v99
    v_mov_b32 v163, v112
    v_mov_b32 v176, v129
    v_mov_b32 v177, v130
    v_mov_b32 v178, v131
    v_mov_b32 v179, v132
    ds_write_b128 v5, v[128:131] offset:4160
    ds_write_b128 v5, v[160:163] offset:8320
    ds_write_b128 v5, v[176:179] offset:12480
    s_waitcnt lgkmcnt(5)
    v_alignbit_b32 v136, v101, v100, 16
    v_alignbit_b32 v137, v102, v101, 16
    v_alignbit_b32 v138, v103, v102, 16
    v_alignbit_b32 v139, v114, v103, 16
    v_alignbit_b32 v140, v115, v114, 16
    v_mov_b32 v164, v101
    v_mov_b32 v165, v102
    v_mov_b32 v166, v103
    v_mov_b32 v167, v114
    v_mov_b32 v180, v137
    v_mov_b32 v181, v138
    v_mov_b32 v182, v139
    v_mov_b32 v183, v140
    ds_write_b128 v5, v[136:139] offset:5184
    ds_write_b128 v5, v[164:167] offset:9344
    ds_write_b128 v5, v[180:183] offset:13504
    s_waitcnt lgkmcnt(7)
    v_alignbit_b32 v144, v105, v104, 16
    v_alignbit_b32 v145, v106, v105, 16
    v_alignbit_b32 v146, v107, v106, 16
    v_alignbit_b32 v147, v116, v107, 16
    v_alignbit_b32 v148, v117, v116, 16
    v_mov_b32 v168, v105
    v_mov_b32 v169, v106
    v_mov_b32 v170, v107
    v_mov_b32 v171, v116
    v_mov_b32 v184, v145
    v_mov_b32 v185, v146
    v_mov_b32 v186, v147
    v_mov_b32 v187, v148
    ds_write_b128 v5, v[144:147] offset:6208
    ds_write_b128 v5, v[168:171] offset:10368
    ds_write_b128 v5, v[184:187] offset:14528
    s_waitcnt lgkmcnt(9)
    v_alignbit_b32 v152, v109, v108, 16
    v_alignbit_b32 v153, v110, v109, 16
    v_alignbit_b32 v154, v111, v110, 16
    v_alignbit_b32 v155, v118, v111, 16
    v_alignbit_b32 v156, v119, v118, 16
    v_mov_b32 v172, v109
    v_mov_b32 v173, v110
    v_mov_b32 v174, v111
    v_mov_b32 v175, v118
    v_mov_b32 v188, v153
    v_mov_b32 v189, v154
    v_mov_b32 v190, v155
    v_mov_b32 v191, v156
    ds_write_b128 v5, v[152:155] offset:7232
    ds_write_b128 v5, v[172:175] offset:11392
    ds_write_b128 v5, v[188:191] offset:15552
    s_waitcnt vmcnt(3)
    ds_write_b128 v5, v[40:43] offset:17152
    s_waitcnt vmcnt(2)
    ds_write_b128 v5, v[44:47] offset:18176
    s_waitcnt vmcnt(1)
    ds_write_b128 v5, v[48:51] offset:19200
    s_waitcnt vmcnt(0)
    ds_write_b128 v5, v[52:55] offset:20224
L_kc_bar3_33:
    s_add_u32 s8, s50, 0x1000000
    s_addc_u32 s9, s51, 0
    s_mov_b32 s10, 0x280000
    s_mov_b32 s11, 0x00020000
    s_lshl_b32 s31, s37, 1
    s_and_b32 s31, s31, 0xfffffffc
    s_load_dword s48, s[52:53], s31
    s_add_u32 s31, s31, 4
    s_min_u32 s31, s31, 1276
    s_load_dword s49, s[52:53], s31
    v_and_b32 v3, 3, v1
    v_sub_u32 v3, 3, v3
    v_mul_u32_u24 v6, 4160, v3
    v_and_b32 v3, 12, v1
    v_lshlrev_b32 v3, 1, v3
    v_sub_u32 v6, v6, v3
    v_lshrrev_b32 v4, 4, v1
    v_lshl_add_u32 v6, v4, 4, v6
    v_add_u32 v6, 24, v6
    v_and_b32 v3, 15, v1
    v_lshlrev_b32 v7, 5, v3
    v_lshl_add_u32 v8, v4, 3, v7
    v_lshl_add_u32 v7, v4, 4, v7
    v_add_u32 v7, 16672, v7
    v_add_u32 v8, 17152, v8
    s_waitcnt lgkmcnt(0)
    s_and_b32 s30, s37, 1
    s_lshl_b32 s30, s30, 4
    s_lshr_b64 s[48:49], s[48:49], s30
    s_lshl_b32 s44, s48, 16
    s_and_b32 s45, s48, 0xffff0000
    s_lshl_b32 s46, s49, 16
    s_barrier
    s_cmp_eq_u32 s4, 3
    s_cbranch_scc1 L_kc_chelp_34
    s_cmp_ge_u32 s4, s38
    s_cbranch_scc1 L_kc_bar4_35
    v_add_u32 v10, s33, v6
    v_add_u32 v11, s33, v7
    ds_read_b64 v[64:65], v10 offset:4032
    ds_read_b64 v[66:67], v10 offset:4040
    ds_read_b64 v[68:69], v10 offset:3520
    ds_read_b64 v[70:71], v10 offset:3528
    ds_read_b64 v[72:73], v10 offset:3008
    ds_read_b64 v[74:75], v10 offset:3016
    ds_read_b64 v[76:77], v10 offset:2496
    ds_read_b64 v[78:79], v10 offset:2504
    ds_read_b64 v[80:81], v10 offset:1984
    ds_read_b64 v[82:83], v10 offset:1992
    ds_read_b64 v[84:85], v10 offset:1472
    ds_read_b64 v[86:87], v10 offset:1480
    ds_read_b64 v[88:89], v10 offset:960
    ds_read_b64 v[90:91], v10 offset:968
    ds_read_b64 v[92:93], v10 offset:448
    ds_read_b64 v[94:95], v10 offset:456
    ds_read_b128 v[96:99], v11 offset:448
    ds_read_b128 v[100:103], v11 offset:960
    ds_read_b128 v[104:107], v11 offset:1472
    ds_read_b128 v[108:111], v11 offset:1984
    ds_read_b128 v[112:115], v11 offset:2496
    ds_read_b128 v[116:119], v11 offset:3008
    ds_read_b128 v[120:123], v11 offset:3520
    ds_read_b128 v[124:127], v11 offset:4032
    s_waitcnt lgkmcnt(0)
    ds_read_b64 v[128:129], v10 offset:3968
    ds_read_b64 v[130:131], v10 offset:3976
    ds_read_b64 v[132:133], v10 offset:3456
    ds_read_b64 v[134:135], v10 offset:3464
    ds_read_b64 v[136:137], v10 offset:2944
    ds_read_b64 v[138:139], v10 offset:2952
    ds_read_b64 v[140:141], v10 offset:2432
    ds_read_b64 v[142:143], v10 offset:2440
    ds_read_b64 v[144:145], v10 offset:1920
    ds_read_b64 v[146:147], v10 offset:1928
    ds_read_b64 v[148:149], v10 offset:1408
    ds_read_b64 v[150:151], v10 offset:1416
    ds_read_b64 v[152:153], v10 offset:896
    ds_read_b64 v[154:155], v10 offset:904
    ds_read_b64 v[156:157], v10 offset:384
    ds_read_b64 v[158:159], v10 offset:392
    ds_read_b128 v[160:163], v11 offset:384
    ds_read_b128 v[164:167], v11 offset:896
    ds_read_b128 v[168:171], v11 offset:1408
    ds_read_b128 v[172:175], v11 offset:1920
    ds_read_b128 v[176:179], v11 offset:2432
    ds_read_b128 v[180:183], v11 offset:2944
    ds_read_b128 v[184:187], v11 offset:3456
    ds_read_b128 v[188:191], v11 offset:3968
    v_mfma_f32_16x16x32_bf16 v[16:19], v[64:67], v[96:99], 0
    v_mfma_f32_16x16x32_bf16 v[20:23], v[64:67], v[112:115], 0
    v_mfma_f32_16x16x32_bf16 v[24:27], v[64:67], v[116:119], 0
    v_mfma_f32_16x16x32_bf16 v[28:31], v[64:67], v[120:123], 0
    v_mfma_f32_16x16x32_bf16 v[32:35], v[64:67], v[124:127], 0
    v_mfma_f32_16x16x32_bf16 v[20:23], v[68:71], v[108:111], v[20:23]
    v_mfma_f32_16x16x32_bf16 v[24:27], v[68:71], v[112:115], v[24:27]
    v_mfma_f32_16x16x32_bf16 v[28:31], v[68:71], v[116:119], v[28:31]
    v_mfma_f32_16x16x32_bf16 v[32:35], v[68:71], v[120:123], v[32:35]
    v_mfma_f32_16x16x32_bf16 v[20:23], v[72:75], v[104:107], v[20:23]
    v_mfma_f32_16x16x32_bf16 v[24:27], v[72:75], v[108:111], v[24:27]
    v_mfma_f32_16x16x32_bf16 v[28:31], v[72:75], v[112:115], v[28:31]
    v_mfma_f32_16x16x32_bf16 v[32:35], v[72:75], v[116:119], v[32:35]
    v_mfma_f32_16x16x32_bf16 v[20:23], v[76:79], v[100:103], v[20:23]
    v_mfma_f32_16x16x32_bf16 v[24:27], v[76:79], v[104:107], v[24:27]
    v_mfma_f32_16x16x32_bf16 v[28:31], v[76:79], v[108:111], v[28:31]
    v_mfma_f32_16x16x32_bf16 v[32:35], v[76:79], v[112:115], v[32:35]
    v_mfma_f32_16x16x32_bf16 v[20:23], v[80:83], v[96:99], v[20:23]
    v_mfma_f32_16x16x32_bf16 v[24:27], v[80:83], v[100:103], v[24:27]
    v_mfma_f32_16x16x32_bf16 v[28:31], v[80:83], v[104:107], v[28:31]
    v_mfma_f32_16x16x32_bf16 v[32:35], v[80:83], v[108:111], v[32:35]
    v_mfma_f32_16x16x32_bf16 v[24:27], v[84:87], v[96:99], v[24:27]
    v_mfma_f32_16x16x32_bf16 v[28:31], v[84:87], v[100:103], v[28:31]
    v_mfma_f32_16x16x32_bf16 v[32:35], v[84:87], v[104:107], v[32:35]
    v_mfma_f32_16x16x32_bf16 v[28:31], v[88:91], v[96:99], v[28:31]
    v_mfma_f32_16x16x32_bf16 v[32:35], v[88:91], v[100:103], v[32:35]
    v_mfma_f32_16x16x32_bf16 v[32:35], v[92:95], v[96:99], v[32:35]
    s_waitcnt lgkmcnt(0)
    ds_read_b64 v[64:65], v10 offset:3904
    ds_read_b64 v[66:67], v10 offset:3912
    ds_read_b64 v[68:69], v10 offset:3392
    ds_read_b64 v[70:71], v10 offset:3400
    ds_read_b64 v[72:73], v10 offset:2880
    ds_read_b64 v[74:75], v10 offset:2888
    ds_read_b64 v[76:77], v10 offset:2368
    ds_read_b64 v[78:79], v10 offset:2376
    ds_read_b64 v[80:81], v10 offset:1856
    ds_read_b64 v[82:83], v10 offset:1864
    ds_read_b64 v[84:85], v10 offset:1344
    ds_read_b64 v[86:87], v10 offset:1352
    ds_read_b64 v[88:89], v10 offset:832
    ds_read_b64 v[90:91], v10 offset:840
    ds_read_b64 v[92:93], v10 offset:320
    ds_read_b64 v[94:95], v10 offset:328
    ds_read_b128 v[96:99], v11 offset:320
    ds_read_b128 v[100:103], v11 offset:832
    ds_read_b128 v[104:107], v11 offset:1344
    ds_read_b128 v[108:111], v11 offset:1856
    ds_read_b128 v[112:115], v11 offset:2368
    ds_read_b128 v[116:119], v11 offset:2880
    ds_read_b128 v[120:123], v11 offset:3392
    ds_read_b128 v[124:127], v11 offset:3904
    v_mfma_f32_16x16x32_bf16 v[16:19], v[128:131], v[160:163], v[16:19]
    v_mfma_f32_16x16x32_bf16 v[20:23], v[128:131], v[176:179], v[20:23]
    v_mfma_f32_16x16x32_bf16 v[24:27], v[128:131], v[180:183], v[24:27]
    v_mfma_f32_16x16x32_bf16 v[28:31], v[128:131], v[184:187], v[28:31]
    v_mfma_f32_16x16x32_bf16 v[32:35], v[128:131], v[188:191], v[32:35]
    v_mfma_f32_16x16x32_bf16 v[20:23], v[132:135], v[172:175], v[20:23]
    v_mfma_f32_16x16x32_bf16 v[24:27], v[132:135], v[176:179], v[24:27]
    v_mfma_f32_16x16x32_bf16 v[28:31], v[132:135], v[180:183], v[28:31]
    v_mfma_f32_16x16x32_bf16 v[32:35], v[132:135], v[184:187], v[32:35]
    v_mfma_f32_16x16x32_bf16 v[20:23], v[136:139], v[168:171], v[20:23]
    v_mfma_f32_16x16x32_bf16 v[24:27], v[136:139], v[172:175], v[24:27]
    v_mfma_f32_16x16x32_bf16 v[28:31], v[136:139], v[176:179], v[28:31]
    v_mfma_f32_16x16x32_bf16 v[32:35], v[136:139], v[180:183], v[32:35]
    v_mfma_f32_16x16x32_bf16 v[20:23], v[140:143], v[164:167], v[20:23]
    v_mfma_f32_16x16x32_bf16 v[24:27], v[140:143], v[168:171], v[24:27]
    v_mfma_f32_16x16x32_bf16 v[28:31], v[140:143], v[172:175], v[28:31]
    v_mfma_f32_16x16x32_bf16 v[32:35], v[140:143], v[176:179], v[32:35]
    v_mfma_f32_16x16x32_bf16 v[20:23], v[144:147], v[160:163], v[20:23]
    v_mfma_f32_16x16x32_bf16 v[24:27], v[144:147], v[164:167], v[24:27]
    v_mfma_f32_16x16x32_bf16 v[28:31], v[144:147], v[168:171], v[28:31]
    v_mfma_f32_16x16x32_bf16 v[32:35], v[144:147], v[172:175], v[32:35]
    v_mfma_f32_16x16x32_bf16 v[24:27], v[148:151], v[160:163], v[24:27]
    v_mfma_f32_16x16x32_bf16 v[28:31], v[148:151], v[164:167], v[28:31]
    v_mfma_f32_16x16x32_bf16 v[32:35], v[148:151], v[168:171], v[32:35]
    v_mfma_f32_16x16x32_bf16 v[28:31], v[152:155], v[160:163], v[28:31]
    v_mfma_f32_16x16x32_bf16 v[32:35], v[152:155], v[164:167], v[32:35]
    v_mfma_f32_16x16x32_bf16 v[32:35], v[156:159], v[160:163], v[32:35]
    s_waitcnt lgkmcnt(0)
    ds_read_b64 v[128:129], v10 offset:3840
    ds_read_b64 v[130:131], v10 offset:3848
    ds_read_b64 v[132:133], v10 offset:3328
    ds_read_b64 v[134:135], v10 offset:3336
    ds_read_b64 v[136:137], v10 offset:2816
    ds_read_b64 v[138:139], v10 offset:2824
    ds_read_b64 v[140:141], v10 offset:2304
    ds_read_b64 v[142:143], v10 offset:2312
    ds_read_b64 v[144:145], v10 offset:1792
    ds_read_b64 v[146:147], v10 offset:1800
    ds_read_b64 v[148:149], v10 offset:1280
    ds_read_b64 v[150:151], v10 offset:1288
    ds_read_b64 v[152:153], v10 offset:768
    ds_read_b64 v[154:155], v10 offset:776
    ds_read_b64 v[156:157], v10 offset:256
    ds_read_b64 v[158:159], v10 offset:264
    ds_read_b128 v[160:163], v11 offset:256
    ds_read_b128 v[164:167], v11 offset:768
    ds_read_b128 v[168:171], v11 offset:1280
    ds_read_b128 v[172:175], v11 offset:1792
    ds_read_b128 v[176:179], v11 offset:2304
    ds_read_b128 v[180:183], v11 offset:2816
    ds_read_b128 v[184:187], v11 offset:3328
    ds_read_b128 v[188:191], v11 offset:3840
    v_mfma_f32_16x16x32_bf16 v[16:19], v[64:67], v[96:99], v[16:19]
    v_mfma_f32_16x16x32_bf16 v[20:23], v[64:67], v[112:115], v[20:23]
    v_mfma_f32_16x16x32_bf16 v[24:27], v[64:67], v[116:119], v[24:27]
    v_mfma_f32_16x16x32_bf16 v[28:31], v[64:67], v[120:123], v[28:31]
    v_mfma_f32_16x16x32_bf16 v[32:35], v[64:67], v[124:127], v[32:35]
    v_mfma_f32_16x16x32_bf16 v[20:23], v[68:71], v[108:111], v[20:23]
    v_mfma_f32_16x16x32_bf16 v[24:27], v[68:71], v[112:115], v[24:27]
    v_mfma_f32_16x16x32_bf16 v[28:31], v[68:71], v[116:119], v[28:31]
    v_mfma_f32_16x16x32_bf16 v[32:35], v[68:71], v[120:123], v[32:35]
    v_mfma_f32_16x16x32_bf16 v[20:23], v[72:75], v[104:107], v[20:23]
    v_mfma_f32_16x16x32_bf16 v[24:27], v[72:75], v[108:111], v[24:27]
    v_mfma_f32_16x16x32_bf16 v[28:31], v[72:75], v[112:115], v[28:31]
    v_mfma_f32_16x16x32_bf16 v[32:35], v[72:75], v[116:119], v[32:35]
    v_mfma_f32_16x16x32_bf16 v[20:23], v[76:79], v[100:103], v[20:23]
    v_mfma_f32_16x16x32_bf16 v[24:27], v[76:79], v[104:107], v[24:27]
    v_mfma_f32_16x16x32_bf16 v[28:31], v[76:79], v[108:111], v[28:31]
    v_mfma_f32_16x16x32_bf16 v[32:35], v[76:79], v[112:115], v[32:35]
    v_mfma_f32_16x16x32_bf16 v[20:23], v[80:83], v[96:99], v[20:23]
    v_mfma_f32_16x16x32_bf16 v[24:27], v[80:83], v[100:103], v[24:27]
    v_mfma_f32_16x16x32_bf16 v[28:31], v[80:83], v[104:107], v[28:31]
    v_mfma_f32_16x16x32_bf16 v[32:35], v[80:83], v[108:111], v[32:35]
    v_mfma_f32_16x16x32_bf16 v[24:27], v[84:87], v[96:99], v[24:27]
    v_mfma_f32_16x16x32_bf16 v[28:31], v[84:87], v[100:103], v[28:31]
    v_mfma_f32_16x16x32_bf16 v[32:35], v[84:87], v[104:107], v[32:35]
    v_mfma_f32_16x16x32_bf16 v[28:31], v[88:91], v[96:99], v[28:31]
    v_mfma_f32_16x16x32_bf16 v[32:35], v[88:91], v[100:103], v[32:35]
    v_mfma_f32_16x16x32_bf16 v[32:35], v[92:95], v[96:99], v[32:35]
    s_waitcnt lgkmcnt(0)
    ds_read_b64 v[64:65], v10 offset:3776
    ds_read_b64 v[66:67], v10 offset:3784
    ds_read_b64 v[68:69], v10 offset:3264
    ds_read_b64 v[70:71], v10 offset:3272
    ds_read_b64 v[72:73], v10 offset:2752
    ds_read_b64 v[74:75], v10 offset:2760
    ds_read_b64 v[76:77], v10 offset:2240
    ds_read_b64 v[78:79], v10 offset:2248
    ds_read_b64 v[80:81], v10 offset:1728
    ds_read_b64 v[82:83], v10 offset:1736
    ds_read_b64 v[84:85], v10 offset:1216
    ds_read_b64 v[86:87], v10 offset:1224
    ds_read_b64 v[88:89], v10 offset:704
    ds_read_b64 v[90:91], v10 offset:712
    ds_read_b64 v[92:93], v10 offset:192
    ds_read_b64 v[94:95], v10 offset:200
    ds_read_b128 v[96:99], v11 offset:192
    ds_read_b128 v[100:103], v11 offset:704
    ds_read_b128 v[104:107], v11 offset:1216
    ds_read_b128 v[108:111], v11 offset:1728
    ds_read_b128 v[112:115], v11 offset:2240
    ds_read_b128 v[116:119], v11 offset:2752
    ds_read_b128 v[120:123], v11 offset:3264
    ds_read_b128 v[124:127], v11 offset:3776
    v_mfma_f32_16x16x32_bf16 v[16:19], v[128:131], v[160:163], v[16:19]
    v_mfma_f32_16x16x32_bf16 v[20:23], v[128:131], v[176:179], v[20:23]
    v_mfma_f32_16x16x32_bf16 v[24:27], v[128:131], v[180:183], v[24:27]
    v_mfma_f32_16x16x32_bf16 v[28:31], v[128:131], v[184:187], v[28:31]
    v_mfma_f32_16x16x32_bf16 v[32:35], v[128:131], v[188:191], v[32:35]
    v_mfma_f32_16x16x32_bf16 v[20:23], v[132:135], v[172:175], v[20:23]
    v_mfma_f32_16x16x32_bf16 v[24:27], v[132:135], v[176:179], v[24:27]
    v_mfma_f32_16x16x32_bf16 v[28:31], v[132:135], v[180:183], v[28:31]
    v_mfma_f32_16x16x32_bf16 v[32:35], v[132:135], v[184:187], v[32:35]
    v_mfma_f32_16x16x32_bf16 v[20:23], v[136:139], v[168:171], v[20:23]
    v_mfma_f32_16x16x32_bf16 v[24:27], v[136:139], v[172:175], v[24:27]
    v_mfma_f32_16x16x32_bf16 v[28:31], v[136:139], v[176:179], v[28:31]
    v_mfma_f32_16x16x32_bf16 v[32:35], v[136:139], v[180:183], v[32:35]
    v_mfma_f32_16x16x32_bf16 v[20:23], v[140:143], v[164:167], v[20:23]
    v_mfma_f32_16x16x32_bf16 v[24:27], v[140:143], v[168:171], v[24:27]
    v_mfma_f32_16x16x32_bf16 v[28:31], v[140:143], v[172:175], v[28:31]
    v_mfma_f32_16x16x32_bf16 v[32:35], v[140:143], v[176:179], v[32:35]
    v_mfma_f32_16x16x32_bf16 v[20:23], v[144:147], v[160:163], v[20:23]
    v_mfma_f32_16x16x32_bf16 v[24:27], v[144:147], v[164:167], v[24:27]
    v_mfma_f32_16x16x32_bf16 v[28:31], v[144:147], v[168:171], v[28:31]
    v_mfma_f32_16x16x32_bf16 v[32:35], v[144:147], v[172:175], v[32:35]
    v_mfma_f32_16x16x32_bf16 v[24:27], v[148:151], v[160:163], v[24:27]
    v_mfma_f32_16x16x32_bf16 v[28:31], v[148:151], v[164:167], v[28:31]
    v_mfma_f32_16x16x32_bf16 v[32:35], v[148:151], v[168:171], v[32:35]
    v_mfma_f32_16x16x32_bf16 v[28:31], v[152:155], v[160:163], v[28:31]
    v_mfma_f32_16x16x32_bf16 v[32:35], v[152:155], v[164:167], v[32:35]
    v_mfma_f32_16x16x32_bf16 v[32:35], v[156:159], v[160:163], v[32:35]
    s_waitcnt lgkmcnt(0)
    ds_read_b64 v[128:129], v10 offset:3712
    ds_read_b64 v[130:131], v10 offset:3720
    ds_read_b64 v[132:133], v10 offset:3200
    ds_read_b64 v[134:135], v10 offset:3208
    ds_read_b64 v[136:137], v10 offset:2688
    ds_read_b64 v[138:139], v10 offset:2696
    ds_read_b64 v[140:141], v10 offset:2176
    ds_read_b64 v[142:143], v10 offset:2184
    ds_read_b64 v[144:145], v10 offset:1664
    ds_read_b64 v[146:147], v10 offset:1672
    ds_read_b64 v[148:149], v10 offset:1152
    ds_read_b64 v[150:151], v10 offset:1160
    ds_read_b64 v[152:153], v10 offset:640
    ds_read_b64 v[154:155], v10 offset:648
    ds_read_b64 v[156:157], v10 offset:128
    ds_read_b64 v[158:159], v10 offset:136
    ds_read_b128 v[160:163], v11 offset:128
    ds_read_b128 v[164:167], v11 offset:640
    ds_read_b128 v[168:171], v11 offset:1152
    ds_read_b128 v[172:175], v11 offset:1664
    ds_read_b128 v[176:179], v11 offset:2176
    ds_read_b128 v[180:183], v11 offset:2688
    ds_read_b128 v[184:187], v11 offset:3200
    ds_read_b128 v[188:191], v11 offset:3712
    v_mfma_f32_16x16x32_bf16 v[16:19], v[64:67], v[96:99], v[16:19]
    v_mfma_f32_16x16x32_bf16 v[20:23], v[64:67], v[112:115], v[20:23]
    v_mfma_f32_16x16x32_bf16 v[24:27], v[64:67], v[116:119], v[24:27]
    v_mfma_f32_16x16x32_bf16 v[28:31], v[64:67], v[120:123], v[28:31]
    v_mfma_f32_16x16x32_bf16 v[32:35], v[64:67], v[124:127], v[32:35]
    v_mfma_f32_16x16x32_bf16 v[20:23], v[68:71], v[108:111], v[20:23]
    v_mfma_f32_16x16x32_bf16 v[24:27], v[68:71], v[112:115], v[24:27]
    v_mfma_f32_16x16x32_bf16 v[28:31], v[68:71], v[116:119], v[28:31]
    v_mfma_f32_16x16x32_bf16 v[32:35], v[68:71], v[120:123], v[32:35]
    v_mfma_f32_16x16x32_bf16 v[20:23], v[72:75], v[104:107], v[20:23]
    v_mfma_f32_16x16x32_bf16 v[24:27], v[72:75], v[108:111], v[24:27]
    v_mfma_f32_16x16x32_bf16 v[28:31], v[72:75], v[112:115], v[28:31]
    v_mfma_f32_16x16x32_bf16 v[32:35], v[72:75], v[116:119], v[32:35]
    v_mfma_f32_16x16x32_bf16 v[20:23], v[76:79], v[100:103], v[20:23]
    v_mfma_f32_16x16x32_bf16 v[24:27], v[76:79], v[104:107], v[24:27]
    v_mfma_f32_16x16x32_bf16 v[28:31], v[76:79], v[108:111], v[28:31]
    v_mfma_f32_16x16x32_bf16 v[32:35], v[76:79], v[112:115], v[32:35]
    v_mfma_f32_16x16x32_bf16 v[20:23], v[80:83], v[96:99], v[20:23]
    v_mfma_f32_16x16x32_bf16 v[24:27], v[80:83], v[100:103], v[24:27]
    v_mfma_f32_16x16x32_bf16 v[28:31], v[80:83], v[104:107], v[28:31]
    v_mfma_f32_16x16x32_bf16 v[32:35], v[80:83], v[108:111], v[32:35]
    v_mfma_f32_16x16x32_bf16 v[24:27], v[84:87], v[96:99], v[24:27]
    v_mfma_f32_16x16x32_bf16 v[28:31], v[84:87], v[100:103], v[28:31]
    v_mfma_f32_16x16x32_bf16 v[32:35], v[84:87], v[104:107], v[32:35]
    v_mfma_f32_16x16x32_bf16 v[28:31], v[88:91], v[96:99], v[28:31]
    v_mfma_f32_16x16x32_bf16 v[32:35], v[88:91], v[100:103], v[32:35]
    v_mfma_f32_16x16x32_bf16 v[32:35], v[92:95], v[96:99], v[32:35]
    s_waitcnt lgkmcnt(0)
    ds_read_b64 v[64:65], v10 offset:3648
    ds_read_b64 v[66:67], v10 offset:3656
    ds_read_b64 v[68:69], v10 offset:3136
    ds_read_b64 v[70:71], v10 offset:3144
    ds_read_b64 v[72:73], v10 offset:2624
    ds_read_b64 v[74:75], v10 offset:2632
    ds_read_b64 v[76:77], v10 offset:2112
    ds_read_b64 v[78:79], v10 offset:2120
    ds_read_b64 v[80:81], v10 offset:1600
    ds_read_b64 v[82:83], v10 offset:1608
    ds_read_b64 v[84:85], v10 offset:1088
    ds_read_b64 v[86:87], v10 offset:1096
    ds_read_b64 v[88:89], v10 offset:576
    ds_read_b64 v[90:91], v10 offset:584
    ds_read_b64 v[92:93], v10 offset:64
    ds_read_b64 v[94:95], v10 offset:72
    ds_read_b128 v[96:99], v11 offset:64
    ds_read_b128 v[100:103], v11 offset:576
    ds_read_b128 v[104:107], v11 offset:1088
    ds_read_b128 v[108:111], v11 offset:1600
    ds_read_b128 v[112:115], v11 offset:2112
    ds_read_b128 v[116:119], v11 offset:2624
    ds_read_b128 v[120:123], v11 offset:3136
    ds_read_b128 v[124:127], v11 offset:3648
    v_mfma_f32_16x16x32_bf16 v[16:19], v[128:131], v[160:163], v[16:19]
    v_mfma_f32_16x16x32_bf16 v[20:23], v[128:131], v[176:179], v[20:23]
    v_mfma_f32_16x16x32_bf16 v[24:27], v[128:131], v[180:183], v[24:27]
    v_mfma_f32_16x16x32_bf16 v[28:31], v[128:131], v[184:187], v[28:31]
    v_mfma_f32_16x16x32_bf16 v[32:35], v[128:131], v[188:191], v[32:35]
    v_mfma_f32_16x16x32_bf16 v[20:23], v[132:135], v[172:175], v[20:23]
    v_mfma_f32_16x16x32_bf16 v[24:27], v[132:135], v[176:179], v[24:27]
    v_mfma_f32_16x16x32_bf16 v[28:31], v[132:135], v[180:183], v[28:31]
    v_mfma_f32_16x16x32_bf16 v[32:35], v[132:135], v[184:187], v[32:35]
    v_mfma_f32_16x16x32_bf16 v[20:23], v[136:139], v[168:171], v[20:23]
    v_mfma_f32_16x16x32_bf16 v[24:27], v[136:139], v[172:175], v[24:27]
    v_mfma_f32_16x16x32_bf16 v[28:31], v[136:139], v[176:179], v[28:31]
    v_mfma_f32_16x16x32_bf16 v[32:35], v[136:139], v[180:183], v[32:35]
    v_mfma_f32_16x16x32_bf16 v[20:23], v[140:143], v[164:167], v[20:23]
    v_mfma_f32_16x16x32_bf16 v[24:27], v[140:143], v[168:171], v[24:27]
    v_mfma_f32_16x16x32_bf16 v[28:31], v[140:143], v[172:175], v[28:31]
    v_mfma_f32_16x16x32_bf16 v[32:35], v[140:143], v[176:179], v[32:35]
    v_mfma_f32_16x16x32_bf16 v[20:23], v[144:147], v[160:163], v[20:23]
    v_mfma_f32_16x16x32_bf16 v[24:27], v[144:147], v[164:167], v[24:27]
    v_mfma_f32_16x16x32_bf16 v[28:31], v[144:147], v[168:171], v[28:31]
    v_mfma_f32_16x16x32_bf16 v[32:35], v[144:147], v[172:175], v[32:35]
    v_mfma_f32_16x16x32_bf16 v[24:27], v[148:151], v[160:163], v[24:27]
    v_mfma_f32_16x16x32_bf16 v[28:31], v[148:151], v[164:167], v[28:31]
    v_mfma_f32_16x16x32_bf16 v[32:35], v[148:151], v[168:171], v[32:35]
    v_mfma_f32_16x16x32_bf16 v[28:31], v[152:155], v[160:163], v[28:31]
    v_mfma_f32_16x16x32_bf16 v[32:35], v[152:155], v[164:167], v[32:35]
    v_mfma_f32_16x16x32_bf16 v[32:35], v[156:159], v[160:163], v[32:35]
    s_waitcnt lgkmcnt(0)
    ds_read_b64 v[128:129], v10 offset:3584
    ds_read_b64 v[130:131], v10 offset:3592
    ds_read_b64 v[132:133], v10 offset:3072
    ds_read_b64 v[134:135], v10 offset:3080
    ds_read_b64 v[136:137], v10 offset:2560
    ds_read_b64 v[138:139], v10 offset:2568
    ds_read_b64 v[140:141], v10 offset:2048
    ds_read_b64 v[142:143], v10 offset:2056
    ds_read_b64 v[144:145], v10 offset:1536
    ds_read_b64 v[146:147], v10 offset:1544
    ds_read_b64 v[148:149], v10 offset:1024
    ds_read_b64 v[150:151], v10 offset:1032
    ds_read_b64 v[152:153], v10 offset:512
    ds_read_b64 v[154:155], v10 offset:520
    ds_read_b64 v[156:157], v10 offset:0
    ds_read_b64 v[158:159], v10 offset:8
    ds_read_b128 v[160:163], v11 offset:0
    ds_read_b128 v[164:167], v11 offset:512
    ds_read_b128 v[168:171], v11 offset:1024
    ds_read_b128 v[172:175], v11 offset:1536
    ds_read_b128 v[176:179], v11 offset:2048
    ds_read_b128 v[180:183], v11 offset:2560
    ds_read_b128 v[184:187], v11 offset:3072
    ds_read_b128 v[188:191], v11 offset:3584
    v_mfma_f32_16x16x32_bf16 v[16:19], v[64:67], v[96:99], v[16:19]
    v_mfma_f32_16x16x32_bf16 v[20:23], v[64:67], v[112:115], v[20:23]
    v_mfma_f32_16x16x32_bf16 v[24:27], v[64:67], v[116:119], v[24:27]
    v_mfma_f32_16x16x32_bf16 v[28:31], v[64:67], v[120:123], v[28:31]
    v_mfma_f32_16x16x32_bf16 v[32:35], v[64:67], v[124:127], v[32:35]
    v_mfma_f32_16x16x32_bf16 v[20:23], v[68:71], v[108:111], v[20:23]
    v_mfma_f32_16x16x32_bf16 v[24:27], v[68:71], v[112:115], v[24:27]
    v_mfma_f32_16x16x32_bf16 v[28:31], v[68:71], v[116:119], v[28:31]
    v_mfma_f32_16x16x32_bf16 v[32:35], v[68:71], v[120:123], v[32:35]
    v_mfma_f32_16x16x32_bf16 v[20:23], v[72:75], v[104:107], v[20:23]
    v_mfma_f32_16x16x32_bf16 v[24:27], v[72:75], v[108:111], v[24:27]
    v_mfma_f32_16x16x32_bf16 v[28:31], v[72:75], v[112:115], v[28:31]
    v_mfma_f32_16x16x32_bf16 v[32:35], v[72:75], v[116:119], v[32:35]
    v_mfma_f32_16x16x32_bf16 v[20:23], v[76:79], v[100:103], v[20:23]
    v_mfma_f32_16x16x32_bf16 v[24:27], v[76:79], v[104:107], v[24:27]
    v_mfma_f32_16x16x32_bf16 v[28:31], v[76:79], v[108:111], v[28:31]
    v_mfma_f32_16x16x32_bf16 v[32:35], v[76:79], v[112:115], v[32:35]
    v_mfma_f32_16x16x32_bf16 v[20:23], v[80:83], v[96:99], v[20:23]
    v_mfma_f32_16x16x32_bf16 v[24:27], v[80:83], v[100:103], v[24:27]
    v_mfma_f32_16x16x32_bf16 v[28:31], v[80:83], v[104:107], v[28:31]
    v_mfma_f32_16x16x32_bf16 v[32:35], v[80:83], v[108:111], v[32:35]
    v_mfma_f32_16x16x32_bf16 v[24:27], v[84:87], v[96:99], v[24:27]
    v_mfma_f32_16x16x32_bf16 v[28:31], v[84:87], v[100:103], v[28:31]
    v_mfma_f32_16x16x32_bf16 v[32:35], v[84:87], v[104:107], v[32:35]
    v_mfma_f32_16x16x32_bf16 v[28:31], v[88:91], v[96:99], v[28:31]
    v_mfma_f32_16x16x32_bf16 v[32:35], v[88:91], v[100:103], v[32:35]
    v_mfma_f32_16x16x32_bf16 v[32:35], v[92:95], v[96:99], v[32:35]
    s_waitcnt lgkmcnt(0)
    v_mfma_f32_16x16x32_bf16 v[16:19], v[128:131], v[160:163], v[16:19]
    v_mfma_f32_16x16x32_bf16 v[20:23], v[128:131], v[176:179], v[20:23]
    v_mfma_f32_16x16x32_bf16 v[24:27], v[128:131], v[180:183], v[24:27]
    v_mfma_f32_16x16x32_bf16 v[28:31], v[128:131], v[184:187], v[28:31]
    v_mfma_f32_16x16x32_bf16 v[32:35], v[128:131], v[188:191], v[32:35]
    v_mfma_f32_16x16x32_bf16 v[20:23], v[132:135], v[172:175], v[20:23]
    v_mfma_f32_16x16x32_bf16 v[24:27], v[132:135], v[176:179], v[24:27]
    v_mfma_f32_16x16x32_bf16 v[28:31], v[132:135], v[180:183], v[28:31]
    v_mfma_f32_16x16x32_bf16 v[32:35], v[132:135], v[184:187], v[32:35]
    v_mfma_f32_16x16x32_bf16 v[20:23], v[136:139], v[168:171], v[20:23]
    v_mfma_f32_16x16x32_bf16 v[24:27], v[136:139], v[172:175], v[24:27]
    v_mfma_f32_16x16x32_bf16 v[28:31], v[136:139], v[176:179], v[28:31]
    v_mfma_f32_16x16x32_bf16 v[32:35], v[136:139], v[180:183], v[32:35]
    v_mfma_f32_16x16x32_bf16 v[20:23], v[140:143], v[164:167], v[20:23]
    v_mfma_f32_16x16x32_bf16 v[24:27], v[140:143], v[168:171], v[24:27]
    v_mfma_f32_16x16x32_bf16 v[28:31], v[140:143], v[172:175], v[28:31]
    v_mfma_f32_16x16x32_bf16 v[32:35], v[140:143], v[176:179], v[32:35]
    v_mfma_f32_16x16x32_bf16 v[20:23], v[144:147], v[160:163], v[20:23]
    v_mfma_f32_16x16x32_bf16 v[24:27], v[144:147], v[164:167], v[24:27]
    v_mfma_f32_16x16x32_bf16 v[28:31], v[144:147], v[168:171], v[28:31]
    v_mfma_f32_16x16x32_bf16 v[32:35], v[144:147], v[172:175], v[32:35]
    v_mfma_f32_16x16x32_bf16 v[24:27], v[148:151], v[160:163], v[24:27]
    v_mfma_f32_16x16x32_bf16 v[28:31], v[148:151], v[164:167], v[28:31]
    v_mfma_f32_16x16x32_bf16 v[32:35], v[148:151], v[168:171], v[32:35]
    v_mfma_f32_16x16x32_bf16 v[28:31], v[152:155], v[160:163], v[28:31]
    v_mfma_f32_16x16x32_bf16 v[32:35], v[152:155], v[164:167], v[32:35]
    v_mfma_f32_16x16x32_bf16 v[32:35], v[156:159], v[160:163], v[32:35]
    s_branch L_kc_bar4_35
L_kc_chelp_34:
    v_add_u32 v10, 0, v6
    v_add_u32 v11, 0, v7
    ds_read_b64 v[64:65], v10 offset:4032
    ds_read_b64 v[66:67], v10 offset:4040
    ds_read_b64 v[68:69], v10 offset:3520
    ds_read_b64 v[70:71], v10 offset:3528
    ds_read_b64 v[72:73], v10 offset:3008
    ds_read_b64 v[74:75], v10 offset:3016
    ds_read_b64 v[76:77], v10 offset:2496
    ds_read_b64 v[78:79], v10 offset:2504
    ds_read_b128 v[96:99], v11 offset:448
    ds_read_b128 v[100:103], v11 offset:960
    ds_read_b128 v[104:107], v11 offset:1472
    ds_read_b128 v[108:111], v11 offset:1984
    s_waitcnt lgkmcnt(0)
    ds_read_b64 v[128:129], v10 offset:3968
    ds_read_b64 v[130:131], v10 offset:3976
    ds_read_b64 v[132:133], v10 offset:3456
    ds_read_b64 v[134:135], v10 offset:3464
    ds_read_b64 v[136:137], v10 offset:2944
    ds_read_b64 v[138:139], v10 offset:2952
    ds_read_b64 v[140:141], v10 offset:2432
    ds_read_b64 v[142:143], v10 offset:2440
    ds_read_b128 v[160:163], v11 offset:384
    ds_read_b128 v[164:167], v11 offset:896
    ds_read_b128 v[168:171], v11 offset:1408
    ds_read_b128 v[172:175], v11 offset:1920
    v_mfma_f32_16x16x32_bf16 v[16:19], v[64:67], v[100:103], 0
    v_mfma_f32_16x16x32_bf16 v[20:23], v[64:67], v[104:107], 0
    v_mfma_f32_16x16x32_bf16 v[24:27], v[64:67], v[108:111], 0
    v_mfma_f32_16x16x32_bf16 v[16:19], v[68:71], v[96:99], v[16:19]
    v_mfma_f32_16x16x32_bf16 v[20:23], v[68:71], v[100:103], v[20:23]
    v_mfma_f32_16x16x32_bf16 v[24:27], v[68:71], v[104:107], v[24:27]
    v_mfma_f32_16x16x32_bf16 v[20:23], v[72:75], v[96:99], v[20:23]
    v_mfma_f32_16x16x32_bf16 v[24:27], v[72:75], v[100:103], v[24:27]
    v_mfma_f32_16x16x32_bf16 v[24:27], v[76:79], v[96:99], v[24:27]
    s_waitcnt lgkmcnt(0)
    ds_read_b64 v[64:65], v10 offset:3904
    ds_read_b64 v[66:67], v10 offset:3912
    ds_read_b64 v[68:69], v10 offset:3392
    ds_read_b64 v[70:71], v10 offset:3400
    ds_read_b64 v[72:73], v10 offset:2880
    ds_read_b64 v[74:75], v10 offset:2888
    ds_read_b64 v[76:77], v10 offset:2368
    ds_read_b64 v[78:79], v10 offset:2376
    ds_read_b128 v[96:99], v11 offset:320
    ds_read_b128 v[100:103], v11 offset:832
    ds_read_b128 v[104:107], v11 offset:1344
    ds_read_b128 v[108:111], v11 offset:1856
    v_mfma_f32_16x16x32_bf16 v[16:19], v[128:131], v[164:167], v[16:19]
    v_mfma_f32_16x16x32_bf16 v[20:23], v[128:131], v[168:171], v[20:23]
    v_mfma_f32_16x16x32_bf16 v[24:27], v[128:131], v[172:175], v[24:27]
    v_mfma_f32_16x16x32_bf16 v[16:19], v[132:135], v[160:163], v[16:19]
    v_mfma_f32_16x16x32_bf16 v[20:23], v[132:135], v[164:167], v[20:23]
    v_mfma_f32_16x16x32_bf16 v[24:27], v[132:135], v[168:171], v[24:27]
    v_mfma_f32_16x16x32_bf16 v[20:23], v[136:139], v[160:163], v[20:23]
    v_mfma_f32_16x16x32_bf16 v[24:27], v[136:139], v[164:167], v[24:27]
    v_mfma_f32_16x16x32_bf16 v[24:27], v[140:143], v[160:163], v[24:27]
    s_waitcnt lgkmcnt(0)
    ds_read_b64 v[128:129], v10 offset:3840
    ds_read_b64 v[130:131], v10 offset:3848
    ds_read_b64 v[132:133], v10 offset:3328
    ds_read_b64 v[134:135], v10 offset:3336
    ds_read_b64 v[136:137], v10 offset:2816
    ds_read_b64 v[138:139], v10 offset:2824
    ds_read_b64 v[140:141], v10 offset:2304
    ds_read_b64 v[142:143], v10 offset:2312
    ds_read_b128 v[160:163], v11 offset:256
    ds_read_b128 v[164:167], v11 offset:768
    ds_read_b128 v[168:171], v11 offset:1280
    ds_read_b128 v[172:175], v11 offset:1792
    v_mfma_f32_16x16x32_bf16 v[16:19], v[64:67], v[100:103], v[16:19]
    v_mfma_f32_16x16x32_bf16 v[20:23], v[64:67], v[104:107], v[20:23]
    v_mfma_f32_16x16x32_bf16 v[24:27], v[64:67], v[108:111], v[24:27]
    v_mfma_f32_16x16x32_bf16 v[16:19], v[68:71], v[96:99], v[16:19]
    v_mfma_f32_16x16x32_bf16 v[20:23], v[68:71], v[100:103], v[20:23]
    v_mfma_f32_16x16x32_bf16 v[24:27], v[68:71], v[104:107], v[24:27]
    v_mfma_f32_16x16x32_bf16 v[20:23], v[72:75], v[96:99], v[20:23]
    v_mfma_f32_16x16x32_bf16 v[24:27], v[72:75], v[100:103], v[24:27]
    v_mfma_f32_16x16x32_bf16 v[24:27], v[76:79], v[96:99], v[24:27]
    s_waitcnt lgkmcnt(0)
    ds_read_b64 v[64:65], v10 offset:3776
    ds_read_b64 v[66:67], v10 offset:3784
    ds_read_b64 v[68:69], v10 offset:3264
    ds_read_b64 v[70:71], v10 offset:3272
    ds_read_b64 v[72:73], v10 offset:2752
    ds_read_b64 v[74:75], v10 offset:2760
    ds_read_b64 v[76:77], v10 offset:2240
    ds_read_b64 v[78:79], v10 offset:2248
    ds_read_b128 v[96:99], v11 offset:192
    ds_read_b128 v[100:103], v11 offset:704
    ds_read_b128 v[104:107], v11 offset:1216
    ds_read_b128 v[108:111], v11 offset:1728
    v_mfma_f32_16x16x32_bf16 v[16:19], v[128:131], v[164:167], v[16:19]
    v_mfma_f32_16x16x32_bf16 v[20:23], v[128:131], v[168:171], v[20:23]
    v_mfma_f32_16x16x32_bf16 v[24:27], v[128:131], v[172:175], v[24:27]
    v_mfma_f32_16x16x32_bf16 v[16:19], v[132:135], v[160:163], v[16:19]
    v_mfma_f32_16x16x32_bf16 v[20:23], v[132:135], v[164:167], v[20:23]
    v_mfma_f32_16x16x32_bf16 v[24:27], v[132:135], v[168:171], v[24:27]
    v_mfma_f32_16x16x32_bf16 v[20:23], v[136:139], v[160:163], v[20:23]
    v_mfma_f32_16x16x32_bf16 v[24:27], v[136:139], v[164:167], v[24:27]
    v_mfma_f32_16x16x32_bf16 v[24:27], v[140:143], v[160:163], v[24:27]
    s_waitcnt lgkmcnt(0)
    ds_read_b64 v[128:129], v10 offset:3712
    ds_read_b64 v[130:131], v10 offset:3720
    ds_read_b64 v[132:133], v10 offset:3200
    ds_read_b64 v[134:135], v10 offset:3208
    ds_read_b64 v[136:137], v10 offset:2688
    ds_read_b64 v[138:139], v10 offset:2696
    ds_read_b64 v[140:141], v10 offset:2176
    ds_read_b64 v[142:143], v10 offset:2184
    ds_read_b128 v[160:163], v11 offset:128
    ds_read_b128 v[164:167], v11 offset:640
    ds_read_b128 v[168:171], v11 offset:1152
    ds_read_b128 v[172:175], v11 offset:1664
    v_mfma_f32_16x16x32_bf16 v[16:19], v[64:67], v[100:103], v[16:19]
    v_mfma_f32_16x16x32_bf16 v[20:23], v[64:67], v[104:107], v[20:23]
    v_mfma_f32_16x16x32_bf16 v[24:27], v[64:67], v[108:111], v[24:27]
    v_mfma_f32_16x16x32_bf16 v[16:19], v[68:71], v[96:99], v[16:19]
    v_mfma_f32_16x16x32_bf16 v[20:23], v[68:71], v[100:103], v[20:23]
    v_mfma_f32_16x16x32_bf16 v[24:27], v[68:71], v[104:107], v[24:27]
    v_mfma_f32_16x16x32_bf16 v[20:23], v[72:75], v[96:99], v[20:23]
    v_mfma_f32_16x16x32_bf16 v[24:27], v[72:75], v[100:103], v[24:27]
    v_mfma_f32_16x16x32_bf16 v[24:27], v[76:79], v[96:99], v[24:27]
    s_waitcnt lgkmcnt(0)
    ds_read_b64 v[64:65], v10 offset:3648
    ds_read_b64 v[66:67], v10 offset:3656
    ds_read_b64 v[68:69], v10 offset:3136
    ds_read_b64 v[70:71], v10 offset:3144
    ds_read_b64 v[72:73], v10 offset:2624
    ds_read_b64 v[74:75], v10 offset:2632
    ds_read_b64 v[76:77], v10 offset:2112
    ds_read_b64 v[78:79], v10 offset:2120
    ds_read_b128 v[96:99], v11 offset:64
    ds_read_b128 v[100:103], v11 offset:576
    ds_read_b128 v[104:107], v11 offset:1088
    ds_read_b128 v[108:111], v11 offset:1600
    v_mfma_f32_16x16x32_bf16 v[16:19], v[128:131], v[164:167], v[16:19]
    v_mfma_f32_16x16x32_bf16 v[20:23], v[128:131], v[168:171], v[20:23]
    v_mfma_f32_16x16x32_bf16 v[24:27], v[128:131], v[172:175], v[24:27]
    v_mfma_f32_16x16x32_bf16 v[16:19], v[132:135], v[160:163], v[16:19]
    v_mfma_f32_16x16x32_bf16 v[20:23], v[132:135], v[164:167], v[20:23]
    v_mfma_f32_16x16x32_bf16 v[24:27], v[132:135], v[168:171], v[24:27]
    v_mfma_f32_16x16x32_bf16 v[20:23], v[136:139], v[160:163], v[20:23]
    v_mfma_f32_16x16x32_bf16 v[24:27], v[136:139], v[164:167], v[24:27]
    v_mfma_f32_16x16x32_bf16 v[24:27], v[140:143], v[160:163], v[24:27]
    s_waitcnt lgkmcnt(0)
    ds_read_b64 v[128:129], v10 offset:3584
    ds_read_b64 v[130:131], v10 offset:3592
    ds_read_b64 v[132:133], v10 offset:3072
    ds_read_b64 v[134:135], v10 offset:3080
    ds_read_b64 v[136:137], v10 offset:2560
    ds_read_b64 v[138:139], v10 offset:2568
    ds_read_b64 v[140:141], v10 offset:2048
    ds_read_b64 v[142:143], v10 offset:2056
    ds_read_b128 v[160:163], v11 offset:0
    ds_read_b128 v[164:167], v11 offset:512
    ds_read_b128 v[168:171], v11 offset:1024
    ds_read_b128 v[172:175], v11 offset:1536
    v_mfma_f32_16x16x32_bf16 v[16:19], v[64:67], v[100:103], v[16:19]
    v_mfma_f32_16x16x32_bf16 v[20:23], v[64:67], v[104:107], v[20:23]
    v_mfma_f32_16x16x32_bf16 v[24:27], v[64:67], v[108:111], v[24:27]
    v_mfma_f32_16x16x32_bf16 v[16:19], v[68:71], v[96:99], v[16:19]
    v_mfma_f32_16x16x32_bf16 v[20:23], v[68:71], v[100:103], v[20:23]
    v_mfma_f32_16x16x32_bf16 v[24:27], v[68:71], v[104:107], v[24:27]
    v_mfma_f32_16x16x32_bf16 v[20:23], v[72:75], v[96:99], v[20:23]
    v_mfma_f32_16x16x32_bf16 v[24:27], v[72:75], v[100:103], v[24:27]
    v_mfma_f32_16x16x32_bf16 v[24:27], v[76:79], v[96:99], v[24:27]
    s_waitcnt lgkmcnt(0)
    v_mfma_f32_16x16x32_bf16 v[16:19], v[128:131], v[164:167], v[16:19]
    v_mfma_f32_16x16x32_bf16 v[20:23], v[128:131], v[168:171], v[20:23]
    v_mfma_f32_16x16x32_bf16 v[24:27], v[128:131], v[172:175], v[24:27]
    v_mfma_f32_16x16x32_bf16 v[16:19], v[132:135], v[160:163], v[16:19]
    v_mfma_f32_16x16x32_bf16 v[20:23], v[132:135], v[164:167], v[20:23]
    v_mfma_f32_16x16x32_bf16 v[24:27], v[132:135], v[168:171], v[24:27]
    v_mfma_f32_16x16x32_bf16 v[20:23], v[136:139], v[160:163], v[20:23]
    v_mfma_f32_16x16x32_bf16 v[24:27], v[136:139], v[164:167], v[24:27]
    v_mfma_f32_16x16x32_bf16 v[24:27], v[140:143], v[160:163], v[24:27]
    v_add_u32 v10, 21248, v6
    v_add_u32 v11, 21248, v7
    ds_read_b64 v[64:65], v10 offset:4032
    ds_read_b64 v[66:67], v10 offset:4040
    ds_read_b64 v[68:69], v10 offset:3520
    ds_read_b64 v[70:71], v10 offset:3528
    ds_read_b64 v[72:73], v10 offset:3008
    ds_read_b64 v[74:75], v10 offset:3016
    ds_read_b64 v[76:77], v10 offset:2496
    ds_read_b64 v[78:79], v10 offset:2504
    ds_read_b128 v[96:99], v11 offset:448
    ds_read_b128 v[100:103], v11 offset:960
    ds_read_b128 v[104:107], v11 offset:1472
    ds_read_b128 v[108:111], v11 offset:1984
    s_waitcnt lgkmcnt(0)
    ds_read_b64 v[128:129], v10 offset:3968
    ds_read_b64 v[130:131], v10 offset:3976
    ds_read_b64 v[132:133], v10 offset:3456
    ds_read_b64 v[134:135], v10 offset:3464
    ds_read_b64 v[136:137], v10 offset:2944
    ds_read_b64 v[138:139], v10 offset:2952
    ds_read_b64 v[140:141], v10 offset:2432
    ds_read_b64 v[142:143], v10 offset:2440
    ds_read_b128 v[160:163], v11 offset:384
    ds_read_b128 v[164:167], v11 offset:896
    ds_read_b128 v[168:171], v11 offset:1408
    ds_read_b128 v[172:175], v11 offset:1920
    v_mfma_f32_16x16x32_bf16 v[28:31], v[64:67], v[100:103], 0
    v_mfma_f32_16x16x32_bf16 v[32:35], v[64:67], v[104:107], 0
    v_mfma_f32_16x16x32_bf16 v[36:39], v[64:67], v[108:111], 0
    v_mfma_f32_16x16x32_bf16 v[28:31], v[68:71], v[96:99], v[28:31]
    v_mfma_f32_16x16x32_bf16 v[32:35], v[68:71], v[100:103], v[32:35]
    v_mfma_f32_16x16x32_bf16 v[36:39], v[68:71], v[104:107], v[36:39]
    v_mfma_f32_16x16x32_bf16 v[32:35], v[72:75], v[96:99], v[32:35]
    v_mfma_f32_16x16x32_bf16 v[36:39], v[72:75], v[100:103], v[36:39]
    v_mfma_f32_16x16x32_bf16 v[36:39], v[76:79], v[96:99], v[36:39]
    s_waitcnt lgkmcnt(0)
    ds_read_b64 v[64:65], v10 offset:3904
    ds_read_b64 v[66:67], v10 offset:3912
    ds_read_b64 v[68:69], v10 offset:3392
    ds_read_b64 v[70:71], v10 offset:3400
    ds_read_b64 v[72:73], v10 offset:2880
    ds_read_b64 v[74:75], v10 offset:2888
    ds_read_b64 v[76:77], v10 offset:2368
    ds_read_b64 v[78:79], v10 offset:2376
    ds_read_b128 v[96:99], v11 offset:320
    ds_read_b128 v[100:103], v11 offset:832
    ds_read_b128 v[104:107], v11 offset:1344
    ds_read_b128 v[108:111], v11 offset:1856
    v_mfma_f32_16x16x32_bf16 v[28:31], v[128:131], v[164:167], v[28:31]
    v_mfma_f32_16x16x32_bf16 v[32:35], v[128:131], v[168:171], v[32:35]
    v_mfma_f32_16x16x32_bf16 v[36:39], v[128:131], v[172:175], v[36:39]
    v_mfma_f32_16x16x32_bf16 v[28:31], v[132:135], v[160:163], v[28:31]
    v_mfma_f32_16x16x32_bf16 v[32:35], v[132:135], v[164:167], v[32:35]
    v_mfma_f32_16x16x32_bf16 v[36:39], v[132:135], v[168:171], v[36:39]
    v_mfma_f32_16x16x32_bf16 v[32:35], v[136:139], v[160:163], v[32:35]
    v_mfma_f32_16x16x32_bf16 v[36:39], v[136:139], v[164:167], v[36:39]
    v_mfma_f32_16x16x32_bf16 v[36:39], v[140:143], v[160:163], v[36:39]
    s_waitcnt lgkmcnt(0)
    ds_read_b64 v[128:129], v10 offset:3840
    ds_read_b64 v[130:131], v10 offset:3848
    ds_read_b64 v[132:133], v10 offset:3328
    ds_read_b64 v[134:135], v10 offset:3336
    ds_read_b64 v[136:137], v10 offset:2816
    ds_read_b64 v[138:139], v10 offset:2824
    ds_read_b64 v[140:141], v10 offset:2304
    ds_read_b64 v[142:143], v10 offset:2312
    ds_read_b128 v[160:163], v11 offset:256
    ds_read_b128 v[164:167], v11 offset:768
    ds_read_b128 v[168:171], v11 offset:1280
    ds_read_b128 v[172:175], v11 offset:1792
    v_mfma_f32_16x16x32_bf16 v[28:31], v[64:67], v[100:103], v[28:31]
    v_mfma_f32_16x16x32_bf16 v[32:35], v[64:67], v[104:107], v[32:35]
    v_mfma_f32_16x16x32_bf16 v[36:39], v[64:67], v[108:111], v[36:39]
    v_mfma_f32_16x16x32_bf16 v[28:31], v[68:71], v[96:99], v[28:31]
    v_mfma_f32_16x16x32_bf16 v[32:35], v[68:71], v[100:103], v[32:35]
    v_mfma_f32_16x16x32_bf16 v[36:39], v[68:71], v[104:107], v[36:39]
    v_mfma_f32_16x16x32_bf16 v[32:35], v[72:75], v[96:99], v[32:35]
    v_mfma_f32_16x16x32_bf16 v[36:39], v[72:75], v[100:103], v[36:39]
    v_mfma_f32_16x16x32_bf16 v[36:39], v[76:79], v[96:99], v[36:39]
    s_waitcnt lgkmcnt(0)
    ds_read_b64 v[64:65], v10 offset:3776
    ds_read_b64 v[66:67], v10 offset:3784
    ds_read_b64 v[68:69], v10 offset:3264
    ds_read_b64 v[70:71], v10 offset:3272
    ds_read_b64 v[72:73], v10 offset:2752
    ds_read_b64 v[74:75], v10 offset:2760
    ds_read_b64 v[76:77], v10 offset:2240
    ds_read_b64 v[78:79], v10 offset:2248
    ds_read_b128 v[96:99], v11 offset:192
    ds_read_b128 v[100:103], v11 offset:704
    ds_read_b128 v[104:107], v11 offset:1216
    ds_read_b128 v[108:111], v11 offset:1728
    v_mfma_f32_16x16x32_bf16 v[28:31], v[128:131], v[164:167], v[28:31]
    v_mfma_f32_16x16x32_bf16 v[32:35], v[128:131], v[168:171], v[32:35]
    v_mfma_f32_16x16x32_bf16 v[36:39], v[128:131], v[172:175], v[36:39]
    v_mfma_f32_16x16x32_bf16 v[28:31], v[132:135], v[160:163], v[28:31]
    v_mfma_f32_16x16x32_bf16 v[32:35], v[132:135], v[164:167], v[32:35]
    v_mfma_f32_16x16x32_bf16 v[36:39], v[132:135], v[168:171], v[36:39]
    v_mfma_f32_16x16x32_bf16 v[32:35], v[136:139], v[160:163], v[32:35]
    v_mfma_f32_16x16x32_bf16 v[36:39], v[136:139], v[164:167], v[36:39]
    v_mfma_f32_16x16x32_bf16 v[36:39], v[140:143], v[160:163], v[36:39]
    s_waitcnt lgkmcnt(0)
    ds_read_b64 v[128:129], v10 offset:3712
    ds_read_b64 v[130:131], v10 offset:3720
    ds_read_b64 v[132:133], v10 offset:3200
    ds_read_b64 v[134:135], v10 offset:3208
    ds_read_b64 v[136:137], v10 offset:2688
    ds_read_b64 v[138:139], v10 offset:2696
    ds_read_b64 v[140:141], v10 offset:2176
    ds_read_b64 v[142:143], v10 offset:2184
    ds_read_b128 v[160:163], v11 offset:128
    ds_read_b128 v[164:167], v11 offset:640
    ds_read_b128 v[168:171], v11 offset:1152
    ds_read_b128 v[172:175], v11 offset:1664
    v_mfma_f32_16x16x32_bf16 v[28:31], v[64:67], v[100:103], v[28:31]
    v_mfma_f32_16x16x32_bf16 v[32:35], v[64:67], v[104:107], v[32:35]
    v_mfma_f32_16x16x32_bf16 v[36:39], v[64:67], v[108:111], v[36:39]
    v_mfma_f32_16x16x32_bf16 v[28:31], v[68:71], v[96:99], v[28:31]
    v_mfma_f32_16x16x32_bf16 v[32:35], v[68:71], v[100:103], v[32:35]
    v_mfma_f32_16x16x32_bf16 v[36:39], v[68:71], v[104:107], v[36:39]
    v_mfma_f32_16x16x32_bf16 v[32:35], v[72:75], v[96:99], v[32:35]
    v_mfma_f32_16x16x32_bf16 v[36:39], v[72:75], v[100:103], v[36:39]
    v_mfma_f32_16x16x32_bf16 v[36:39], v[76:79], v[96:99], v[36:39]
    s_waitcnt lgkmcnt(0)
    ds_read_b64 v[64:65], v10 offset:3648
    ds_read_b64 v[66:67], v10 offset:3656
    ds_read_b64 v[68:69], v10 offset:3136
    ds_read_b64 v[70:71], v10 offset:3144
    ds_read_b64 v[72:73], v10 offset:2624
    ds_read_b64 v[74:75], v10 offset:2632
    ds_read_b64 v[76:77], v10 offset:2112
    ds_read_b64 v[78:79], v10 offset:2120
    ds_read_b128 v[96:99], v11 offset:64
    ds_read_b128 v[100:103], v11 offset:576
    ds_read_b128 v[104:107], v11 offset:1088
    ds_read_b128 v[108:111], v11 offset:1600
    v_mfma_f32_16x16x32_bf16 v[28:31], v[128:131], v[164:167], v[28:31]
    v_mfma_f32_16x16x32_bf16 v[32:35], v[128:131], v[168:171], v[32:35]
    v_mfma_f32_16x16x32_bf16 v[36:39], v[128:131], v[172:175], v[36:39]
    v_mfma_f32_16x16x32_bf16 v[28:31], v[132:135], v[160:163], v[28:31]
    v_mfma_f32_16x16x32_bf16 v[32:35], v[132:135], v[164:167], v[32:35]
    v_mfma_f32_16x16x32_bf16 v[36:39], v[132:135], v[168:171], v[36:39]
    v_mfma_f32_16x16x32_bf16 v[32:35], v[136:139], v[160:163], v[32:35]
    v_mfma_f32_16x16x32_bf16 v[36:39], v[136:139], v[164:167], v[36:39]
    v_mfma_f32_16x16x32_bf16 v[36:39], v[140:143], v[160:163], v[36:39]
    s_waitcnt lgkmcnt(0)
    ds_read_b64 v[128:129], v10 offset:3584
    ds_read_b64 v[130:131], v10 offset:3592
    ds_read_b64 v[132:133], v10 offset:3072
    ds_read_b64 v[134:135], v10 offset:3080
    ds_read_b64 v[136:137], v10 offset:2560
    ds_read_b64 v[138:139], v10 offset:2568
    ds_read_b64 v[140:141], v10 offset:2048
    ds_read_b64 v[142:143], v10 offset:2056
    ds_read_b128 v[160:163], v11 offset:0
    ds_read_b128 v[164:167], v11 offset:512
    ds_read_b128 v[168:171], v11 offset:1024
    ds_read_b128 v[172:175], v11 offset:1536
    v_mfma_f32_16x16x32_bf16 v[28:31], v[64:67], v[100:103], v[28:31]
    v_mfma_f32_16x16x32_bf16 v[32:35], v[64:67], v[104:107], v[32:35]
    v_mfma_f32_16x16x32_bf16 v[36:39], v[64:67], v[108:111], v[36:39]
    v_mfma_f32_16x16x32_bf16 v[28:31], v[68:71], v[96:99], v[28:31]
    v_mfma_f32_16x16x32_bf16 v[32:35], v[68:71], v[100:103], v[32:35]
    v_mfma_f32_16x16x32_bf16 v[36:39], v[68:71], v[104:107], v[36:39]
    v_mfma_f32_16x16x32_bf16 v[32:35], v[72:75], v[96:99], v[32:35]
    v_mfma_f32_16x16x32_bf16 v[36:39], v[72:75], v[100:103], v[36:39]
    v_mfma_f32_16x16x32_bf16 v[36:39], v[76:79], v[96:99], v[36:39]
    s_waitcnt lgkmcnt(0)
    v_mfma_f32_16x16x32_bf16 v[28:31], v[128:131], v[164:167], v[28:31]
    v_mfma_f32_16x16x32_bf16 v[32:35], v[128:131], v[168:171], v[32:35]
    v_mfma_f32_16x16x32_bf16 v[36:39], v[128:131], v[172:175], v[36:39]
    v_mfma_f32_16x16x32_bf16 v[28:31], v[132:135], v[160:163], v[28:31]
    v_mfma_f32_16x16x32_bf16 v[32:35], v[132:135], v[164:167], v[32:35]
    v_mfma_f32_16x16x32_bf16 v[36:39], v[132:135], v[168:171], v[36:39]
    v_mfma_f32_16x16x32_bf16 v[32:35], v[136:139], v[160:163], v[32:35]
    v_mfma_f32_16x16x32_bf16 v[36:39], v[136:139], v[164:167], v[36:39]
    v_mfma_f32_16x16x32_bf16 v[36:39], v[140:143], v[160:163], v[36:39]
    s_cmp_lt_u32 s38, 3
    s_cbranch_scc1 L_kc_bar4_35
    v_add_u32 v10, 42496, v6
    v_add_u32 v11, 42496, v7
    ds_read_b64 v[64:65], v10 offset:4032
    ds_read_b64 v[66:67], v10 offset:4040
    ds_read_b64 v[68:69], v10 offset:3520
    ds_read_b64 v[70:71], v10 offset:3528
    ds_read_b64 v[72:73], v10 offset:3008
    ds_read_b64 v[74:75], v10 offset:3016
    ds_read_b64 v[76:77], v10 offset:2496
    ds_read_b64 v[78:79], v10 offset:2504
    ds_read_b128 v[96:99], v11 offset:448
    ds_read_b128 v[100:103], v11 offset:960
    ds_read_b128 v[104:107], v11 offset:1472
    ds_read_b128 v[108:111], v11 offset:1984
    s_waitcnt lgkmcnt(0)
    ds_read_b64 v[128:129], v10 offset:3968
    ds_read_b64 v[130:131], v10 offset:3976
    ds_read_b64 v[132:133], v10 offset:3456
    ds_read_b64 v[134:135], v10 offset:3464
    ds_read_b64 v[136:137], v10 offset:2944
    ds_read_b64 v[138:139], v10 offset:2952
    ds_read_b64 v[140:141], v10 offset:2432
    ds_read_b64 v[142:143], v10 offset:2440
    ds_read_b128 v[160:163], v11 offset:384
    ds_read_b128 v[164:167], v11 offset:896
    ds_read_b128 v[168:171], v11 offset:1408
    ds_read_b128 v[172:175], v11 offset:1920
    v_mfma_f32_16x16x32_bf16 v[40:43], v[64:67], v[100:103], 0
    v_mfma_f32_16x16x32_bf16 v[44:47], v[64:67], v[104:107], 0
    v_mfma_f32_16x16x32_bf16 v[48:51], v[64:67], v[108:111], 0
    v_mfma_f32_16x16x32_bf16 v[40:43], v[68:71], v[96:99], v[40:43]
    v_mfma_f32_16x16x32_bf16 v[44:47], v[68:71], v[100:103], v[44:47]
    v_mfma_f32_16x16x32_bf16 v[48:51], v[68:71], v[104:107], v[48:51]
    v_mfma_f32_16x16x32_bf16 v[44:47], v[72:75], v[96:99], v[44:47]
    v_mfma_f32_16x16x32_bf16 v[48:51], v[72:75], v[100:103], v[48:51]
    v_mfma_f32_16x16x32_bf16 v[48:51], v[76:79], v[96:99], v[48:51]
    s_waitcnt lgkmcnt(0)
    ds_read_b64 v[64:65], v10 offset:3904
    ds_read_b64 v[66:67], v10 offset:3912
    ds_read_b64 v[68:69], v10 offset:3392
    ds_read_b64 v[70:71], v10 offset:3400
    ds_read_b64 v[72:73], v10 offset:2880
    ds_read_b64 v[74:75], v10 offset:2888
    ds_read_b64 v[76:77], v10 offset:2368
    ds_read_b64 v[78:79], v10 offset:2376
    ds_read_b128 v[96:99], v11 offset:320
    ds_read_b128 v[100:103], v11 offset:832
    ds_read_b128 v[104:107], v11 offset:1344
    ds_read_b128 v[108:111], v11 offset:1856
    v_mfma_f32_16x16x32_bf16 v[40:43], v[128:131], v[164:167], v[40:43]
    v_mfma_f32_16x16x32_bf16 v[44:47], v[128:131], v[168:171], v[44:47]
    v_mfma_f32_16x16x32_bf16 v[48:51], v[128:131], v[172:175], v[48:51]
    v_mfma_f32_16x16x32_bf16 v[40:43], v[132:135], v[160:163], v[40:43]
    v_mfma_f32_16x16x32_bf16 v[44:47], v[132:135], v[164:167], v[44:47]
    v_mfma_f32_16x16x32_bf16 v[48:51], v[132:135], v[168:171], v[48:51]
    v_mfma_f32_16x16x32_bf16 v[44:47], v[136:139], v[160:163], v[44:47]
    v_mfma_f32_16x16x32_bf16 v[48:51], v[136:139], v[164:167], v[48:51]
    v_mfma_f32_16x16x32_bf16 v[48:51], v[140:143], v[160:163], v[48:51]
    s_waitcnt lgkmcnt(0)
    ds_read_b64 v[128:129], v10 offset:3840
    ds_read_b64 v[130:131], v10 offset:3848
    ds_read_b64 v[132:133], v10 offset:3328
    ds_read_b64 v[134:135], v10 offset:3336
    ds_read_b64 v[136:137], v10 offset:2816
    ds_read_b64 v[138:139], v10 offset:2824
    ds_read_b64 v[140:141], v10 offset:2304
    ds_read_b64 v[142:143], v10 offset:2312
    ds_read_b128 v[160:163], v11 offset:256
    ds_read_b128 v[164:167], v11 offset:768
    ds_read_b128 v[168:171], v11 offset:1280
    ds_read_b128 v[172:175], v11 offset:1792
    v_mfma_f32_16x16x32_bf16 v[40:43], v[64:67], v[100:103], v[40:43]
    v_mfma_f32_16x16x32_bf16 v[44:47], v[64:67], v[104:107], v[44:47]
    v_mfma_f32_16x16x32_bf16 v[48:51], v[64:67], v[108:111], v[48:51]
    v_mfma_f32_16x16x32_bf16 v[40:43], v[68:71], v[96:99], v[40:43]
    v_mfma_f32_16x16x32_bf16 v[44:47], v[68:71], v[100:103], v[44:47]
    v_mfma_f32_16x16x32_bf16 v[48:51], v[68:71], v[104:107], v[48:51]
    v_mfma_f32_16x16x32_bf16 v[44:47], v[72:75], v[96:99], v[44:47]
    v_mfma_f32_16x16x32_bf16 v[48:51], v[72:75], v[100:103], v[48:51]
    v_mfma_f32_16x16x32_bf16 v[48:51], v[76:79], v[96:99], v[48:51]
    s_waitcnt lgkmcnt(0)
    ds_read_b64 v[64:65], v10 offset:3776
    ds_read_b64 v[66:67], v10 offset:3784
    ds_read_b64 v[68:69], v10 offset:3264
    ds_read_b64 v[70:71], v10 offset:3272
    ds_read_b64 v[72:73], v10 offset:2752
    ds_read_b64 v[74:75], v10 offset:2760
    ds_read_b64 v[76:77], v10 offset:2240
    ds_read_b64 v[78:79], v10 offset:2248
    ds_read_b128 v[96:99], v11 offset:192
    ds_read_b128 v[100:103], v11 offset:704
    ds_read_b128 v[104:107], v11 offset:1216
    ds_read_b128 v[108:111], v11 offset:1728
    v_mfma_f32_16x16x32_bf16 v[40:43], v[128:131], v[164:167], v[40:43]
    v_mfma_f32_16x16x32_bf16 v[44:47], v[128:131], v[168:171], v[44:47]
    v_mfma_f32_16x16x32_bf16 v[48:51], v[128:131], v[172:175], v[48:51]
    v_mfma_f32_16x16x32_bf16 v[40:43], v[132:135], v[160:163], v[40:43]
    v_mfma_f32_16x16x32_bf16 v[44:47], v[132:135], v[164:167], v[44:47]
    v_mfma_f32_16x16x32_bf16 v[48:51], v[132:135], v[168:171], v[48:51]
    v_mfma_f32_16x16x32_bf16 v[44:47], v[136:139], v[160:163], v[44:47]
    v_mfma_f32_16x16x32_bf16 v[48:51], v[136:139], v[164:167], v[48:51]
    v_mfma_f32_16x16x32_bf16 v[48:51], v[140:143], v[160:163], v[48:51]
    s_waitcnt lgkmcnt(0)
    ds_read_b64 v[128:129], v10 offset:3712
    ds_read_b64 v[130:131], v10 offset:3720
    ds_read_b64 v[132:133], v10 offset:3200
    ds_read_b64 v[134:135], v10 offset:3208
    ds_read_b64 v[136:137], v10 offset:2688
    ds_read_b64 v[138:139], v10 offset:2696
    ds_read_b64 v[140:141], v10 offset:2176
    ds_read_b64 v[142:143], v10 offset:2184
    ds_read_b128 v[160:163], v11 offset:128
    ds_read_b128 v[164:167], v11 offset:640
    ds_read_b128 v[168:171], v11 offset:1152
    ds_read_b128 v[172:175], v11 offset:1664
    v_mfma_f32_16x16x32_bf16 v[40:43], v[64:67], v[100:103], v[40:43]
    v_mfma_f32_16x16x32_bf16 v[44:47], v[64:67], v[104:107], v[44:47]
    v_mfma_f32_16x16x32_bf16 v[48:51], v[64:67], v[108:111], v[48:51]
    v_mfma_f32_16x16x32_bf16 v[40:43], v[68:71], v[96:99], v[40:43]
    v_mfma_f32_16x16x32_bf16 v[44:47], v[68:71], v[100:103], v[44:47]
    v_mfma_f32_16x16x32_bf16 v[48:51], v[68:71], v[104:107], v[48:51]
    v_mfma_f32_16x16x32_bf16 v[44:47], v[72:75], v[96:99], v[44:47]
    v_mfma_f32_16x16x32_bf16 v[48:51], v[72:75], v[100:103], v[48:51]
    v_mfma_f32_16x16x32_bf16 v[48:51], v[76:79], v[96:99], v[48:51]
    s_waitcnt lgkmcnt(0)
    ds_read_b64 v[64:65], v10 offset:3648
    ds_read_b64 v[66:67], v10 offset:3656
    ds_read_b64 v[68:69], v10 offset:3136
    ds_read_b64 v[70:71], v10 offset:3144
    ds_read_b64 v[72:73], v10 offset:2624
    ds_read_b64 v[74:75], v10 offset:2632
    ds_read_b64 v[76:77], v10 offset:2112
    ds_read_b64 v[78:79], v10 offset:2120
    ds_read_b128 v[96:99], v11 offset:64
    ds_read_b128 v[100:103], v11 offset:576
    ds_read_b128 v[104:107], v11 offset:1088
    ds_read_b128 v[108:111], v11 offset:1600
    v_mfma_f32_16x16x32_bf16 v[40:43], v[128:131], v[164:167], v[40:43]
    v_mfma_f32_16x16x32_bf16 v[44:47], v[128:131], v[168:171], v[44:47]
    v_mfma_f32_16x16x32_bf16 v[48:51], v[128:131], v[172:175], v[48:51]
    v_mfma_f32_16x16x32_bf16 v[40:43], v[132:135], v[160:163], v[40:43]
    v_mfma_f32_16x16x32_bf16 v[44:47], v[132:135], v[164:167], v[44:47]
    v_mfma_f32_16x16x32_bf16 v[48:51], v[132:135], v[168:171], v[48:51]
    v_mfma_f32_16x16x32_bf16 v[44:47], v[136:139], v[160:163], v[44:47]
    v_mfma_f32_16x16x32_bf16 v[48:51], v[136:139], v[164:167], v[48:51]
    v_mfma_f32_16x16x32_bf16 v[48:51], v[140:143], v[160:163], v[48:51]
    s_waitcnt lgkmcnt(0)
    ds_read_b64 v[128:129], v10 offset:3584
    ds_read_b64 v[130:131], v10 offset:3592
    ds_read_b64 v[132:133], v10 offset:3072
    ds_read_b64 v[134:135], v10 offset:3080
    ds_read_b64 v[136:137], v10 offset:2560
    ds_read_b64 v[138:139], v10 offset:2568
    ds_read_b64 v[140:141], v10 offset:2048
    ds_read_b64 v[142:143], v10 offset:2056
    ds_read_b128 v[160:163], v11 offset:0
    ds_read_b128 v[164:167], v11 offset:512
    ds_read_b128 v[168:171], v11 offset:1024
    ds_read_b128 v[172:175], v11 offset:1536
    v_mfma_f32_16x16x32_bf16 v[40:43], v[64:67], v[100:103], v[40:43]
    v_mfma_f32_16x16x32_bf16 v[44:47], v[64:67], v[104:107], v[44:47]
    v_mfma_f32_16x16x32_bf16 v[48:51], v[64:67], v[108:111], v[48:51]
    v_mfma_f32_16x16x32_bf16 v[40:43], v[68:71], v[96:99], v[40:43]
    v_mfma_f32_16x16x32_bf16 v[44:47], v[68:71], v[100:103], v[44:47]
    v_mfma_f32_16x16x32_bf16 v[48:51], v[68:71], v[104:107], v[48:51]
    v_mfma_f32_16x16x32_bf16 v[44:47], v[72:75], v[96:99], v[44:47]
    v_mfma_f32_16x16x32_bf16 v[48:51], v[72:75], v[100:103], v[48:51]
    v_mfma_f32_16x16x32_bf16 v[48:51], v[76:79], v[96:99], v[48:51]
    s_waitcnt lgkmcnt(0)
    v_mfma_f32_16x16x32_bf16 v[40:43], v[128:131], v[164:167], v[40:43]
    v_mfma_f32_16x16x32_bf16 v[44:47], v[128:131], v[168:171], v[44:47]
    v_mfma_f32_16x16x32_bf16 v[48:51], v[128:131], v[172:175], v[48:51]
    v_mfma_f32_16x16x32_bf16 v[40:43], v[132:135], v[160:163], v[40:43]
    v_mfma_f32_16x16x32_bf16 v[44:47], v[132:135], v[164:167], v[44:47]
    v_mfma_f32_16x16x32_bf16 v[48:51], v[132:135], v[168:171], v[48:51]
    v_mfma_f32_16x16x32_bf16 v[44:47], v[136:139], v[160:163], v[44:47]
    v_mfma_f32_16x16x32_bf16 v[48:51], v[136:139], v[164:167], v[48:51]
    v_mfma_f32_16x16x32_bf16 v[48:51], v[140:143], v[160:163], v[48:51]
L_kc_bar4_35:
    s_barrier
    s_cmp_eq_u32 s4, 3
    s_cbranch_scc1 L_kc_ehelp_36
    s_cmp_ge_u32 s4, s38
    s_cbranch_scc1 L_kc_bar5_37
    v_add_u32 v12, s33, v8
    s_cmp_eq_u32 s4, 1
    s_cselect_b32 s47, s45, s44
    s_cmp_eq_u32 s4, 2
    s_cselect_b32 s47, s46, s47
    ds_read_b64 v[64:65], v12 offset:0
    ds_read_b64 v[66:67], v12 offset:2048
    ds_read_b64 v[68:69], v12 offset:2560
    ds_read_b64 v[70:71], v12 offset:3072
    ds_read_b64 v[72:73], v12 offset:3584
    s_waitcnt lgkmcnt(4)
    v_lshlrev_b32 v96, 16, v64
    v_and_b32 v97, 0xffff0000, v64
    v_lshlrev_b32 v98, 16, v65
    v_and_b32 v99, 0xffff0000, v65
    v_fma_f32 v96, v96, s47, v16
    v_fma_f32 v97, v97, s47, v17
    v_fma_f32 v98, v98, s47, v18
    v_fma_f32 v99, v99, s47, v19
    v_cvt_pk_bf16_f32 v112, v96, v97
    v_cvt_pk_bf16_f32 v113, v98, v99
    ds_write_b64 v12, v[112:113] offset:0
    s_waitcnt lgkmcnt(4)
    v_lshlrev_b32 v100, 16, v66
    v_and_b32 v101, 0xffff0000, v66
    v_lshlrev_b32 v102, 16, v67
    v_and_b32 v103, 0xffff0000, v67
    v_fma_f32 v100, v100, s47, v20
    v_fma_f32 v101, v101, s47, v21
    v_fma_f32 v102, v102, s47, v22
    v_fma_f32 v103, v103, s47, v23
    v_cvt_pk_bf16_f32 v114, v100, v101
    v_cvt_pk_bf16_f32 v115, v102, v103
    ds_write_b64 v12, v[114:115] offset:2048
    s_waitcnt lgkmcnt(4)
    v_lshlrev_b32 v96, 16, v68
    v_and_b32 v97, 0xffff0000, v68
    v_lshlrev_b32 v98, 16, v69
    v_and_b32 v99, 0xffff0000, v69
    v_fma_f32 v96, v96, s47, v24
    v_fma_f32 v97, v97, s47, v25
    v_fma_f32 v98, v98, s47, v26
    v_fma_f32 v99, v99, s47, v27
    v_cvt_pk_bf16_f32 v116, v96, v97
    v_cvt_pk_bf16_f32 v117, v98, v99
    ds_write_b64 v12, v[116:117] offset:2560
    s_waitcnt lgkmcnt(4)
    v_lshlrev_b32 v100, 16, v70
    v_and_b32 v101, 0xffff0000, v70
    v_lshlrev_b32 v102, 16, v71
    v_and_b32 v103, 0xffff0000, v71
    v_fma_f32 v100, v100, s47, v28
    v_fma_f32 v101, v101, s47, v29
    v_fma_f32 v102, v102, s47, v30
    v_fma_f32 v103, v103, s47, v31
    v_cvt_pk_bf16_f32 v118, v100, v101
    v_cvt_pk_bf16_f32 v119, v102, v103
    ds_write_b64 v12, v[118:119] offset:3072
    s_waitcnt lgkmcnt(4)
    v_lshlrev_b32 v96, 16, v72
    v_and_b32 v97, 0xffff0000, v72
    v_lshlrev_b32 v98, 16, v73
    v_and_b32 v99, 0xffff0000, v73
    v_fma_f32 v96, v96, s47, v32
    v_fma_f32 v97, v97, s47, v33
    v_fma_f32 v98, v98, s47, v34
    v_fma_f32 v99, v99, s47, v35
    v_cvt_pk_bf16_f32 v120, v96, v97
    v_cvt_pk_bf16_f32 v121, v98, v99
    ds_write_b64 v12, v[120:121] offset:3584
    s_branch L_kc_bar5_37
L_kc_ehelp_36:
    v_add_u32 v12, 0, v8
    ds_read_b64 v[64:65], v12 offset:512
    ds_read_b64 v[66:67], v12 offset:1024
    ds_read_b64 v[68:69], v12 offset:1536
    s_waitcnt lgkmcnt(2)
    v_lshlrev_b32 v96, 16, v64
    v_and_b32 v97, 0xffff0000, v64
    v_lshlrev_b32 v98, 16, v65
    v_and_b32 v99, 0xffff0000, v65
    v_fma_f32 v96, v96, s44, v16
    v_fma_f32 v97, v97, s44, v17
    v_fma_f32 v98, v98, s44, v18
    v_fma_f32 v99, v99, s44, v19
    v_cvt_pk_bf16_f32 v112, v96, v97
    v_cvt_pk_bf16_f32 v113, v98, v99
    ds_write_b64 v12, v[112:113] offset:512
    s_waitcnt lgkmcnt(2)
    v_lshlrev_b32 v100, 16, v66
    v_and_b32 v101, 0xffff0000, v66
    v_lshlrev_b32 v102, 16, v67
    v_and_b32 v103, 0xffff0000, v67
    v_fma_f32 v100, v100, s44, v20
    v_fma_f32 v101, v101, s44, v21
    v_fma_f32 v102, v102, s44, v22
    v_fma_f32 v103, v103, s44, v23
    v_cvt_pk_bf16_f32 v114, v100, v101
    v_cvt_pk_bf16_f32 v115, v102, v103
    ds_write_b64 v12, v[114:115] offset:1024
    s_waitcnt lgkmcnt(2)
    v_lshlrev_b32 v96, 16, v68
    v_and_b32 v97, 0xffff0000, v68
    v_lshlrev_b32 v98, 16, v69
    v_and_b32 v99, 0xffff0000, v69
    v_fma_f32 v96, v96, s44, v24
    v_fma_f32 v97, v97, s44, v25
    v_fma_f32 v98, v98, s44, v26
    v_fma_f32 v99, v99, s44, v27
    v_cvt_pk_bf16_f32 v116, v96, v97
    v_cvt_pk_bf16_f32 v117, v98, v99
    ds_write_b64 v12, v[116:117] offset:1536
    s_waitcnt lgkmcnt(0)
    v_add_u32 v12, 21248, v8
    ds_read_b64 v[64:65], v12 offset:512
    ds_read_b64 v[66:67], v12 offset:1024
    ds_read_b64 v[68:69], v12 offset:1536
    s_waitcnt lgkmcnt(2)
    v_lshlrev_b32 v96, 16, v64
    v_and_b32 v97, 0xffff0000, v64
    v_lshlrev_b32 v98, 16, v65
    v_and_b32 v99, 0xffff0000, v65
    v_fma_f32 v96, v96, s45, v28
    v_fma_f32 v97, v97, s45, v29
    v_fma_f32 v98, v98, s45, v30
    v_fma_f32 v99, v99, s45, v31
    v_cvt_pk_bf16_f32 v112, v96, v97
    v_cvt_pk_bf16_f32 v113, v98, v99
    ds_write_b64 v12, v[112:113] offset:512
    s_waitcnt lgkmcnt(2)
    v_lshlrev_b32 v100, 16, v66
    v_and_b32 v101, 0xffff0000, v66
    v_lshlrev_b32 v102, 16, v67
    v_and_b32 v103, 0xffff0000, v67
    v_fma_f32 v100, v100, s45, v32
    v_fma_f32 v101, v101, s45, v33
    v_fma_f32 v102, v102, s45, v34
    v_fma_f32 v103, v103, s45, v35
    v_cvt_pk_bf16_f32 v114, v100, v101
    v_cvt_pk_bf16_f32 v115, v102, v103
    ds_write_b64 v12, v[114:115] offset:1024
    s_waitcnt lgkmcnt(2)
    v_lshlrev_b32 v96, 16, v68
    v_and_b32 v97, 0xffff0000, v68
    v_lshlrev_b32 v98, 16, v69
    v_and_b32 v99, 0xffff0000, v69
    v_fma_f32 v96, v96, s45, v36
    v_fma_f32 v97, v97, s45, v37
    v_fma_f32 v98, v98, s45, v38
    v_fma_f32 v99, v99, s45, v39
    v_cvt_pk_bf16_f32 v116, v96, v97
    v_cvt_pk_bf16_f32 v117, v98, v99
    ds_write_b64 v12, v[116:117] offset:1536
    s_waitcnt lgkmcnt(0)
    s_cmp_lt_u32 s38, 3
    s_cbranch_scc1 L_kc_bar5_37
    v_add_u32 v12, 42496, v8
    ds_read_b64 v[64:65], v12 offset:512
    ds_read_b64 v[66:67], v12 offset:1024
    ds_read_b64 v[68:69], v12 offset:1536
    s_waitcnt lgkmcnt(2)
    v_lshlrev_b32 v96, 16, v64
    v_and_b32 v97, 0xffff0000, v64
    v_lshlrev_b32 v98, 16, v65
    v_and_b32 v99, 0xffff0000, v65
    v_fma_f32 v96, v96, s46, v40
    v_fma_f32 v97, v97, s46, v41
    v_fma_f32 v98, v98, s46, v42
    v_fma_f32 v99, v99, s46, v43
    v_cvt_pk_bf16_f32 v112, v96, v97
    v_cvt_pk_bf16_f32 v113, v98, v99
    ds_write_b64 v12, v[112:113] offset:512
    s_waitcnt lgkmcnt(2)
    v_lshlrev_b32 v100, 16, v66
    v_and_b32 v101, 0xffff0000, v66
    v_lshlrev_b32 v102, 16, v67
    v_and_b32 v103, 0xffff0000, v67
    v_fma_f32 v100, v100, s46, v44
    v_fma_f32 v101, v101, s46, v45
    v_fma_f32 v102, v102, s46, v46
    v_fma_f32 v103, v103, s46, v47
    v_cvt_pk_bf16_f32 v114, v100, v101
    v_cvt_pk_bf16_f32 v115, v102, v103
    ds_write_b64 v12, v[114:115] offset:1024
    s_waitcnt lgkmcnt(2)
    v_lshlrev_b32 v96, 16, v68
    v_and_b32 v97, 0xffff0000, v68
    v_lshlrev_b32 v98, 16, v69
    v_and_b32 v99, 0xffff0000, v69
    v_fma_f32 v96, v96, s46, v48
    v_fma_f32 v97, v97, s46, v49
    v_fma_f32 v98, v98, s46, v50
    v_fma_f32 v99, v99, s46, v51
    v_cvt_pk_bf16_f32 v116, v96, v97
    v_cvt_pk_bf16_f32 v117, v98, v99
    ds_write_b64 v12, v[116:117] offset:1536
    s_waitcnt lgkmcnt(0)
L_kc_bar5_37:
    s_waitcnt lgkmcnt(0)
    s_barrier
    s_cmp_ge_u32 s4, s38
    s_cbranch_scc1 L_kc_done_38
    s_add_u32 s36, s33, 17152
    v_add_u32 v12, s36, v2
    ds_read_b128 v[64:67], v12 offset:0
    ds_read_b128 v[68:71], v12 offset:1024
    ds_read_b128 v[72:75], v12 offset:2048
    ds_read_b128 v[76:79], v12 offset:3072
    s_waitcnt lgkmcnt(3)
    buffer_store_dwordx4 v[64:67], v2, s[8:11], s35 offen offset:0 sc1
    s_waitcnt lgkmcnt(2)
    buffer_store_dwordx4 v[68:71], v2, s[8:11], s35 offen offset:1024 sc1
    s_waitcnt lgkmcnt(1)
    buffer_store_dwordx4 v[72:75], v2, s[8:11], s35 offen offset:2048 sc1
    s_waitcnt lgkmcnt(0)
    buffer_store_dwordx4 v[76:79], v2, s[8:11], s35 offen offset:3072 sc1
L_kc_done_38:
    s_waitcnt vmcnt(0)
    s_barrier
    s_cmp_lg_u32 s4, 0
    s_cbranch_scc1 L_kc_nosig_39
    s_and_b32 s6, s3, 7
    s_mul_i32 s6, s6, 28
    s_lshr_b32 s7, s3, 3
    s_add_u32 s6, s6, s7
    s_add_u32 s6, s6, 512
    s_lshl_b32 s60, s6, 7
    v_mov_b32 v3, 0
    v_mov_b32 v4, s61
    s_mov_b64 exec, 1
    buffer_store_dword v4, v3, s[80:83], s60 offen sc1
    s_mov_b64 exec, -1
L_kc_nosig_39:
    s_endpgm
L_role_k_2:
    s_sub_u32 s3, s2, 224
    s_branch L_body_k_0
.section .rodata,"a"
.p2align 6
.amdhsa_kernel recurrent_scan__ssm_conv_s4d__dense_activation_silu__prompt_kernel
  .amdhsa_next_free_vgpr 256
  .amdhsa_next_free_sgpr 102
  .amdhsa_accum_offset 256
  .amdhsa_group_segment_fixed_size 0
  .amdhsa_kernarg_size 104
  .amdhsa_user_sgpr_count 2
  .amdhsa_user_sgpr_kernarg_segment_ptr 1
  .amdhsa_system_sgpr_workgroup_id_x 1
  .amdhsa_ieee_mode 0
.end_amdhsa_kernel
```
